```python
import torch

def _softmax(x, axis=-1):
    return torch.softmax(x, dim=axis)
def _gelu(x):
    return torch.nn.functional.gelu(x, approximate="tanh")
def _silu(x):
    return torch.nn.functional.silu(x)
def _sigmoid(x):
    return torch.sigmoid(x)
def _layernorm(x, axis=-1, eps=1e-5):
    m = x.mean(dim=axis, keepdim=True)
    v = x.var(dim=axis, keepdim=True, unbiased=False)
    return (x - m) / torch.sqrt(v + eps)
def _scatter_add(tgt, idx, src, axis=0):
    return tgt.clone().index_add_(axis, idx, src)
def _segment_sum(src, seg, n):
    out = torch.zeros((n,) + src.shape[1:], dtype=src.dtype)
    return out.index_add_(0, seg, src)
def _pad(x, pw):
    flat = tuple(v for pair in reversed(pw) for v in pair)
    return torch.nn.functional.pad(x, flat)

kernel_name = 'gated_mix__linear_kernel_hedgehog__glu_gated_geglu__prompt'

def setup_inputs():

    _w = (lambda a: (lambda t: t.to(torch.bfloat16) if t.is_floating_point() else t)(torch.as_tensor(a)))
    def _A_setup():
        B, S, D, H = 1, 2048, 512, 32
        Dh = D // H
        return {
            "x": _w((lambda *s: torch.randn(*s, dtype=torch.bfloat16) * 0.05)(B, S, D)),
            "wqkv": _w((lambda *s: torch.randn(*s, dtype=torch.bfloat16) * 0.8)(D, 3 * D)),
            "w_phi": _w((lambda *s: torch.randn(*s, dtype=torch.bfloat16) * 0.8)(H, Dh, Dh) * (Dh ** -0.5)),
            "wo": _w((lambda *s: torch.randn(*s, dtype=torch.bfloat16) * 0.05)(D, D)),
        }
    _A_in = _A_setup()

    def _B_setup():
        B, S, Dm, Df = 1, 2048, 512, 1792
        return {
            "x": _w((lambda *s: torch.randn(*s, dtype=torch.bfloat16) * 0.05)(B, S, Dm)),
            "w_gate": _w((lambda *s: torch.randn(*s, dtype=torch.bfloat16) * 1.6)(Dm, Df) * (Dm ** -0.5)),
            "w_up": _w((lambda *s: torch.randn(*s, dtype=torch.bfloat16) * 1.6)(Dm, Df) * (Dm ** -0.5)),
            "w_down": _w((lambda *s: torch.randn(*s, dtype=torch.bfloat16) * 1.6)(Df, Dm) * (Df ** -0.5)),
        }
    _B_in = _B_setup()

    return {
        "A_x": _A_in["x"],
        "A_wqkv": _A_in["wqkv"],
        "A_w_phi": _A_in["w_phi"],
        "A_wo": _A_in["wo"],
        "B_x": _B_in["x"],
        "B_w_gate": _B_in["w_gate"],
        "B_w_up": _B_in["w_up"],
        "B_w_down": _B_in["w_down"],
        "gate_w": _w((lambda *s: torch.randn(*s, dtype=torch.bfloat16) * 0.05)(512) * 16.0),
    }

def reference(A_x, A_wqkv, A_w_phi, A_wo, B_x, B_w_gate, B_w_up, B_w_down, gate_w):
    def _A_ref(x, wqkv, w_phi, wo):
        B, S, D = x.shape
        H = 32; Dh = D // H
        qkv = (lambda x, *d: x.permute(*d))((x @ wqkv).reshape(B, S, 3, H, Dh), 2, 0, 3, 1, 4)
        q, k, v = qkv[0], qkv[1], qkv[2]
        pq = torch.einsum("bhsd,hdf->bhsf", q, w_phi)
        pk = torch.einsum("bhsd,hdf->bhsf", k, w_phi)
        phi_q = torch.concatenate([_softmax(pq, axis=-1), _softmax(-pq, axis=-1)], axis=-1)
        phi_k = torch.concatenate([_softmax(pk, axis=-1), _softmax(-pk, axis=-1)], axis=-1)
        kv = torch.einsum("bhsf,bhsd->bhfd", phi_k, v)
        z  = torch.einsum("bhsf->bhf", phi_k)
        num = torch.einsum("bhqf,bhfd->bhqd", phi_q, kv)
        den = torch.einsum("bhqf,bhf->bhq", phi_q, z)[..., None] + 1e-6
        o = num / den
        return (lambda x, *d: x.permute(*d))(o, 0, 2, 1, 3).reshape(B, S, D) @ wo

    def _B_ref(x, w_gate, w_up, w_down):
        g = torch.einsum("bsd,df->bsf", x, w_gate)
        u = torch.einsum("bsd,df->bsf", x, w_up)
        h = _gelu(g) * u
        return torch.einsum("bsf,fd->bsd", h, w_down)

    x = A_x
    g = _sigmoid((x * gate_w).sum(-1, keepdims=True))
    a = _A_ref(x, A_wqkv, A_w_phi, A_wo)
    b = _B_ref(x, B_w_gate, B_w_up, B_w_down)
    return g * a + (1 - g) * b
```

```asm
; @launch grid=(256,1,1) block=(256,1,1) lds=163840
.amdgcn_target "amdgcn-amd-amdhsa--gfx950"
.text

.p2align 12
.globl gated_mix__linear_kernel_hedgehog__glu_gated_geglu__prompt_kernel
.p2align 8
.type gated_mix__linear_kernel_hedgehog__glu_gated_geglu__prompt_kernel,@function
gated_mix__linear_kernel_hedgehog__glu_gated_geglu__prompt_kernel:

    s_cmp_ge_u32 s2, 256
    s_cbranch_scc1 L_end
    s_load_dwordx2 s[28:29], s[0:1], 0
    s_load_dwordx16 s[4:19], s[0:1], 0
    s_load_dwordx8 s[20:27], s[0:1], 64
    s_lshr_b32 s42, s2, 3
    s_getpc_b64 s[48:49]
L_pc:
    v_lshrrev_b32 v62, 4, v0
    v_lshl_add_u32 v62, s42, 4, v62
    v_lshlrev_b32_e64 v62, 7, v62
    v_min_u32 v62, L_last-L_pc, v62
    global_load_dword v63, v62, s[48:49]
    v_lshrrev_b32_e64 v1, 6, v0
    s_and_b32 s91, s42, 7
    v_readfirstlane_b32 s40, v1
    s_and_b32 s43, s2, 1
    s_lshl3_add_u32 s43, s43, s91
    s_lshr_b32 s49, s42, 4
    s_and_b32 s44, s2, 6
    s_add_u32 s44, s44, s49
    s_lshr_b32 s99, s43, 3
    s_add_u32 s99, s99, s44
    s_lshl1_add_u32 s99, s43, s99
    s_and_b32 s99, s99, 7
    s_lshl_b32 s53, s99, 7
    v_bfe_u32 v32, v0, 3, 3
    v_and_b32 v33, 7, v0
    v_lshrrev_b32 v34, 1, v32
    v_xor_b32 v34, v34, v33
    s_lshl2_add_u32 s48, s43, s40
    s_lshl_b32 s48, s48, 15
    s_movk_i32 s49, 7168
    v_lshlrev_b32 v35, 10, v32
    v_add_u32 v36, s48, v35
    v_lshl_add_u32 v2, v34, 4, v36
    v_xad_u32 v3, v2, 64, s49
    s_lshl_b32 s49, s49, 1
    s_add_u32 s51, s40, 16
    s_lshl_b32 s51, s51, 12
    s_mov_b32 m0, s51
    v_add_u32 v4, s49, v2
    v_add_u32 v5, s49, v3
    s_mov_b32 s31, 0x20000
    s_lshl_b32 s30, s31, 4
    s_waitcnt lgkmcnt(0)
    buffer_load_dwordx4 v2, s[28:31], s53 offen offset:0 lds
    buffer_load_dwordx4 v3, s[28:31], s53 offen offset:1024 lds
    buffer_load_dwordx4 v4, s[28:31], s53 offen offset:2048 lds
    buffer_load_dwordx4 v5, s[28:31], s53 offen offset:3072 lds
    v_and_b32 v0, 63, v0
    s_lshl_b32 s99, s99, 1
    s_lshl_b32 s50, s40, 12
    s_and_b32 s46, s40, 1
    s_lshr_b32 s47, s40, 1
    v_and_b32 v37, 6, v32
    v_xor_b32 v37, v37, v33
    v_lshlrev_b32 v37, 4, v37
    v_and_b32 v39, 4, v32
    v_add_u32 v38, v39, v32
    s_bfe_u32 s45, s2, 0x10006
    s_cbranch_scc0 L_q0
    s_mov_b64 s[80:81], s[6:7]
    s_mov_b32 s82, 0x180000
    s_mov_b32 s83, s31
    s_lshl3_add_u32 s48, s46, s44
    s_lshl_b32 s48, s48, 7
    s_addk_i32 s48, 1024
    v_mul_u32_u24 v40, 3072, v38
    v_add3_u32 v6, v40, v37, s48
    v_add_u32 v9, 58368, v6
    v_add_u32 v8, 47104, v6
    v_add_u32 v7, 11264, v6
    s_add_u32 s98, s99, s47
    s_add_u32 m0, s50, 0
    s_mul_i32 s52, s98, 98304
    buffer_load_dwordx4 v6, s[80:83], s52 offen offset:0 lds
    buffer_load_dwordx4 v7, s[80:83], s52 offen offset:1024 lds
    buffer_load_dwordx4 v8, s[80:83], s52 offen offset:2048 lds
    buffer_load_dwordx4 v9, s[80:83], s52 offen offset:3072 lds
    s_branch L_kv
L_q0:
    s_cmp_eq_u32 s47, 0
    s_cselect_b64 s[32:33], s[14:15], s[16:17]
    s_mov_b32 s34, 1835008
    s_mov_b32 s35, s31
    s_lshl1_add_u32 s48, s44, s46
    s_lshl_b32 s48, s48, 7
    v_mul_u32_u24 v40, 3584, v38
    v_add3_u32 v6, v40, v37, s48
    v_add_u32 v9, 68608, v6
    v_add_u32 v8, 55296, v6
    v_add_u32 v7, 13312, v6
    s_mov_b32 s98, s99
    s_bfe_u32 s41, s43, 0x10002
    s_add_u32 m0, s50, 0
    s_mul_i32 s52, s98, 114688
    buffer_load_dwordx4 v6, s[32:35], s52 offen offset:0 lds
    buffer_load_dwordx4 v7, s[32:35], s52 offen offset:1024 lds
    buffer_load_dwordx4 v8, s[32:35], s52 offen offset:2048 lds
    buffer_load_dwordx4 v9, s[32:35], s52 offen offset:3072 lds
    v_lshlrev_b32 v16, 4, v0
    v_lshlrev_b32 v1, 2, v0
    s_mov_b64 s[68:69], s[8:9]
    s_movk_i32 s70, 0x4000
    s_mov_b32 s71, s31
    s_mov_b64 s[36:37], s[26:27]
    s_mov_b32 s38, 0x1000000
    s_mov_b32 s39, s31
    s_mov_b64 s[64:65], s[20:21]
    s_movk_i32 s66, 0x400
    s_mov_b32 s67, s31
    buffer_load_dwordx4 v[208:211], v16, s[64:67], 0 offen
    v_bfe_u32 v42, v0, 3, 1
    v_lshrrev_b32 v43, 4, v0
    v_and_b32 v44, 3, v0
    v_lshlrev_b32_e64 v45, 9, v42
    v_lshl_add_u32 v45, v43, 7, v45
    v_lshl_add_u32 v45, v44, 3, v45
    s_lshl1_add_u32 s85, s44, s47
    s_lshl_b32 s48, s85, 10
    buffer_load_dwordx2 v[240:241], v45, s[68:71], s48 offen offset:0
    buffer_load_dwordx2 v[242:243], v45, s[68:71], s48 offen offset:32
    buffer_load_dwordx2 v[244:245], v45, s[68:71], s48 offen offset:64
    buffer_load_dwordx2 v[246:247], v45, s[68:71], s48 offen offset:96
    s_and_b32 s48, s2, 0x87
    s_cbranch_scc0 L_clrq
L_noclrq:
    s_add_u32 s98, s98, 1
    s_and_b32 s98, s98, 15
    s_add_u32 m0, s50, 16384
    s_mul_i32 s52, s98, 114688
    s_mov_b64 s[80:81], s[6:7]
    s_mov_b32 s82, 0x180000
    s_mov_b32 s83, s31
    s_mov_b64 s[56:57], s[18:19]
    s_mov_b32 s58, 0x1c0000
    s_mov_b32 s59, s31
    s_mov_b64 s[60:61], s[10:11]
    s_mov_b32 s62, 0x80000
    s_mov_b32 s63, s31
    s_mov_b64 s[72:73], s[24:25]
    s_movk_i32 s74, 0x100
    s_mov_b32 s75, s31
    s_mov_b64 s[76:77], s[22:23]
    s_mov_b32 s78, 0x200000
    s_mov_b32 s79, s31
    s_lshl1_add_u32 s55, s43, s46
    s_lshl4_add_u32 s3, s55, s85
    s_lshl_b32 s48, s91, 7
    v_add3_u32 v20, v35, v37, s48
    v_lshlrev_b32 v13, 10, v39
    v_mul_u32_u24 v40, 3072, v38
    v_add_u32 v28, v40, v37
    v_and_b32 v32, 15, v0
    v_lshrrev_b32 v33, 1, v32
    v_xor_b32 v33, v33, v43
    v_lshlrev_b32_e64 v33, 4, v33
    v_lshl_add_u32 v33, v32, 7, v33
    s_add_u32 s48, s46, 8
    s_lshl_b32 s48, s48, 13
    v_add_u32 v10, s48, v33
    v_xor_b32 v11, 64, v10
    v_bfe_u32 v32, v0, 2, 3
    v_lshrrev_b32 v33, 5, v0
    v_lshlrev_b32 v33, 11, v33
    v_lshl_add_u32 v33, v32, 7, v33
    v_lshl_add_u32 v33, v44, 3, v33
    v_lshrrev_b32_e64 v32, 1, v32
    v_lshl_add_u32 v24, v32, 5, v33
    s_lshl_b32 s48, s47, 6
    v_xor_b32 v14, s48, v24
    v_xor_b32_e64 v15, 32, v14
    s_add_u32 s48, s50, 0x20000
    v_add_u32 v24, s48, v24
    v_xor_b32 v25, 32, v24
    v_xor_b32_e64 v26, 64, v24
    v_xor_b32 v27, 96, v24
    v_lshl_add_u32 v218, v0, 2, s40
    v_cmp_eq_u32_e64 vcc, 1, v218
    v_mov_b32 v219, 0x7ffffff0
    s_nop 0
    v_cndmask_b32_e64 v18, v219, 0, vcc
    s_lshl_b32 s48, s44, 7
    v_add_u32 v28, s48, v28
    s_and_b32 s48, s2, 7
    s_lshr_b32 s90, s42, 3
    s_lshl2_add_u32 s90, s48, s90
    s_bfe_u32 s48, s91, 0x10000
    s_xor_b32 s90, s90, s48
    s_lshl_b32 s4, s40, 18
    s_lshl_b32 s7, s40, 17
    s_add_u32 s5, s7, 1048576
    s_lshl_b32 s6, s40, 16
    s_add_u32 s6, s6, 1572864
    s_mul_i32 s48, s90, 294912
    s_add_u32 s48, s48, 0x100000
    s_lshr_b32 s8, s4, 3
    s_add_u32 s8, s8, s48
    s_lshr_b32 s9, s5, 3
    s_add_u32 s9, s9, s48
    s_lshr_b32 s10, s6, 3
    s_add_u32 s10, s10, s48
    s_add_u32 s11, s9, 98304
    s_and_b32 s48, s2, 7
    s_lshl_b32 s100, s48, 15
    s_lshl_b32 s101, s48, 12
    s_bfe_u32 s48, s90, 0x10001
    s_lshl_b32 s49, s48, 17
    s_add_u32 s4, s4, s49
    s_lshl_b32 s49, s48, 14
    s_add_u32 s8, s8, s49
    s_lshl_b32 s49, s48, 16
    s_add_u32 s7, s7, s49
    s_lshl_b32 s49, s48, 13
    s_add_u32 s11, s11, s49
    v_add_u32 v21, 15360, v20
    v_add_u32 v22, 6144, v20
    v_add_u32 v23, 21504, v20
    buffer_load_dwordx4 v6, s[32:35], s52 offen offset:0 lds
    buffer_load_dwordx4 v7, s[32:35], s52 offen offset:1024 lds
    buffer_load_dwordx4 v8, s[32:35], s52 offen offset:2048 lds
    buffer_load_dwordx4 v9, s[32:35], s52 offen offset:3072 lds
    s_addk_i32 s53, 128
    s_and_b32 s53, s53, 0x3ff
    s_add_u32 m0, s51, 16384
    s_nop 0
    buffer_load_dwordx4 v2, s[28:31], s53 offen offset:0 lds
    buffer_load_dwordx4 v3, s[28:31], s53 offen offset:1024 lds
    s_mov_b64 exec, 0
    s_cmp_eq_u32 s40, 0
    s_cbranch_scc1 L_qmain_s1
    s_cmp_eq_u32 s40, 1
    s_cbranch_scc1 L_qmain_s2
    s_cmp_eq_u32 s40, 2
    s_cbranch_scc1 L_qmain_s3
    s_branch L_qmain_s4
L_qmain_ret:
    s_mov_b64 exec, -1
    s_branch L_qmain
.p2align 6
L_kv:
    v_lshlrev_b32 v16, 4, v0
    v_lshlrev_b32 v1, 2, v0
    s_mov_b64 s[68:69], s[8:9]
    s_movk_i32 s70, 0x4000
    s_mov_b32 s71, s31
    s_mov_b64 s[36:37], s[26:27]
    s_mov_b32 s38, 0x1000000
    s_mov_b32 s39, s31
    v_bfe_u32 v42, v0, 3, 1
    v_lshrrev_b32 v43, 4, v0
    v_and_b32 v44, 3, v0
    v_lshlrev_b32 v45, 9, v42
    v_lshl_add_u32 v45, v43, 7, v45
    v_lshl_add_u32 v45, v44, 3, v45
    s_lshl1_add_u32 s85, s44, s47
    s_lshl_b32 s48, s85, 10
    buffer_load_dwordx2 v[104:105], v45, s[68:71], s48 offen offset:0
    buffer_load_dwordx2 v[106:107], v45, s[68:71], s48 offen offset:32
    buffer_load_dwordx2 v[108:109], v45, s[68:71], s48 offen offset:64
    buffer_load_dwordx2 v[110:111], v45, s[68:71], s48 offen offset:96
    s_and_b32 s48, s2, 0x87
    s_cbranch_scc0 L_clrk
L_noclrk:
    s_addk_i32 s53, 128
    s_and_b32 s53, s53, 0x3ff
    s_add_u32 m0, s51, 16384
    s_cmp_eq_u32 s46, 0
    s_cselect_b64 s[32:33], s[14:15], s[16:17]
    s_mov_b32 s34, 1835008
    s_mov_b32 s35, s31
    s_mov_b64 s[56:57], s[18:19]
    s_mov_b32 s58, 0x1c0000
    s_mov_b32 s59, s31
    s_mov_b64 s[60:61], s[10:11]
    s_mov_b32 s62, 0x80000
    s_mov_b32 s63, s31
    s_mov_b64 s[72:73], s[24:25]
    s_movk_i32 s74, 0x100
    s_mov_b32 s75, s31
    s_mov_b64 s[76:77], s[22:23]
    s_mov_b32 s78, 0x200000
    s_mov_b32 s79, s31
    s_lshl1_add_u32 s55, s43, s46
    s_lshl4_add_u32 s3, s55, s85
    s_lshl_b32 s48, s91, 7
    v_add3_u32 v20, v35, v37, s48
    v_lshlrev_b32 v13, 10, v39
    v_mul_u32_u24 v40, 3584, v38
    v_add_u32 v28, v40, v37
    v_and_b32 v32, 15, v0
    v_lshrrev_b32 v33, 1, v32
    v_xor_b32 v33, v33, v43
    v_lshlrev_b32_e64 v33, 4, v33
    v_lshl_add_u32 v33, v32, 7, v33
    s_add_u32 s48, s46, 8
    s_lshl_b32 s48, s48, 13
    v_add_u32 v10, s48, v33
    v_xor_b32 v11, 64, v10
    v_bfe_u32 v32, v0, 2, 3
    v_lshrrev_b32 v33, 5, v0
    v_lshlrev_b32 v33, 11, v33
    v_lshl_add_u32 v33, v32, 7, v33
    v_lshl_add_u32 v33, v44, 3, v33
    v_lshrrev_b32_e64 v32, 1, v32
    v_lshl_add_u32 v24, v32, 5, v33
    s_lshl_b32 s48, s47, 6
    v_xor_b32 v14, s48, v24
    v_xor_b32_e64 v15, 32, v14
    s_add_u32 s48, s50, 0x20000
    v_add_u32 v24, s48, v24
    v_xor_b32 v25, 32, v24
    v_xor_b32_e64 v26, 64, v24
    v_xor_b32 v27, 96, v24
    v_lshl_add_u32 v120, v0, 2, s40
    v_cmp_eq_u32_e64 vcc, 1, v120
    v_mov_b32 v121, 0x7ffffff0
    s_nop 0
    v_cndmask_b32_e64 v18, v121, 0, vcc
    buffer_load_dwordx4 v2, s[28:31], s53 offen offset:0 lds
    buffer_load_dwordx4 v3, s[28:31], s53 offen offset:1024 lds
    buffer_load_dwordx4 v4, s[28:31], s53 offen offset:2048 lds
    buffer_load_dwordx4 v5, s[28:31], s53 offen offset:3072 lds
    s_add_u32 s98, s98, 2
    s_and_b32 s98, s98, 15
    s_add_u32 m0, s50, 16384
    s_mul_i32 s52, s98, 98304
    buffer_load_dwordx4 v6, s[80:83], s52 offen offset:0 lds
    buffer_load_dwordx4 v7, s[80:83], s52 offen offset:1024 lds
    s_mov_b64 exec, 0
    s_cmp_eq_u32 s40, 0
    s_cbranch_scc1 L_kvmain_s1
    s_cmp_eq_u32 s40, 1
    s_cbranch_scc1 L_kvmain_s2
    s_cmp_eq_u32 s40, 2
    s_cbranch_scc1 L_kvmain_s3
    s_branch L_kvmain_s4
L_kvmain_ret:
    s_mov_b64 exec, -1
    s_branch L_kvmain
L_end:
    s_endpgm
L_clrq:
    v_mov_b32 v56, 0
    v_mov_b32 v57, 0
    v_mov_b32 v58, 0
    v_mov_b32 v59, 0
    s_lshl2_add_u32 s49, s42, s40
    s_lshl_b32 s48, s49, 11
    s_add_u32 s48, s48, 0x40000
    buffer_store_dwordx4 v[56:59], v16, s[36:39], s48 offen sc1
    buffer_store_dwordx4 v[56:59], v16, s[36:39], s48 offen offset:1024 sc1
    v_mov_b32 v52, -1
    v_mov_b32 v53, -1
    v_mov_b32 v54, -1
    v_mov_b32_e64 v55, -1
    s_lshl_b32 s48, s49, 10
    buffer_store_dwordx4 v[52:55], v16, s[36:39], s48 offen sc1
    s_branch L_noclrq
L_clrk:
    v_mov_b32 v56, 0
    v_mov_b32 v57, 0
    v_mov_b32 v58, 0
    v_mov_b32_e64 v59, 0
    s_lshl2_add_u32 s49, s42, s40
    s_lshl_b32 s48, s49, 11
    s_add_u32 s48, s48, 0x40000
    buffer_store_dwordx4 v[56:59], v16, s[36:39], s48 offen sc1
    buffer_store_dwordx4 v[56:59], v16, s[36:39], s48 offen offset:1024 sc1
    v_mov_b32 v52, -1
    v_mov_b32 v53, -1
    v_mov_b32 v54, -1
    v_mov_b32_e64 v55, -1
    s_lshl_b32 s48, s49, 10
    buffer_store_dwordx4 v[52:55], v16, s[36:39], s48 offen sc1
    s_branch L_noclrk
L_sp1:
    s_mov_b32 s87, 0x40000
L_sq1:
    buffer_load_dword v19, v1, s[72:75], 0 offen offset:0 sc1
    s_waitcnt vmcnt(0)
    v_cmp_ne_u32 s[92:93], 0, v19
    s_nop 1
    s_cmp_eq_u64 s[92:93], -1
    s_cbranch_scc1 L_ok1
    s_sub_u32 s87, s87, 1
    s_cmp_lg_u32 s87, 0
    s_cbranch_scc1 L_sq1
    s_branch L_ok1
L_spgQ:
    s_mov_b32 s87, 0x40000
L_sqgQ:
    buffer_load_dword v12, v29, s[36:39], s45 offen sc1
    s_waitcnt vmcnt(0)
    v_cmp_ne_u32 s[92:93], v12, 0
    s_nop 1
    s_cmp_eq_u64 s[92:93], -1
    s_cbranch_scc1 L_okgQ
    s_sleep 8
    s_sub_u32 s87, s87, 1
    s_cmp_lg_u32 s87, 0
    s_cbranch_scc1 L_sqgQ
    s_branch L_okgQ
L_sp2:
    s_mov_b32 s87, 0x40000
L_sq2:
    buffer_load_dword v19, v1, s[36:39], s15 offen offset:0 sc1
    s_waitcnt vmcnt(0)
    v_cmp_ne_u32 s[92:93], 0, v19
    s_nop 1
    s_cmp_eq_u64 s[92:93], -1
    s_cbranch_scc1 L_ok2
    s_sub_u32 s87, s87, 1
    s_cmp_lg_u32 s87, 0
    s_cbranch_scc1 L_sq2
    s_branch L_ok2
L_sp3:
    s_mov_b32 s87, 0x40000
L_sq3:
    buffer_load_dword v19, v1, s[36:39], s1 offen offset:0 sc1
    s_waitcnt vmcnt(0)
    v_cmp_ne_u32 s[92:93], 0, v19
    s_nop 1
    s_cmp_eq_u64 s[92:93], -1
    s_cbranch_scc1 L_ok3
    s_sub_u32 s87, s87, 1
    s_cmp_lg_u32 s87, 0
    s_cbranch_scc1 L_sq3
    s_branch L_ok3
L_spkv:
    s_mov_b32 s87, 0x40000
L_sqkv:
    buffer_load_dwordx4 v[176:179], v161, s[36:39], s17 offen offset:0 sc1
    buffer_load_dwordx4 v[180:183], v161, s[36:39], s17 offen offset:1024 sc1
    buffer_load_dwordx4 v[184:187], v162, s[36:39], s17 offen offset:0 sc1
    buffer_load_dwordx4 v[188:191], v162, s[36:39], s17 offen offset:16 sc1
    s_waitcnt vmcnt(0)
    v_max3_u32 v164, v176, v177, v178
    v_max3_u32 v164, v164, v179, v180
    v_max3_u32 v164, v164, v181, v182
    v_max3_u32 v164, v164, v183, v184
    v_max3_u32 v164, v164, v185, v186
    v_max3_u32 v164, v164, v187, v188
    v_max3_u32 v164, v164, v189, v190
    v_max_u32 v164, v164, v191
    v_cmp_ne_u32 s[92:93], -1, v164
    s_nop 1
    s_cmp_eq_u64 s[92:93], -1
    s_cbranch_scc1 L_okkv
    s_sub_u32 s87, s87, 1
    s_cmp_lg_u32 s87, 0
    s_cbranch_scc1 L_sqkv
    s_branch L_okkv
L_sp4:
    s_mov_b32 s87, 0x40000
L_sq4:
    buffer_load_dword v19, v1, s[36:39], s1 offen offset:1024 sc1
    s_waitcnt vmcnt(0)
    v_cmp_ne_u32 s[92:93], 0, v19
    s_nop 1
    s_cmp_eq_u64 s[92:93], -1
    s_cbranch_scc1 L_ok4
    s_sub_u32 s87, s87, 1
    s_cmp_lg_u32 s87, 0
    s_cbranch_scc1 L_sq4
    s_branch L_ok4
L_sp5:
    s_mov_b32 s87, 0x40000
L_sq5:
    buffer_load_dword v19, v1, s[36:39], s49 offen offset:1024 sc1
    s_waitcnt vmcnt(0)
    v_cmp_ne_u32 s[92:93], 0, v19
    s_nop 1
    s_cmp_eq_u64 s[92:93], -1
    s_cbranch_scc1 L_ok5
    s_sub_u32 s87, s87, 1
    s_cmp_lg_u32 s87, 0
    s_cbranch_scc1 L_sq5
    s_branch L_ok5
L_sp6:
    s_mov_b32 s87, 0x40000
L_sq6:
    buffer_load_dword v10, v1, s[36:39], s49 offen offset:0 sc1
    s_waitcnt vmcnt(0)
    v_cmp_ne_u32 s[92:93], 0, v10
    s_nop 1
    s_cmp_eq_u64 s[92:93], -1
    s_cbranch_scc1 L_ok6
    s_sub_u32 s87, s87, 1
    s_cmp_lg_u32 s87, 0
    s_cbranch_scc1 L_sq6
    s_branch L_ok6
L_sp7:
    s_mov_b32 s87, 0x40000
L_sq7:
    buffer_load_dword v19, v1, s[72:75], 0 offen offset:0 sc1
    s_waitcnt vmcnt(0)
    v_cmp_ne_u32 s[92:93], 0, v19
    s_nop 1
    s_cmp_eq_u64 s[92:93], -1
    s_cbranch_scc1 L_ok7
    s_sub_u32 s87, s87, 1
    s_cmp_lg_u32 s87, 0
    s_cbranch_scc1 L_sq7
    s_branch L_ok7
L_spgKV:
    s_mov_b32 s87, 0x40000
L_sqgKV:
    buffer_load_dword v164, v165, s[36:39], s45 offen sc1
    s_waitcnt vmcnt(0)
    v_cmp_ne_u32 s[92:93], v164, 0
    s_nop 1
    s_cmp_eq_u64 s[92:93], -1
    s_cbranch_scc1 L_okgKV
    s_sleep 8
    s_sub_u32 s87, s87, 1
    s_cmp_lg_u32 s87, 0
    s_cbranch_scc1 L_sqgKV
    s_branch L_okgKV
L_sp8:
    s_mov_b32 s87, 0x40000
L_sq8:
    buffer_load_dword v19, v1, s[36:39], s1 offen offset:0 sc1
    s_waitcnt vmcnt(0)
    v_cmp_ne_u32 s[92:93], 0, v19
    s_nop 1
    s_cmp_eq_u64 s[92:93], -1
    s_cbranch_scc1 L_ok8
    s_sub_u32 s87, s87, 1
    s_cmp_lg_u32 s87, 0
    s_cbranch_scc1 L_sq8
    s_branch L_ok8
L_sp9:
    s_mov_b32 s87, 0x40000
L_sq9:
    buffer_load_dword v19, v1, s[36:39], s1 offen offset:1024 sc1
    s_waitcnt vmcnt(0)
    v_cmp_ne_u32 s[92:93], 0, v19
    s_nop 1
    s_cmp_eq_u64 s[92:93], -1
    s_cbranch_scc1 L_ok9
    s_sub_u32 s87, s87, 1
    s_cmp_lg_u32 s87, 0
    s_cbranch_scc1 L_sq9
    s_branch L_ok9
L_sp10:
    s_mov_b32 s87, 0x40000
L_sq10:
    buffer_load_dword v19, v1, s[36:39], s49 offen offset:1024 sc1
    s_waitcnt vmcnt(0)
    v_cmp_ne_u32 s[92:93], 0, v19
    s_nop 1
    s_cmp_eq_u64 s[92:93], -1
    s_cbranch_scc1 L_ok10
    s_sub_u32 s87, s87, 1
    s_cmp_lg_u32 s87, 0
    s_cbranch_scc1 L_sq10
    s_branch L_ok10
L_sp11:
    s_mov_b32 s87, 0x40000
L_sq11:
    buffer_load_dword v10, v1, s[36:39], s49 offen offset:0 sc1
    s_waitcnt vmcnt(0)
    v_cmp_ne_u32 s[92:93], 0, v10
    s_nop 1
    s_cmp_eq_u64 s[92:93], -1
    s_cbranch_scc1 L_ok11
    s_sub_u32 s87, s87, 1
    s_cmp_lg_u32 s87, 0
    s_cbranch_scc1 L_sq11
    s_branch L_ok11
.p2align 12
L_qmain:
    buffer_load_dwordx4 v4, s[28:31], s53 offen offset:2048 lds
    buffer_load_dwordx4 v5, s[28:31], s53 offen offset:3072 lds
    s_add_u32 s98, s98, 1
    s_and_b32 s98, s98, 15
    s_add_u32 m0, s50, 32768
    s_mul_i32 s52, s98, 114688
    s_waitcnt vmcnt(13)
    s_barrier
    ds_read_b128 a[0:3], v10 offset:0
    ds_read_b128 a[4:7], v10 offset:2048
    ds_read_b128 a[8:11], v10 offset:4096
    ds_read_b128 a[12:15], v10 offset:6144
    ds_read_b64_tr_b16 v[32:33], v14 offset:0
    ds_read_b64_tr_b16 v[34:35], v14 offset:1024
    ds_read_b64_tr_b16 v[36:37], v15 offset:0
    ds_read_b64_tr_b16 v[38:39], v15 offset:1024
    ds_read_b64_tr_b16 v[40:41], v14 offset:8192
    ds_read_b64_tr_b16 v[42:43], v14 offset:9216
    ds_read_b64_tr_b16 v[44:45], v15 offset:8192
    ds_read_b64_tr_b16 v[46:47], v15 offset:9216
    buffer_load_dwordx4 v6, s[32:35], s52 offen offset:0 lds
    buffer_load_dwordx4 v7, s[32:35], s52 offen offset:1024 lds
    buffer_load_dwordx4 v8, s[32:35], s52 offen offset:2048 lds
    s_waitcnt lgkmcnt(6)
    v_mfma_f32_16x16x32_bf16 v[64:67], v[32:35], a[0:3], 0
    ds_read_b64_tr_b16 v[48:49], v14 offset:4096
    v_mfma_f32_16x16x32_bf16 v[80:83], v[32:35], a[4:7], 0
    buffer_load_dwordx4 v9, s[32:35], s52 offen offset:3072 lds
    v_mfma_f32_16x16x32_bf16 v[96:99], v[32:35], a[8:11], 0
    ds_read_b64_tr_b16 v[50:51], v14 offset:5120
    s_add_u32 s98, s98, 1
    s_and_b32 s98, s98, 15
    v_mfma_f32_16x16x32_bf16 v[112:115], v[32:35], a[12:15], 0
    ds_read_b64_tr_b16 v[52:53], v15 offset:4096
    s_add_u32 m0, s50, 49152
    s_waitcnt lgkmcnt(7)
    v_mfma_f32_16x16x32_bf16 v[116:119], v[36:39], a[12:15], 0
    ds_read_b64_tr_b16 v[54:55], v15 offset:5120
    s_mul_i32 s52, s98, 114688
    v_mfma_f32_16x16x32_bf16 v[100:103], v[36:39], a[8:11], 0
    buffer_load_dwordx4 v6, s[32:35], s52 offen offset:0 lds
    v_mfma_f32_16x16x32_bf16 v[84:87], v[36:39], a[4:7], 0
    ds_read_b64_tr_b16 v[56:57], v14 offset:12288
    v_mfma_f32_16x16x32_bf16 v[68:71], v[36:39], a[0:3], 0
    ds_read_b64_tr_b16 v[58:59], v14 offset:13312
    s_waitcnt lgkmcnt(5)
    v_mfma_f32_16x16x32_bf16 v[72:75], v[40:43], a[0:3], 0
    ds_read_b64_tr_b16 v[60:61], v15 offset:12288
    v_mfma_f32_16x16x32_bf16 v[88:91], v[40:43], a[4:7], 0
    buffer_load_dwordx4 v7, s[32:35], s52 offen offset:1024 lds
    v_mfma_f32_16x16x32_bf16 v[104:107], v[40:43], a[8:11], 0
    ds_read_b64_tr_b16 v[62:63], v15 offset:13312
    v_mfma_f32_16x16x32_bf16 v[120:123], v[40:43], a[12:15], 0
    v_mfma_f32_16x16x32_bf16 v[124:127], v[44:47], a[12:15], 0
    v_mfma_f32_16x16x32_bf16 v[108:111], v[44:47], a[8:11], 0
    buffer_load_dwordx4 v8, s[32:35], s52 offen offset:2048 lds
    v_mfma_f32_16x16x32_bf16 v[92:95], v[44:47], a[4:7], 0
    s_waitcnt vmcnt(11) lgkmcnt(0)
    v_mfma_f32_16x16x32_bf16 v[76:79], v[44:47], a[0:3], 0
    s_barrier
    v_mfma_f32_16x16x32_bf16 v[128:131], v[48:51], a[0:3], 0
    ds_read_b128 a[16:19], v11 offset:0
    v_mfma_f32_16x16x32_bf16 v[144:147], v[48:51], a[4:7], 0
    buffer_load_dwordx4 v9, s[32:35], s52 offen offset:3072 lds
    v_mfma_f32_16x16x32_bf16 v[160:163], v[48:51], a[8:11], 0
    ds_read_b64_tr_b16 v[32:33], v14 offset:16384
    s_addk_i32 s53, 128
    v_mfma_f32_16x16x32_bf16 v[176:179], v[48:51], a[12:15], 0
    ds_read_b64_tr_b16 v[34:35], v14 offset:17408
    s_and_b32 s53, s53, 0x3ff
    v_mfma_f32_16x16x32_bf16 v[180:183], v[52:55], a[12:15], 0
    ds_read_b128 a[20:23], v11 offset:2048
    s_add_u32 m0, s51, 32768
    v_mfma_f32_16x16x32_bf16 v[164:167], v[52:55], a[8:11], 0
    buffer_load_dwordx4 v2, s[28:31], s53 offen offset:0 lds
    v_mfma_f32_16x16x32_bf16 v[148:151], v[52:55], a[4:7], 0
    ds_read_b128 a[24:27], v11 offset:4096
    v_mfma_f32_16x16x32_bf16 v[132:135], v[52:55], a[0:3], 0
    ds_read_b128 a[28:31], v11 offset:6144
    v_mfma_f32_16x16x32_bf16 v[136:139], v[56:59], a[0:3], 0
    ds_read_b64_tr_b16 v[36:37], v15 offset:16384
    v_mfma_f32_16x16x32_bf16 v[152:155], v[56:59], a[4:7], 0
    buffer_load_dwordx4 v3, s[28:31], s53 offen offset:1024 lds
    v_mfma_f32_16x16x32_bf16 v[168:171], v[56:59], a[8:11], 0
    ds_read_b64_tr_b16 v[38:39], v15 offset:17408
    s_and_b32 s87, s2, 0x87
    s_cbranch_scc1 L_nosigQ
    s_lshl_b32 s87, s42, 4
    buffer_store_dwordx4 v[24:27], v18, s[72:75], s87 offen sc1
L_nosigQ:
    s_add_u32 s98, s98, 1
    v_mfma_f32_16x16x32_bf16 v[184:187], v[56:59], a[12:15], 0
    ds_read_b64_tr_b16 v[40:41], v14 offset:24576
    s_and_b32 s98, s98, 15
    s_add_u32 m0, s50, 0
    v_mfma_f32_16x16x32_bf16 v[188:191], v[60:63], a[12:15], 0
    ds_read_b64_tr_b16 v[42:43], v14 offset:25600
    s_mul_i32 s52, s98, 114688
    v_mfma_f32_16x16x32_bf16 v[172:175], v[60:63], a[8:11], 0
    buffer_load_dwordx4 v6, s[32:35], s52 offen offset:0 lds
    v_mfma_f32_16x16x32_bf16 v[156:159], v[60:63], a[4:7], 0
    ds_read_b64_tr_b16 v[44:45], v15 offset:24576
    v_mfma_f32_16x16x32_bf16 v[140:143], v[60:63], a[0:3], 0
    ds_read_b64_tr_b16 v[46:47], v15 offset:25600
    s_waitcnt lgkmcnt(5)
    v_mfma_f32_16x16x32_bf16 v[64:67], v[32:35], a[16:19], v[64:67]
    ds_read_b64_tr_b16 v[48:49], v14 offset:20480
    v_lshlrev_b32_e64 v212, 16, v208
    v_mfma_f32_16x16x32_bf16 v[80:83], v[32:35], a[20:23], v[80:83]
    buffer_load_dwordx4 v7, s[32:35], s52 offen offset:1024 lds
    v_mfma_f32_16x16x32_bf16 v[96:99], v[32:35], a[24:27], v[96:99]
    ds_read_b64_tr_b16 v[50:51], v14 offset:21504
    v_lshlrev_b32_e64 v213, 16, v209
    v_mfma_f32_16x16x32_bf16 v[112:115], v[32:35], a[28:31], v[112:115]
    ds_read_b64_tr_b16 v[52:53], v15 offset:20480
    s_waitcnt lgkmcnt(5)
    v_mfma_f32_16x16x32_bf16 v[116:119], v[36:39], a[28:31], v[116:119]
    ds_read_b64_tr_b16 v[54:55], v15 offset:21504
    v_lshlrev_b32 v214, 16, v210
    v_mfma_f32_16x16x32_bf16 v[100:103], v[36:39], a[24:27], v[100:103]
    buffer_load_dwordx4 v8, s[32:35], s52 offen offset:2048 lds
    v_mfma_f32_16x16x32_bf16 v[84:87], v[36:39], a[20:23], v[84:87]
    ds_read_b64_tr_b16 v[56:57], v14 offset:28672
    v_lshlrev_b32_e64 v215, 16, v211
    v_mfma_f32_16x16x32_bf16 v[68:71], v[36:39], a[16:19], v[68:71]
    ds_read_b64_tr_b16 v[58:59], v14 offset:29696
    v_and_b32 v208, 0xffff0000, v208
    v_mfma_f32_16x16x32_bf16 v[72:75], v[40:43], a[16:19], v[72:75]
    ds_read_b64_tr_b16 v[60:61], v15 offset:28672
    v_and_b32 v209, 0xffff0000, v209
    v_mfma_f32_16x16x32_bf16 v[88:91], v[40:43], a[20:23], v[88:91]
    buffer_load_dwordx4 v9, s[32:35], s52 offen offset:3072 lds
    v_mfma_f32_16x16x32_bf16 v[104:107], v[40:43], a[24:27], v[104:107]
    ds_read_b64_tr_b16 v[62:63], v15 offset:29696
    v_and_b32 v210, 0xffff0000, v210
    v_mfma_f32_16x16x32_bf16 v[120:123], v[40:43], a[28:31], v[120:123]
    v_and_b32 v211, 0xffff0000, v211
    s_waitcnt lgkmcnt(4)
    v_mfma_f32_16x16x32_bf16 v[124:127], v[44:47], a[28:31], v[124:127]
    s_add_u32 m0, s51, 32768
    v_mfma_f32_16x16x32_bf16 v[108:111], v[44:47], a[24:27], v[108:111]
    buffer_load_dwordx4 v4, s[28:31], s53 offen offset:2048 lds
    v_mfma_f32_16x16x32_bf16 v[92:95], v[44:47], a[20:23], v[92:95]
    s_waitcnt vmcnt(11) lgkmcnt(0)
    v_mfma_f32_16x16x32_bf16 v[76:79], v[44:47], a[16:19], v[76:79]
    s_barrier
    v_mfma_f32_16x16x32_bf16 v[128:131], v[48:51], a[16:19], v[128:131]
    ds_read_b128 a[32:35], v10 offset:16384
    v_mfma_f32_16x16x32_bf16 v[144:147], v[48:51], a[20:23], v[144:147]
    buffer_load_dwordx4 v5, s[28:31], s53 offen offset:3072 lds
    v_mfma_f32_16x16x32_bf16 v[160:163], v[48:51], a[24:27], v[160:163]
    ds_read_b64_tr_b16 v[32:33], v14 offset:32768
    s_add_u32 s98, s98, 1
    s_and_b32 s98, s98, 15
    v_mfma_f32_16x16x32_bf16 v[176:179], v[48:51], a[28:31], v[176:179]
    ds_read_b64_tr_b16 v[34:35], v14 offset:33792
    s_add_u32 m0, s50, 16384
    v_mfma_f32_16x16x32_bf16 v[180:183], v[52:55], a[28:31], v[180:183]
    ds_read_b128 a[36:39], v10 offset:18432
    s_mul_i32 s52, s98, 114688
    v_mfma_f32_16x16x32_bf16 v[164:167], v[52:55], a[24:27], v[164:167]
    buffer_load_dwordx4 v6, s[32:35], s52 offen offset:0 lds
    v_mfma_f32_16x16x32_bf16 v[148:151], v[52:55], a[20:23], v[148:151]
    ds_read_b128 a[40:43], v10 offset:20480
    v_mfma_f32_16x16x32_bf16 v[132:135], v[52:55], a[16:19], v[132:135]
    ds_read_b128 a[44:47], v10 offset:22528
    v_mfma_f32_16x16x32_bf16 v[136:139], v[56:59], a[16:19], v[136:139]
    ds_read_b64_tr_b16 v[36:37], v15 offset:32768
    v_mfma_f32_16x16x32_bf16 v[152:155], v[56:59], a[20:23], v[152:155]
    buffer_load_dwordx4 v7, s[32:35], s52 offen offset:1024 lds
    v_mfma_f32_16x16x32_bf16 v[168:171], v[56:59], a[24:27], v[168:171]
    ds_read_b64_tr_b16 v[38:39], v15 offset:33792
    v_mfma_f32_16x16x32_bf16 v[184:187], v[56:59], a[28:31], v[184:187]
    ds_read_b64_tr_b16 v[40:41], v14 offset:40960
    v_mfma_f32_16x16x32_bf16 v[188:191], v[60:63], a[28:31], v[188:191]
    ds_read_b64_tr_b16 v[42:43], v14 offset:41984
    v_mfma_f32_16x16x32_bf16 v[172:175], v[60:63], a[24:27], v[172:175]
    buffer_load_dwordx4 v8, s[32:35], s52 offen offset:2048 lds
    v_mfma_f32_16x16x32_bf16 v[156:159], v[60:63], a[20:23], v[156:159]
    ds_read_b64_tr_b16 v[44:45], v15 offset:40960
    v_mfma_f32_16x16x32_bf16 v[140:143], v[60:63], a[16:19], v[140:143]
    ds_read_b64_tr_b16 v[46:47], v15 offset:41984
    s_waitcnt lgkmcnt(5)
    v_mfma_f32_16x16x32_bf16 v[64:67], v[32:35], a[32:35], v[64:67]
    ds_read_b64_tr_b16 v[48:49], v14 offset:36864
    v_mfma_f32_16x16x32_bf16 v[80:83], v[32:35], a[36:39], v[80:83]
    buffer_load_dwordx4 v9, s[32:35], s52 offen offset:3072 lds
    v_mfma_f32_16x16x32_bf16 v[96:99], v[32:35], a[40:43], v[96:99]
    ds_read_b64_tr_b16 v[50:51], v14 offset:37888
    s_addk_i32 s53, 128
    v_mfma_f32_16x16x32_bf16 v[112:115], v[32:35], a[44:47], v[112:115]
    ds_read_b64_tr_b16 v[52:53], v15 offset:36864
    s_and_b32 s53, s53, 0x3ff
    s_waitcnt lgkmcnt(5)
    v_mfma_f32_16x16x32_bf16 v[116:119], v[36:39], a[44:47], v[116:119]
    ds_read_b64_tr_b16 v[54:55], v15 offset:37888
    s_add_u32 m0, s51, 49152
    v_mfma_f32_16x16x32_bf16 v[100:103], v[36:39], a[40:43], v[100:103]
    buffer_load_dwordx4 v2, s[28:31], s53 offen offset:0 lds
    v_mfma_f32_16x16x32_bf16 v[84:87], v[36:39], a[36:39], v[84:87]
    ds_read_b64_tr_b16 v[56:57], v14 offset:45056
    v_mfma_f32_16x16x32_bf16 v[68:71], v[36:39], a[32:35], v[68:71]
    ds_read_b64_tr_b16 v[58:59], v14 offset:46080
    v_mfma_f32_16x16x32_bf16 v[72:75], v[40:43], a[32:35], v[72:75]
    ds_read_b64_tr_b16 v[60:61], v15 offset:45056
    v_mfma_f32_16x16x32_bf16 v[88:91], v[40:43], a[36:39], v[88:91]
    buffer_load_dwordx4 v3, s[28:31], s53 offen offset:1024 lds
    v_mfma_f32_16x16x32_bf16 v[104:107], v[40:43], a[40:43], v[104:107]
    ds_read_b64_tr_b16 v[62:63], v15 offset:46080
    v_mfma_f32_16x16x32_bf16 v[120:123], v[40:43], a[44:47], v[120:123]
    s_waitcnt lgkmcnt(4)
    v_mfma_f32_16x16x32_bf16 v[124:127], v[44:47], a[44:47], v[124:127]
    s_lshl_b32 s45, s3, 12
    v_mfma_f32_16x16x32_bf16 v[108:111], v[44:47], a[40:43], v[108:111]
    buffer_load_dwordx4 v[192:195], v16, s[28:31], s45 offen offset:0
    v_mfma_f32_16x16x32_bf16 v[92:95], v[44:47], a[36:39], v[92:95]
    s_waitcnt vmcnt(15) lgkmcnt(0)
    v_mfma_f32_16x16x32_bf16 v[76:79], v[44:47], a[32:35], v[76:79]
    s_barrier
    v_mfma_f32_16x16x32_bf16 v[128:131], v[48:51], a[32:35], v[128:131]
    ds_read_b128 a[48:51], v11 offset:16384
    s_add_u32 s98, s98, 1
    v_mfma_f32_16x16x32_bf16 v[144:147], v[48:51], a[36:39], v[144:147]
    ds_read_b64_tr_b16 v[32:33], v14 offset:49152
    s_and_b32 s98, s98, 15
    v_mfma_f32_16x16x32_bf16 v[160:163], v[48:51], a[40:43], v[160:163]
    ds_read_b64_tr_b16 v[34:35], v14 offset:50176
    s_add_u32 m0, s50, 32768
    v_mfma_f32_16x16x32_bf16 v[176:179], v[48:51], a[44:47], v[176:179]
    ds_read_b128 a[52:55], v11 offset:18432
    s_mul_i32 s52, s98, 114688
    v_mfma_f32_16x16x32_bf16 v[180:183], v[52:55], a[44:47], v[180:183]
    buffer_load_dwordx4 v6, s[32:35], s52 offen offset:0 lds
    v_mfma_f32_16x16x32_bf16 v[164:167], v[52:55], a[40:43], v[164:167]
    ds_read_b128 a[56:59], v11 offset:20480
    v_mfma_f32_16x16x32_bf16 v[148:151], v[52:55], a[36:39], v[148:151]
    ds_read_b128 a[60:63], v11 offset:22528
    v_mfma_f32_16x16x32_bf16 v[132:135], v[52:55], a[32:35], v[132:135]
    ds_read_b64_tr_b16 v[36:37], v15 offset:49152
    v_mfma_f32_16x16x32_bf16 v[136:139], v[56:59], a[32:35], v[136:139]
    ds_read_b64_tr_b16 v[38:39], v15 offset:50176
    v_mfma_f32_16x16x32_bf16 v[152:155], v[56:59], a[36:39], v[152:155]
    buffer_load_dwordx4 v7, s[32:35], s52 offen offset:1024 lds
    v_mfma_f32_16x16x32_bf16 v[168:171], v[56:59], a[40:43], v[168:171]
    ds_read_b64_tr_b16 v[40:41], v14 offset:57344
    v_mfma_f32_16x16x32_bf16 v[184:187], v[56:59], a[44:47], v[184:187]
    ds_read_b64_tr_b16 v[42:43], v14 offset:58368
    v_mfma_f32_16x16x32_bf16 v[188:191], v[60:63], a[44:47], v[188:191]
    ds_read_b64_tr_b16 v[44:45], v15 offset:57344
    v_mfma_f32_16x16x32_bf16 v[172:175], v[60:63], a[40:43], v[172:175]
    ds_read_b64_tr_b16 v[46:47], v15 offset:58368
    v_mfma_f32_16x16x32_bf16 v[156:159], v[60:63], a[36:39], v[156:159]
    buffer_load_dwordx4 v8, s[32:35], s52 offen offset:2048 lds
    v_mfma_f32_16x16x32_bf16 v[140:143], v[60:63], a[32:35], v[140:143]
    s_waitcnt lgkmcnt(4)
    v_mfma_f32_16x16x32_bf16 v[64:67], v[32:35], a[48:51], v[64:67]
    ds_read_b64_tr_b16 v[48:49], v14 offset:53248
    v_mfma_f32_16x16x32_bf16 v[80:83], v[32:35], a[52:55], v[80:83]
    buffer_load_dwordx4 v9, s[32:35], s52 offen offset:3072 lds
    v_mfma_f32_16x16x32_bf16 v[96:99], v[32:35], a[56:59], v[96:99]
    ds_read_b64_tr_b16 v[50:51], v14 offset:54272
    v_mfma_f32_16x16x32_bf16 v[112:115], v[32:35], a[60:63], v[112:115]
    ds_read_b64_tr_b16 v[52:53], v15 offset:53248
    v_mfma_f32_16x16x32_bf16 v[116:119], v[36:39], a[60:63], v[116:119]
    ds_read_b64_tr_b16 v[54:55], v15 offset:54272
    s_add_u32 m0, s51, 49152
    v_mfma_f32_16x16x32_bf16 v[100:103], v[36:39], a[56:59], v[100:103]
    buffer_load_dwordx4 v4, s[28:31], s53 offen offset:2048 lds
    v_mfma_f32_16x16x32_bf16 v[84:87], v[36:39], a[52:55], v[84:87]
    ds_read_b64_tr_b16 v[56:57], v14 offset:61440
    v_mfma_f32_16x16x32_bf16 v[68:71], v[36:39], a[48:51], v[68:71]
    ds_read_b64_tr_b16 v[58:59], v14 offset:62464
    s_waitcnt lgkmcnt(5)
    v_mfma_f32_16x16x32_bf16 v[72:75], v[40:43], a[48:51], v[72:75]
    ds_read_b64_tr_b16 v[60:61], v15 offset:61440
    v_mfma_f32_16x16x32_bf16 v[88:91], v[40:43], a[52:55], v[88:91]
    buffer_load_dwordx4 v5, s[28:31], s53 offen offset:3072 lds
    v_mfma_f32_16x16x32_bf16 v[104:107], v[40:43], a[56:59], v[104:107]
    ds_read_b64_tr_b16 v[62:63], v15 offset:62464
    v_mfma_f32_16x16x32_bf16 v[120:123], v[40:43], a[60:63], v[120:123]
    v_mfma_f32_16x16x32_bf16 v[124:127], v[44:47], a[60:63], v[124:127]
    v_mfma_f32_16x16x32_bf16 v[108:111], v[44:47], a[56:59], v[108:111]
    buffer_load_dwordx4 v[196:199], v16, s[28:31], s45 offen offset:1024
    v_mfma_f32_16x16x32_bf16 v[92:95], v[44:47], a[52:55], v[92:95]
    s_waitcnt vmcnt(14) lgkmcnt(0)
    v_mfma_f32_16x16x32_bf16 v[76:79], v[44:47], a[48:51], v[76:79]
    s_barrier
    v_mfma_f32_16x16x32_bf16 v[128:131], v[48:51], a[48:51], v[128:131]
    ds_read_b128 a[64:67], v10 offset:32768
    s_add_u32 s98, s98, 1
    v_mfma_f32_16x16x32_bf16 v[144:147], v[48:51], a[52:55], v[144:147]
    ds_read_b64_tr_b16 v[32:33], v14 offset:0
    s_and_b32 s98, s98, 15
    v_mfma_f32_16x16x32_bf16 v[160:163], v[48:51], a[56:59], v[160:163]
    ds_read_b64_tr_b16 v[34:35], v14 offset:1024
    s_add_u32 m0, s50, 49152
    v_mfma_f32_16x16x32_bf16 v[176:179], v[48:51], a[60:63], v[176:179]
    ds_read_b128 a[68:71], v10 offset:34816
    s_mul_i32 s52, s98, 114688
    v_mfma_f32_16x16x32_bf16 v[180:183], v[52:55], a[60:63], v[180:183]
    buffer_load_dwordx4 v6, s[32:35], s52 offen offset:0 lds
    v_mfma_f32_16x16x32_bf16 v[164:167], v[52:55], a[56:59], v[164:167]
    ds_read_b128 a[72:75], v10 offset:36864
    v_mfma_f32_16x16x32_bf16 v[148:151], v[52:55], a[52:55], v[148:151]
    ds_read_b128 a[76:79], v10 offset:38912
    v_mfma_f32_16x16x32_bf16 v[132:135], v[52:55], a[48:51], v[132:135]
    ds_read_b64_tr_b16 v[36:37], v15 offset:0
    v_mfma_f32_16x16x32_bf16 v[136:139], v[56:59], a[48:51], v[136:139]
    ds_read_b64_tr_b16 v[38:39], v15 offset:1024
    v_mfma_f32_16x16x32_bf16 v[152:155], v[56:59], a[52:55], v[152:155]
    buffer_load_dwordx4 v7, s[32:35], s52 offen offset:1024 lds
    v_mfma_f32_16x16x32_bf16 v[168:171], v[56:59], a[56:59], v[168:171]
    ds_read_b64_tr_b16 v[40:41], v14 offset:8192
    v_mfma_f32_16x16x32_bf16 v[184:187], v[56:59], a[60:63], v[184:187]
    ds_read_b64_tr_b16 v[42:43], v14 offset:9216
    v_mfma_f32_16x16x32_bf16 v[188:191], v[60:63], a[60:63], v[188:191]
    ds_read_b64_tr_b16 v[44:45], v15 offset:8192
    v_mfma_f32_16x16x32_bf16 v[172:175], v[60:63], a[56:59], v[172:175]
    ds_read_b64_tr_b16 v[46:47], v15 offset:9216
    v_mfma_f32_16x16x32_bf16 v[156:159], v[60:63], a[52:55], v[156:159]
    buffer_load_dwordx4 v8, s[32:35], s52 offen offset:2048 lds
    v_mfma_f32_16x16x32_bf16 v[140:143], v[60:63], a[48:51], v[140:143]
    s_waitcnt lgkmcnt(4)
    v_mfma_f32_16x16x32_bf16 v[64:67], v[32:35], a[64:67], v[64:67]
    ds_read_b64_tr_b16 v[48:49], v14 offset:4096
    v_mfma_f32_16x16x32_bf16 v[80:83], v[32:35], a[68:71], v[80:83]
    buffer_load_dwordx4 v9, s[32:35], s52 offen offset:3072 lds
    v_mfma_f32_16x16x32_bf16 v[96:99], v[32:35], a[72:75], v[96:99]
    ds_read_b64_tr_b16 v[50:51], v14 offset:5120
    s_addk_i32 s53, 128
    v_mfma_f32_16x16x32_bf16 v[112:115], v[32:35], a[76:79], v[112:115]
    ds_read_b64_tr_b16 v[52:53], v15 offset:4096
    s_and_b32 s53, s53, 0x3ff
    v_mfma_f32_16x16x32_bf16 v[116:119], v[36:39], a[76:79], v[116:119]
    ds_read_b64_tr_b16 v[54:55], v15 offset:5120
    s_add_u32 m0, s51, 0
    v_mfma_f32_16x16x32_bf16 v[100:103], v[36:39], a[72:75], v[100:103]
    buffer_load_dwordx4 v2, s[28:31], s53 offen offset:0 lds
    v_mfma_f32_16x16x32_bf16 v[84:87], v[36:39], a[68:71], v[84:87]
    ds_read_b64_tr_b16 v[56:57], v14 offset:12288
    v_mfma_f32_16x16x32_bf16 v[68:71], v[36:39], a[64:67], v[68:71]
    ds_read_b64_tr_b16 v[58:59], v14 offset:13312
    s_waitcnt lgkmcnt(5)
    v_mfma_f32_16x16x32_bf16 v[72:75], v[40:43], a[64:67], v[72:75]
    ds_read_b64_tr_b16 v[60:61], v15 offset:12288
    v_mfma_f32_16x16x32_bf16 v[88:91], v[40:43], a[68:71], v[88:91]
    buffer_load_dwordx4 v3, s[28:31], s53 offen offset:1024 lds
    v_mfma_f32_16x16x32_bf16 v[104:107], v[40:43], a[72:75], v[104:107]
    ds_read_b64_tr_b16 v[62:63], v15 offset:13312
    v_mfma_f32_16x16x32_bf16 v[120:123], v[40:43], a[76:79], v[120:123]
    s_waitcnt vmcnt(13)
    v_lshlrev_b32 v216, 16, v192
    v_mfma_f32_16x16x32_bf16 v[124:127], v[44:47], a[76:79], v[124:127]
    v_and_b32 v192, 0xffff0000, v192
    v_mul_f32_e64 v192, v192, v208
    v_mfma_f32_16x16x32_bf16 v[108:111], v[44:47], a[72:75], v[108:111]
    buffer_load_dwordx4 v[200:203], v16, s[28:31], s45 offen offset:2048
    v_mfma_f32_16x16x32_bf16 v[92:95], v[44:47], a[68:71], v[92:95]
    v_fmac_f32 v192, v216, v212
    s_waitcnt lgkmcnt(0)
    v_mfma_f32_16x16x32_bf16 v[76:79], v[44:47], a[64:67], v[76:79]
    s_barrier
    v_mfma_f32_16x16x32_bf16 v[128:131], v[48:51], a[64:67], v[128:131]
    ds_read_b128 a[80:83], v11 offset:32768
    s_add_u32 s98, s98, 1
    v_mfma_f32_16x16x32_bf16 v[144:147], v[48:51], a[68:71], v[144:147]
    ds_read_b64_tr_b16 v[32:33], v14 offset:16384
    s_and_b32 s98, s98, 15
    v_mfma_f32_16x16x32_bf16 v[160:163], v[48:51], a[72:75], v[160:163]
    ds_read_b64_tr_b16 v[34:35], v14 offset:17408
    s_add_u32 m0, s50, 0
    v_mfma_f32_16x16x32_bf16 v[176:179], v[48:51], a[76:79], v[176:179]
    ds_read_b128 a[84:87], v11 offset:34816
    s_mul_i32 s52, s98, 114688
    v_mfma_f32_16x16x32_bf16 v[180:183], v[52:55], a[76:79], v[180:183]
    buffer_load_dwordx4 v6, s[32:35], s52 offen offset:0 lds
    v_mfma_f32_16x16x32_bf16 v[164:167], v[52:55], a[72:75], v[164:167]
    ds_read_b128 a[88:91], v11 offset:36864
    v_lshlrev_b32_e64 v216, 16, v193
    v_mfma_f32_16x16x32_bf16 v[148:151], v[52:55], a[68:71], v[148:151]
    ds_read_b128 a[92:95], v11 offset:38912
    v_and_b32 v193, 0xffff0000, v193
    v_mfma_f32_16x16x32_bf16 v[132:135], v[52:55], a[64:67], v[132:135]
    ds_read_b64_tr_b16 v[36:37], v15 offset:16384
    v_fmac_f32_e64 v192, v216, v213
    v_mfma_f32_16x16x32_bf16 v[136:139], v[56:59], a[64:67], v[136:139]
    ds_read_b64_tr_b16 v[38:39], v15 offset:17408
    v_fmac_f32_e64 v192, v193, v209
    v_mfma_f32_16x16x32_bf16 v[152:155], v[56:59], a[68:71], v[152:155]
    buffer_load_dwordx4 v7, s[32:35], s52 offen offset:1024 lds
    v_mfma_f32_16x16x32_bf16 v[168:171], v[56:59], a[72:75], v[168:171]
    ds_read_b64_tr_b16 v[40:41], v14 offset:24576
    v_lshlrev_b32_e64 v216, 16, v194
    v_mfma_f32_16x16x32_bf16 v[184:187], v[56:59], a[76:79], v[184:187]
    ds_read_b64_tr_b16 v[42:43], v14 offset:25600
    v_and_b32 v194, 0xffff0000, v194
    v_mfma_f32_16x16x32_bf16 v[188:191], v[60:63], a[76:79], v[188:191]
    ds_read_b64_tr_b16 v[44:45], v15 offset:24576
    v_fmac_f32_e64 v192, v216, v214
    v_mfma_f32_16x16x32_bf16 v[172:175], v[60:63], a[72:75], v[172:175]
    ds_read_b64_tr_b16 v[46:47], v15 offset:25600
    v_fmac_f32_e64 v192, v194, v210
    v_mfma_f32_16x16x32_bf16 v[156:159], v[60:63], a[68:71], v[156:159]
    buffer_load_dwordx4 v8, s[32:35], s52 offen offset:2048 lds
    v_mfma_f32_16x16x32_bf16 v[140:143], v[60:63], a[64:67], v[140:143]
    v_lshlrev_b32 v216, 16, v195
    s_waitcnt lgkmcnt(4)
    v_mfma_f32_16x16x32_bf16 v[64:67], v[32:35], a[80:83], v[64:67]
    ds_read_b64_tr_b16 v[48:49], v14 offset:20480
    v_and_b32 v195, 0xffff0000, v195
    v_mfma_f32_16x16x32_bf16 v[80:83], v[32:35], a[84:87], v[80:83]
    buffer_load_dwordx4 v9, s[32:35], s52 offen offset:3072 lds
    v_mfma_f32_16x16x32_bf16 v[96:99], v[32:35], a[88:91], v[96:99]
    ds_read_b64_tr_b16 v[50:51], v14 offset:21504
    v_fmac_f32_e64 v192, v216, v215
    v_mfma_f32_16x16x32_bf16 v[112:115], v[32:35], a[92:95], v[112:115]
    ds_read_b64_tr_b16 v[52:53], v15 offset:20480
    v_fmac_f32_e64 v192, v195, v211
    v_mfma_f32_16x16x32_bf16 v[116:119], v[36:39], a[92:95], v[116:119]
    ds_read_b64_tr_b16 v[54:55], v15 offset:21504
    s_add_u32 m0, s51, 0
    v_mfma_f32_16x16x32_bf16 v[100:103], v[36:39], a[88:91], v[100:103]
    buffer_load_dwordx4 v4, s[28:31], s53 offen offset:2048 lds
    v_mfma_f32_16x16x32_bf16 v[84:87], v[36:39], a[84:87], v[84:87]
    ds_read_b64_tr_b16 v[56:57], v14 offset:28672
    v_mfma_f32_16x16x32_bf16 v[68:71], v[36:39], a[80:83], v[68:71]
    ds_read_b64_tr_b16 v[58:59], v14 offset:29696
    s_waitcnt lgkmcnt(5)
    v_mfma_f32_16x16x32_bf16 v[72:75], v[40:43], a[80:83], v[72:75]
    ds_read_b64_tr_b16 v[60:61], v15 offset:28672
    v_mfma_f32_16x16x32_bf16 v[88:91], v[40:43], a[84:87], v[88:91]
    buffer_load_dwordx4 v5, s[28:31], s53 offen offset:3072 lds
    v_mfma_f32_16x16x32_bf16 v[104:107], v[40:43], a[88:91], v[104:107]
    ds_read_b64_tr_b16 v[62:63], v15 offset:29696
    v_mfma_f32_16x16x32_bf16 v[120:123], v[40:43], a[92:95], v[120:123]
    s_waitcnt vmcnt(13)
    v_lshlrev_b32 v216, 16, v196
    v_mfma_f32_16x16x32_bf16 v[124:127], v[44:47], a[92:95], v[124:127]
    v_and_b32 v196, 0xffff0000, v196
    v_mul_f32_e64 v196, v196, v208
    v_mfma_f32_16x16x32_bf16 v[108:111], v[44:47], a[88:91], v[108:111]
    buffer_load_dwordx4 v[204:207], v16, s[28:31], s45 offen offset:3072
    v_mfma_f32_16x16x32_bf16 v[92:95], v[44:47], a[84:87], v[92:95]
    v_fmac_f32 v196, v216, v212
    s_waitcnt lgkmcnt(0)
    v_mfma_f32_16x16x32_bf16 v[76:79], v[44:47], a[80:83], v[76:79]
    s_barrier
    v_mfma_f32_16x16x32_bf16 v[128:131], v[48:51], a[80:83], v[128:131]
    ds_read_b128 a[96:99], v10 offset:49152
    s_add_u32 s98, s98, 1
    v_mfma_f32_16x16x32_bf16 v[144:147], v[48:51], a[84:87], v[144:147]
    ds_read_b64_tr_b16 v[32:33], v14 offset:32768
    s_and_b32 s98, s98, 15
    v_mfma_f32_16x16x32_bf16 v[160:163], v[48:51], a[88:91], v[160:163]
    ds_read_b64_tr_b16 v[34:35], v14 offset:33792
    s_add_u32 m0, s50, 16384
    v_mfma_f32_16x16x32_bf16 v[176:179], v[48:51], a[92:95], v[176:179]
    ds_read_b128 a[100:103], v10 offset:51200
    s_mul_i32 s52, s98, 114688
    v_mfma_f32_16x16x32_bf16 v[180:183], v[52:55], a[92:95], v[180:183]
    buffer_load_dwordx4 v6, s[32:35], s52 offen offset:0 lds
    v_mfma_f32_16x16x32_bf16 v[164:167], v[52:55], a[88:91], v[164:167]
    ds_read_b128 a[104:107], v10 offset:53248
    v_lshlrev_b32 v216, 16, v197
    v_mfma_f32_16x16x32_bf16 v[148:151], v[52:55], a[84:87], v[148:151]
    ds_read_b128 a[108:111], v10 offset:55296
    v_and_b32 v197, 0xffff0000, v197
    v_mfma_f32_16x16x32_bf16 v[132:135], v[52:55], a[80:83], v[132:135]
    ds_read_b64_tr_b16 v[36:37], v15 offset:32768
    v_fmac_f32_e64 v196, v216, v213
    v_mfma_f32_16x16x32_bf16 v[136:139], v[56:59], a[80:83], v[136:139]
    ds_read_b64_tr_b16 v[38:39], v15 offset:33792
    v_fmac_f32_e64 v196, v197, v209
    v_mfma_f32_16x16x32_bf16 v[152:155], v[56:59], a[84:87], v[152:155]
    buffer_load_dwordx4 v7, s[32:35], s52 offen offset:1024 lds
    v_mfma_f32_16x16x32_bf16 v[168:171], v[56:59], a[88:91], v[168:171]
    ds_read_b64_tr_b16 v[40:41], v14 offset:40960
    v_lshlrev_b32_e64 v216, 16, v198
    v_mfma_f32_16x16x32_bf16 v[184:187], v[56:59], a[92:95], v[184:187]
    ds_read_b64_tr_b16 v[42:43], v14 offset:41984
    v_and_b32 v198, 0xffff0000, v198
    v_mfma_f32_16x16x32_bf16 v[188:191], v[60:63], a[92:95], v[188:191]
    ds_read_b64_tr_b16 v[44:45], v15 offset:40960
    v_fmac_f32_e64 v196, v216, v214
    v_mfma_f32_16x16x32_bf16 v[172:175], v[60:63], a[88:91], v[172:175]
    ds_read_b64_tr_b16 v[46:47], v15 offset:41984
    v_fmac_f32_e64 v196, v198, v210
    v_mfma_f32_16x16x32_bf16 v[156:159], v[60:63], a[84:87], v[156:159]
    buffer_load_dwordx4 v8, s[32:35], s52 offen offset:2048 lds
    v_mfma_f32_16x16x32_bf16 v[140:143], v[60:63], a[80:83], v[140:143]
    v_lshlrev_b32 v216, 16, v199
    s_waitcnt lgkmcnt(4)
    v_mfma_f32_16x16x32_bf16 v[64:67], v[32:35], a[96:99], v[64:67]
    ds_read_b64_tr_b16 v[48:49], v14 offset:36864
    v_and_b32 v199, 0xffff0000, v199
    v_mfma_f32_16x16x32_bf16 v[80:83], v[32:35], a[100:103], v[80:83]
    buffer_load_dwordx4 v9, s[32:35], s52 offen offset:3072 lds
    v_mfma_f32_16x16x32_bf16 v[96:99], v[32:35], a[104:107], v[96:99]
    ds_read_b64_tr_b16 v[50:51], v14 offset:37888
    s_addk_i32 s53, 128
    v_mfma_f32_16x16x32_bf16 v[112:115], v[32:35], a[108:111], v[112:115]
    ds_read_b64_tr_b16 v[52:53], v15 offset:36864
    s_and_b32 s53, s53, 0x3ff
    v_mfma_f32_16x16x32_bf16 v[116:119], v[36:39], a[108:111], v[116:119]
    ds_read_b64_tr_b16 v[54:55], v15 offset:37888
    s_add_u32 m0, s51, 16384
    v_mfma_f32_16x16x32_bf16 v[100:103], v[36:39], a[104:107], v[100:103]
    buffer_load_dwordx4 v2, s[28:31], s53 offen offset:0 lds
    v_mfma_f32_16x16x32_bf16 v[84:87], v[36:39], a[100:103], v[84:87]
    ds_read_b64_tr_b16 v[56:57], v14 offset:45056
    v_fmac_f32 v196, v216, v215
    v_mfma_f32_16x16x32_bf16 v[68:71], v[36:39], a[96:99], v[68:71]
    ds_read_b64_tr_b16 v[58:59], v14 offset:46080
    s_waitcnt lgkmcnt(5)
    v_mfma_f32_16x16x32_bf16 v[72:75], v[40:43], a[96:99], v[72:75]
    ds_read_b64_tr_b16 v[60:61], v15 offset:45056
    v_fmac_f32 v196, v199, v211
    v_mfma_f32_16x16x32_bf16 v[88:91], v[40:43], a[100:103], v[88:91]
    buffer_load_dwordx4 v3, s[28:31], s53 offen offset:1024 lds
    v_mfma_f32_16x16x32_bf16 v[104:107], v[40:43], a[104:107], v[104:107]
    ds_read_b64_tr_b16 v[62:63], v15 offset:46080
    v_mfma_f32_16x16x32_bf16 v[120:123], v[40:43], a[108:111], v[120:123]
    s_waitcnt vmcnt(13)
    v_lshlrev_b32 v216, 16, v200
    v_mfma_f32_16x16x32_bf16 v[124:127], v[44:47], a[108:111], v[124:127]
    v_and_b32 v200, 0xffff0000, v200
    v_mul_f32_e64 v200, v200, v208
    v_mfma_f32_16x16x32_bf16 v[108:111], v[44:47], a[104:107], v[108:111]
    buffer_load_dword v19, v1, s[72:75], 0 offen offset:0 sc1
    v_mfma_f32_16x16x32_bf16 v[92:95], v[44:47], a[100:103], v[92:95]
    v_fmac_f32 v200, v216, v212
    s_waitcnt lgkmcnt(0)
    v_mfma_f32_16x16x32_bf16 v[76:79], v[44:47], a[96:99], v[76:79]
    s_barrier
    v_mfma_f32_16x16x32_bf16 v[128:131], v[48:51], a[96:99], v[128:131]
    ds_read_b128 a[112:115], v11 offset:49152
    s_add_u32 s98, s98, 1
    v_mfma_f32_16x16x32_bf16 v[144:147], v[48:51], a[100:103], v[144:147]
    ds_read_b64_tr_b16 v[32:33], v14 offset:49152
    s_and_b32 s98, s98, 15
    v_mfma_f32_16x16x32_bf16 v[160:163], v[48:51], a[104:107], v[160:163]
    ds_read_b64_tr_b16 v[34:35], v14 offset:50176
    s_add_u32 m0, s50, 32768
    v_mfma_f32_16x16x32_bf16 v[176:179], v[48:51], a[108:111], v[176:179]
    ds_read_b128 a[116:119], v11 offset:51200
    s_mul_i32 s52, s98, 114688
    v_mfma_f32_16x16x32_bf16 v[180:183], v[52:55], a[108:111], v[180:183]
    buffer_load_dwordx4 v6, s[32:35], s52 offen offset:0 lds
    v_mfma_f32_16x16x32_bf16 v[164:167], v[52:55], a[104:107], v[164:167]
    ds_read_b128 a[120:123], v11 offset:53248
    v_lshlrev_b32 v216, 16, v201
    v_mfma_f32_16x16x32_bf16 v[148:151], v[52:55], a[100:103], v[148:151]
L_qmain_s1:
    s_cbranch_execz L_qmain_s5
    ds_read_b128 a[124:127], v11 offset:55296
    v_and_b32 v201, 0xffff0000, v201
    v_mfma_f32_16x16x32_bf16 v[132:135], v[52:55], a[96:99], v[132:135]
    ds_read_b64_tr_b16 v[36:37], v15 offset:49152
    v_fmac_f32 v200, v216, v213
    v_mfma_f32_16x16x32_bf16 v[136:139], v[56:59], a[96:99], v[136:139]
    ds_read_b64_tr_b16 v[38:39], v15 offset:50176
    v_fmac_f32_e64 v200, v201, v209
    v_mfma_f32_16x16x32_bf16 v[152:155], v[56:59], a[100:103], v[152:155]
    buffer_load_dwordx4 v7, s[32:35], s52 offen offset:1024 lds
    v_mfma_f32_16x16x32_bf16 v[168:171], v[56:59], a[104:107], v[168:171]
    ds_read_b64_tr_b16 v[40:41], v14 offset:57344
    v_lshlrev_b32_e64 v216, 16, v202
    v_mfma_f32_16x16x32_bf16 v[184:187], v[56:59], a[108:111], v[184:187]
    ds_read_b64_tr_b16 v[42:43], v14 offset:58368
    v_and_b32 v202, 0xffff0000, v202
    v_mfma_f32_16x16x32_bf16 v[188:191], v[60:63], a[108:111], v[188:191]
    ds_read_b64_tr_b16 v[44:45], v15 offset:57344
    v_fmac_f32_e64 v200, v216, v214
    v_mfma_f32_16x16x32_bf16 v[172:175], v[60:63], a[104:107], v[172:175]
    ds_read_b64_tr_b16 v[46:47], v15 offset:58368
    v_fmac_f32_e64 v200, v202, v210
    v_mfma_f32_16x16x32_bf16 v[156:159], v[60:63], a[100:103], v[156:159]
    buffer_load_dwordx4 v8, s[32:35], s52 offen offset:2048 lds
    v_mfma_f32_16x16x32_bf16 v[140:143], v[60:63], a[96:99], v[140:143]
    v_lshlrev_b32 v216, 16, v203
    s_waitcnt lgkmcnt(4)
    v_mfma_f32_16x16x32_bf16 v[64:67], v[32:35], a[112:115], v[64:67]
    ds_read_b64_tr_b16 v[48:49], v14 offset:53248
    v_and_b32 v203, 0xffff0000, v203
    v_mfma_f32_16x16x32_bf16 v[80:83], v[32:35], a[116:119], v[80:83]
    buffer_load_dwordx4 v9, s[32:35], s52 offen offset:3072 lds
    v_mfma_f32_16x16x32_bf16 v[96:99], v[32:35], a[120:123], v[96:99]
    ds_read_b64_tr_b16 v[50:51], v14 offset:54272
    v_fmac_f32_e64 v200, v216, v215
    v_mfma_f32_16x16x32_bf16 v[112:115], v[32:35], a[124:127], v[112:115]
    ds_read_b64_tr_b16 v[52:53], v15 offset:53248
    v_fmac_f32_e64 v200, v203, v211
    v_mfma_f32_16x16x32_bf16 v[116:119], v[36:39], a[124:127], v[116:119]
    ds_read_b64_tr_b16 v[54:55], v15 offset:54272
    v_mfma_f32_16x16x32_bf16 v[100:103], v[36:39], a[120:123], v[100:103]
    ds_read_b64_tr_b16 v[56:57], v14 offset:61440
    s_add_u32 m0, s51, 16384
    v_mfma_f32_16x16x32_bf16 v[84:87], v[36:39], a[116:119], v[84:87]
    buffer_load_dwordx4 v4, s[28:31], s53 offen offset:2048 lds
    v_mfma_f32_16x16x32_bf16 v[68:71], v[36:39], a[112:115], v[68:71]
    ds_read_b64_tr_b16 v[58:59], v14 offset:62464
    s_waitcnt lgkmcnt(5)
    v_mfma_f32_16x16x32_bf16 v[72:75], v[40:43], a[112:115], v[72:75]
    ds_read_b64_tr_b16 v[60:61], v15 offset:61440
    v_mfma_f32_16x16x32_bf16 v[88:91], v[40:43], a[116:119], v[88:91]
    ds_read_b64_tr_b16 v[62:63], v15 offset:62464
    v_mfma_f32_16x16x32_bf16 v[104:107], v[40:43], a[120:123], v[104:107]
    s_waitcnt vmcnt(12)
    v_lshlrev_b32_e64 v216, 16, v204
    v_mfma_f32_16x16x32_bf16 v[120:123], v[40:43], a[124:127], v[120:123]
    buffer_load_dwordx4 v5, s[28:31], s53 offen offset:3072 lds
    v_mfma_f32_16x16x32_bf16 v[124:127], v[44:47], a[124:127], v[124:127]
    v_and_b32 v204, 0xffff0000, v204
    v_mul_f32_e64 v204, v204, v208
    v_mfma_f32_16x16x32_bf16 v[108:111], v[44:47], a[120:123], v[108:111]
    v_fmac_f32 v204, v216, v212
    v_lshlrev_b32 v216, 16, v205
    v_mfma_f32_16x16x32_bf16 v[92:95], v[44:47], a[116:119], v[92:95]
    v_and_b32 v205, 0xffff0000, v205
    s_waitcnt lgkmcnt(0)
    v_mfma_f32_16x16x32_bf16 v[76:79], v[44:47], a[112:115], v[76:79]
    s_barrier
    v_mfma_f32_16x16x32_bf16 v[128:131], v[48:51], a[112:115], v[128:131]
    ds_read_b128 a[128:131], v10 offset:0
    s_add_u32 s98, s98, 1
    v_mfma_f32_16x16x32_bf16 v[144:147], v[48:51], a[116:119], v[144:147]
    ds_read_b64_tr_b16 v[32:33], v14 offset:0
    s_and_b32 s98, s98, 15
    v_mfma_f32_16x16x32_bf16 v[160:163], v[48:51], a[120:123], v[160:163]
    ds_read_b64_tr_b16 v[34:35], v14 offset:1024
    s_add_u32 m0, s50, 49152
    v_mfma_f32_16x16x32_bf16 v[176:179], v[48:51], a[124:127], v[176:179]
    ds_read_b128 a[132:135], v10 offset:2048
    s_mul_i32 s52, s98, 114688
    v_mfma_f32_16x16x32_bf16 v[180:183], v[52:55], a[124:127], v[180:183]
    buffer_load_dwordx4 v6, s[32:35], s52 offen offset:0 lds
    v_mfma_f32_16x16x32_bf16 v[164:167], v[52:55], a[120:123], v[164:167]
    ds_read_b128 a[136:139], v10 offset:4096
    v_fmac_f32_e64 v204, v216, v213
    v_mfma_f32_16x16x32_bf16 v[148:151], v[52:55], a[116:119], v[148:151]
    ds_read_b128 a[140:143], v10 offset:6144
    v_fmac_f32_e64 v204, v205, v209
    v_mfma_f32_16x16x32_bf16 v[132:135], v[52:55], a[112:115], v[132:135]
    ds_read_b64_tr_b16 v[36:37], v15 offset:0
    v_lshlrev_b32_e64 v216, 16, v206
    v_mfma_f32_16x16x32_bf16 v[136:139], v[56:59], a[112:115], v[136:139]
    ds_read_b64_tr_b16 v[38:39], v15 offset:1024
    v_and_b32 v206, 0xffff0000, v206
    v_mfma_f32_16x16x32_bf16 v[152:155], v[56:59], a[116:119], v[152:155]
    buffer_load_dwordx4 v7, s[32:35], s52 offen offset:1024 lds
    v_mfma_f32_16x16x32_bf16 v[168:171], v[56:59], a[120:123], v[168:171]
    ds_read_b64_tr_b16 v[40:41], v14 offset:8192
    v_fmac_f32_e64 v204, v216, v214
    v_mfma_f32_16x16x32_bf16 v[184:187], v[56:59], a[124:127], v[184:187]
    ds_read_b64_tr_b16 v[42:43], v14 offset:9216
    v_fmac_f32_e64 v204, v206, v210
    v_mfma_f32_16x16x32_bf16 v[188:191], v[60:63], a[124:127], v[188:191]
    ds_read_b64_tr_b16 v[44:45], v15 offset:8192
    v_lshlrev_b32_e64 v216, 16, v207
    v_mfma_f32_16x16x32_bf16 v[172:175], v[60:63], a[120:123], v[172:175]
    ds_read_b64_tr_b16 v[46:47], v15 offset:9216
    v_and_b32 v207, 0xffff0000, v207
    v_mfma_f32_16x16x32_bf16 v[156:159], v[60:63], a[116:119], v[156:159]
    buffer_load_dwordx4 v8, s[32:35], s52 offen offset:2048 lds
    v_mfma_f32_16x16x32_bf16 v[140:143], v[60:63], a[112:115], v[140:143]
    v_fmac_f32 v204, v216, v215
    s_waitcnt lgkmcnt(4)
    v_mfma_f32_16x16x32_bf16 v[64:67], v[32:35], a[128:131], v[64:67]
    ds_read_b64_tr_b16 v[48:49], v14 offset:4096
    v_fmac_f32_e64 v204, v207, v211
    v_mfma_f32_16x16x32_bf16 v[80:83], v[32:35], a[132:135], v[80:83]
    buffer_load_dwordx4 v9, s[32:35], s52 offen offset:3072 lds
    v_mfma_f32_16x16x32_bf16 v[96:99], v[32:35], a[136:139], v[96:99]
    ds_read_b64_tr_b16 v[50:51], v14 offset:5120
    v_cmp_eq_u32_e64 vcc, 0, v0
    v_mfma_f32_16x16x32_bf16 v[112:115], v[32:35], a[140:143], v[112:115]
    ds_read_b64_tr_b16 v[52:53], v15 offset:4096
    s_addk_i32 s53, 128
    v_mfma_f32_16x16x32_bf16 v[116:119], v[36:39], a[140:143], v[116:119]
    ds_read_b64_tr_b16 v[54:55], v15 offset:5120
    s_and_b32 s53, s53, 0x3ff
    v_mfma_f32_16x16x32_bf16 v[100:103], v[36:39], a[136:139], v[100:103]
    ds_read_b64_tr_b16 v[56:57], v14 offset:12288
    s_add_u32 m0, s51, 32768
    v_mfma_f32_16x16x32_bf16 v[84:87], v[36:39], a[132:135], v[84:87]
    buffer_load_dwordx4 v2, s[28:31], s53 offen offset:0 lds
    v_mfma_f32_16x16x32_bf16 v[68:71], v[36:39], a[128:131], v[68:71]
    ds_read_b64_tr_b16 v[58:59], v14 offset:13312
    s_waitcnt lgkmcnt(5)
    v_mfma_f32_16x16x32_bf16 v[72:75], v[40:43], a[128:131], v[72:75]
    ds_read_b64_tr_b16 v[60:61], v15 offset:12288
    v_permlane32_swap_b32 v192, v196
    v_mfma_f32_16x16x32_bf16 v[88:91], v[40:43], a[132:135], v[88:91]
    ds_read_b64_tr_b16 v[62:63], v15 offset:13312
    v_mov_b32 v197, 0x7ffffff0
    v_mfma_f32_16x16x32_bf16 v[104:107], v[40:43], a[136:139], v[104:107]
    v_permlane32_swap_b32 v200, v204
    v_add_f32_e64 v192, v192, v196
    v_mfma_f32_16x16x32_bf16 v[120:123], v[40:43], a[140:143], v[120:123]
    buffer_load_dwordx4 v3, s[28:31], s53 offen offset:1024 lds
    v_mfma_f32_16x16x32_bf16 v[124:127], v[44:47], a[140:143], v[124:127]
    s_waitcnt vmcnt(12)
    v_cmp_ne_u32 s[92:93], 0, v19
    s_nop 0
    s_cmp_eq_u64 s[92:93], -1
    s_cbranch_scc0 L_sp1
L_ok1:
    v_lshrrev_b32 v1, 2, v0
    v_lshlrev_b32 v1, 7, v1
    v_mfma_f32_16x16x32_bf16 v[108:111], v[44:47], a[136:139], v[108:111]
    v_add_f32_e64 v200, v200, v204
    v_cndmask_b32_e64 v197, v197, 0, vcc
    v_mfma_f32_16x16x32_bf16 v[92:95], v[44:47], a[132:135], v[92:95]
    v_permlane16_swap_b32 v192, v200
    s_waitcnt lgkmcnt(0)
    v_mfma_f32_16x16x32_bf16 v[76:79], v[44:47], a[128:131], v[76:79]
    s_barrier
    v_mfma_f32_16x16x32_bf16 v[128:131], v[48:51], a[128:131], v[128:131]
    ds_read_b128 a[144:147], v11 offset:0
    s_add_u32 s98, s98, 1
    v_mfma_f32_16x16x32_bf16 v[144:147], v[48:51], a[132:135], v[144:147]
    ds_read_b64_tr_b16 v[32:33], v14 offset:16384
    s_and_b32 s98, s98, 15
    v_mfma_f32_16x16x32_bf16 v[160:163], v[48:51], a[136:139], v[160:163]
    ds_read_b64_tr_b16 v[34:35], v14 offset:17408
    s_add_u32 m0, s50, 0
    v_mfma_f32_16x16x32_bf16 v[176:179], v[48:51], a[140:143], v[176:179]
    ds_read_b128 a[148:151], v11 offset:2048
    s_mul_i32 s52, s98, 114688
    v_mfma_f32_16x16x32_bf16 v[180:183], v[52:55], a[140:143], v[180:183]
    buffer_load_dwordx4 v6, s[32:35], s52 offen offset:0 lds
    v_mfma_f32_16x16x32_bf16 v[164:167], v[52:55], a[136:139], v[164:167]
    ds_read_b128 a[152:155], v11 offset:4096
    v_add_f32_e64 v192, v192, v200
    v_mfma_f32_16x16x32_bf16 v[148:151], v[52:55], a[132:135], v[148:151]
    ds_read_b128 a[156:159], v11 offset:6144
    v_add_f32_dpp v192, v192, v192 row_ror:8 row_mask:0xf bank_mask:0xf
    v_mfma_f32_16x16x32_bf16 v[132:135], v[52:55], a[128:131], v[132:135]
    ds_read_b64_tr_b16 v[36:37], v15 offset:16384
    v_add_f32_dpp v192, v192, v192 row_ror:4 row_mask:0xf bank_mask:0xf
    v_mfma_f32_16x16x32_bf16 v[136:139], v[56:59], a[128:131], v[136:139]
    ds_read_b64_tr_b16 v[38:39], v15 offset:17408
    v_add_f32_dpp v192, v192, v192 row_ror:2 row_mask:0xf bank_mask:0xf
    v_mfma_f32_16x16x32_bf16 v[152:155], v[56:59], a[132:135], v[152:155]
    buffer_load_dwordx4 v7, s[32:35], s52 offen offset:1024 lds
    v_mfma_f32_16x16x32_bf16 v[168:171], v[56:59], a[136:139], v[168:171]
    ds_read_b64_tr_b16 v[40:41], v14 offset:24576
    v_add_f32_dpp v192, v192, v192 row_ror:1 row_mask:0xf bank_mask:0xf
    v_mfma_f32_16x16x32_bf16 v[184:187], v[56:59], a[140:143], v[184:187]
    ds_read_b64_tr_b16 v[42:43], v14 offset:25600
    v_mul_f32 v192, 0x3fb8aa3b, v192
    v_mfma_f32_16x16x32_bf16 v[188:191], v[60:63], a[140:143], v[188:191]
    ds_read_b64_tr_b16 v[44:45], v15 offset:24576
    v_or_b32_e64 v192, 1, v192
    v_mfma_f32_16x16x32_bf16 v[172:175], v[60:63], a[136:139], v[172:175]
    ds_read_b64_tr_b16 v[46:47], v15 offset:25600
    v_mov_b32_e64 v194, v192
    v_mfma_f32_16x16x32_bf16 v[156:159], v[60:63], a[132:135], v[156:159]
    buffer_load_dwordx4 v8, s[32:35], s52 offen offset:2048 lds
    v_mfma_f32_16x16x32_bf16 v[140:143], v[60:63], a[128:131], v[140:143]
    v_permlane16_swap_b32 v192, v194
    s_waitcnt lgkmcnt(4)
    v_mfma_f32_16x16x32_bf16 v[64:67], v[32:35], a[144:147], v[64:67]
    ds_read_b64_tr_b16 v[48:49], v14 offset:20480
    v_mov_b32_e64 v193, v192
    v_mfma_f32_16x16x32_bf16 v[80:83], v[32:35], a[148:151], v[80:83]
    buffer_load_dwordx4 v9, s[32:35], s52 offen offset:3072 lds
    v_mfma_f32_16x16x32_bf16 v[96:99], v[32:35], a[152:155], v[96:99]
    ds_read_b64_tr_b16 v[50:51], v14 offset:21504
    v_mov_b32_e64 v195, v194
    v_mfma_f32_16x16x32_bf16 v[112:115], v[32:35], a[156:159], v[112:115]
    ds_read_b64_tr_b16 v[52:53], v15 offset:20480
    v_permlane32_swap_b32 v192, v193
    v_mfma_f32_16x16x32_bf16 v[116:119], v[36:39], a[156:159], v[116:119]
    ds_read_b64_tr_b16 v[54:55], v15 offset:21504
    v_permlane32_swap_b32 v194, v195
    v_mfma_f32_16x16x32_bf16 v[100:103], v[36:39], a[152:155], v[100:103]
    ds_read_b64_tr_b16 v[56:57], v14 offset:28672
    s_add_u32 m0, s51, 32768
    v_mfma_f32_16x16x32_bf16 v[84:87], v[36:39], a[148:151], v[84:87]
    buffer_load_dwordx4 v4, s[28:31], s53 offen offset:2048 lds
    v_mfma_f32_16x16x32_bf16 v[68:71], v[36:39], a[144:147], v[68:71]
    ds_read_b64_tr_b16 v[58:59], v14 offset:29696
    s_waitcnt lgkmcnt(5)
    v_mfma_f32_16x16x32_bf16 v[72:75], v[40:43], a[144:147], v[72:75]
    ds_read_b64_tr_b16 v[60:61], v15 offset:28672
    v_mfma_f32_16x16x32_bf16 v[88:91], v[40:43], a[148:151], v[88:91]
    ds_read_b64_tr_b16 v[62:63], v15 offset:29696
    v_mfma_f32_16x16x32_bf16 v[104:107], v[40:43], a[152:155], v[104:107]
    v_mfma_f32_16x16x32_bf16 v[120:123], v[40:43], a[156:159], v[120:123]
    buffer_load_dwordx4 v5, s[28:31], s53 offen offset:3072 lds
    v_mfma_f32_16x16x32_bf16 v[124:127], v[44:47], a[156:159], v[124:127]
    v_mfma_f32_16x16x32_bf16 v[108:111], v[44:47], a[152:155], v[108:111]
    v_mfma_f32_16x16x32_bf16 v[92:95], v[44:47], a[148:151], v[92:95]
    s_waitcnt vmcnt(12) lgkmcnt(0)
    v_mfma_f32_16x16x32_bf16 v[76:79], v[44:47], a[144:147], v[76:79]
    s_barrier
    v_mfma_f32_16x16x32_bf16 v[128:131], v[48:51], a[144:147], v[128:131]
    ds_read_b128 a[160:163], v10 offset:16384
    s_lshl_b32 s45, s3, 4
    v_mfma_f32_16x16x32_bf16 v[144:147], v[48:51], a[148:151], v[144:147]
    ds_read_b64_tr_b16 v[32:33], v14 offset:32768
    s_add_u32 s45, s45, 0x54000
    v_mfma_f32_16x16x32_bf16 v[160:163], v[48:51], a[152:155], v[160:163]
    buffer_store_dwordx4 v[192:195], v197, s[36:39], s45 offen sc1
    v_mfma_f32_16x16x32_bf16 v[176:179], v[48:51], a[156:159], v[176:179]
    ds_read_b64_tr_b16 v[34:35], v14 offset:33792
    s_add_u32 s98, s98, 1
    v_mfma_f32_16x16x32_bf16 v[180:183], v[52:55], a[156:159], v[180:183]
    ds_read_b128 a[164:167], v10 offset:18432
    s_and_b32 s98, s98, 15
    v_mfma_f32_16x16x32_bf16 v[164:167], v[52:55], a[152:155], v[164:167]
    ds_read_b128 a[168:171], v10 offset:20480
    s_add_u32 m0, s50, 16384
    v_mfma_f32_16x16x32_bf16 v[148:151], v[52:55], a[148:151], v[148:151]
    ds_read_b128 a[172:175], v10 offset:22528
    s_mul_i32 s52, s98, 114688
    v_mfma_f32_16x16x32_bf16 v[132:135], v[52:55], a[144:147], v[132:135]
    buffer_load_dwordx4 v6, s[32:35], s52 offen offset:0 lds
    v_mfma_f32_16x16x32_bf16 v[136:139], v[56:59], a[144:147], v[136:139]
    ds_read_b64_tr_b16 v[36:37], v15 offset:32768
    v_mfma_f32_16x16x32_bf16 v[152:155], v[56:59], a[148:151], v[152:155]
    ds_read_b64_tr_b16 v[38:39], v15 offset:33792
    v_mfma_f32_16x16x32_bf16 v[168:171], v[56:59], a[152:155], v[168:171]
    ds_read_b64_tr_b16 v[40:41], v14 offset:40960
    v_mfma_f32_16x16x32_bf16 v[184:187], v[56:59], a[156:159], v[184:187]
    ds_read_b64_tr_b16 v[42:43], v14 offset:41984
    v_mfma_f32_16x16x32_bf16 v[188:191], v[60:63], a[156:159], v[188:191]
    buffer_load_dwordx4 v7, s[32:35], s52 offen offset:1024 lds
    v_mfma_f32_16x16x32_bf16 v[172:175], v[60:63], a[152:155], v[172:175]
    ds_read_b64_tr_b16 v[44:45], v15 offset:40960
    v_mfma_f32_16x16x32_bf16 v[156:159], v[60:63], a[148:151], v[156:159]
    ds_read_b64_tr_b16 v[46:47], v15 offset:41984
    v_mfma_f32_16x16x32_bf16 v[140:143], v[60:63], a[144:147], v[140:143]
    s_waitcnt lgkmcnt(5)
    v_mfma_f32_16x16x32_bf16 v[64:67], v[32:35], a[160:163], v[64:67]
    ds_read_b64_tr_b16 v[48:49], v14 offset:36864
    v_and_b32 v218, 15, v0
    v_mfma_f32_16x16x32_bf16 v[80:83], v[32:35], a[164:167], v[80:83]
    buffer_load_dwordx4 v8, s[32:35], s52 offen offset:2048 lds
    v_mfma_f32_16x16x32_bf16 v[96:99], v[32:35], a[168:171], v[96:99]
    ds_read_b64_tr_b16 v[50:51], v14 offset:37888
    v_cmp_eq_u32_e64 vcc, 0, v218
    v_mfma_f32_16x16x32_bf16 v[112:115], v[32:35], a[172:175], v[112:115]
    ds_read_b64_tr_b16 v[52:53], v15 offset:36864
    s_waitcnt lgkmcnt(5)
    v_mfma_f32_16x16x32_bf16 v[116:119], v[36:39], a[172:175], v[116:119]
    ds_read_b64_tr_b16 v[54:55], v15 offset:37888
    v_bfe_u32 v218, v0, 4, 1
    v_mfma_f32_16x16x32_bf16 v[100:103], v[36:39], a[168:171], v[100:103]
    buffer_load_dwordx4 v9, s[32:35], s52 offen offset:3072 lds
    v_mfma_f32_16x16x32_bf16 v[84:87], v[36:39], a[164:167], v[84:87]
    ds_read_b64_tr_b16 v[56:57], v14 offset:45056
    s_addk_i32 s53, 128
    v_mfma_f32_16x16x32_bf16 v[68:71], v[36:39], a[160:163], v[68:71]
    ds_read_b64_tr_b16 v[58:59], v14 offset:46080
    s_and_b32 s53, s53, 0x3ff
    v_mfma_f32_16x16x32_bf16 v[72:75], v[40:43], a[160:163], v[72:75]
    ds_read_b64_tr_b16 v[60:61], v15 offset:45056
    s_add_u32 m0, s51, 49152
    v_mfma_f32_16x16x32_bf16 v[88:91], v[40:43], a[164:167], v[88:91]
    buffer_load_dwordx4 v2, s[28:31], s53 offen offset:0 lds
    v_mfma_f32_16x16x32_bf16 v[104:107], v[40:43], a[168:171], v[104:107]
    ds_read_b64_tr_b16 v[62:63], v15 offset:46080
    v_lshrrev_b32_e64 v17, 5, v0
    v_mfma_f32_16x16x32_bf16 v[120:123], v[40:43], a[172:175], v[120:123]
    v_lshl_add_u32 v218, v218, 1, v17
    s_waitcnt lgkmcnt(4)
    v_mfma_f32_16x16x32_bf16 v[124:127], v[44:47], a[172:175], v[124:127]
    v_lshlrev_b32 v218, 4, v218
    v_mov_b32 v17, 0x7ffffff0
    v_mfma_f32_16x16x32_bf16 v[108:111], v[44:47], a[168:171], v[108:111]
    buffer_load_dwordx4 v3, s[28:31], s53 offen offset:1024 lds
    v_mfma_f32_16x16x32_bf16 v[92:95], v[44:47], a[164:167], v[92:95]
    s_add_u32 s84, s100, 0
    s_and_b32 s84, s84, 229376
    s_add_u32 m0, s50, 131072
    s_xor_b32 s84, s84, s4
    s_waitcnt vmcnt(15) lgkmcnt(0)
    v_mfma_f32_16x16x32_bf16 v[76:79], v[44:47], a[160:163], v[76:79]
    s_barrier
    v_mfma_f32_16x16x32_bf16 v[128:131], v[48:51], a[160:163], v[128:131]
    ds_read_b128 a[176:179], v11 offset:16384
    v_cndmask_b32_e64 v17, v17, v218, vcc
    v_mfma_f32_16x16x32_bf16 v[144:147], v[48:51], a[164:167], v[144:147]
    buffer_load_dwordx4 v20, s[56:59], s84 offen offset:0 lds
    v_mfma_f32_16x16x32_bf16 v[160:163], v[48:51], a[168:171], v[160:163]
    ds_read_b64_tr_b16 v[32:33], v14 offset:49152
    s_add_u32 s98, s98, 1
    s_and_b32 s98, s98, 15
    v_mfma_f32_16x16x32_bf16 v[176:179], v[48:51], a[172:175], v[176:179]
    ds_read_b64_tr_b16 v[34:35], v14 offset:50176
    s_add_u32 m0, s50, 32768
    v_mfma_f32_16x16x32_bf16 v[180:183], v[52:55], a[172:175], v[180:183]
    ds_read_b128 a[180:183], v11 offset:18432
    s_mul_i32 s52, s98, 114688
    v_mfma_f32_16x16x32_bf16 v[164:167], v[52:55], a[168:171], v[164:167]
    buffer_load_dwordx4 v6, s[32:35], s52 offen offset:0 lds
    v_mfma_f32_16x16x32_bf16 v[148:151], v[52:55], a[164:167], v[148:151]
    ds_read_b128 a[184:187], v11 offset:20480
    s_lshl_b32 s13, s85, 5
    v_mfma_f32_16x16x32_bf16 v[132:135], v[52:55], a[160:163], v[132:135]
    ds_read_b128 a[188:191], v11 offset:22528
    s_add_u32 s13, s13, s55
    v_mfma_f32_16x16x32_bf16 v[136:139], v[56:59], a[160:163], v[136:139]
    ds_read_b64_tr_b16 v[36:37], v15 offset:49152
    s_lshl_b32 s13, s13, 7
    v_mfma_f32_16x16x32_bf16 v[152:155], v[56:59], a[164:167], v[152:155]
    buffer_load_dwordx4 v7, s[32:35], s52 offen offset:1024 lds
    v_mfma_f32_16x16x32_bf16 v[168:171], v[56:59], a[168:171], v[168:171]
    ds_read_b64_tr_b16 v[38:39], v15 offset:50176
    s_mul_i32 s12, s85, 0x22000
    v_mfma_f32_16x16x32_bf16 v[184:187], v[56:59], a[172:175], v[184:187]
    ds_read_b64_tr_b16 v[40:41], v14 offset:57344
    s_lshl_b32 s48, s55, 12
    v_mfma_f32_16x16x32_bf16 v[188:191], v[60:63], a[172:175], v[188:191]
    ds_read_b64_tr_b16 v[42:43], v14 offset:58368
    s_add_u32 s12, s12, 0xa00000
    v_mfma_f32_16x16x32_bf16 v[172:175], v[60:63], a[168:171], v[172:175]
    buffer_load_dwordx4 v8, s[32:35], s52 offen offset:2048 lds
    v_mfma_f32_16x16x32_bf16 v[156:159], v[60:63], a[164:167], v[156:159]
    ds_read_b64_tr_b16 v[44:45], v15 offset:57344
    s_add_u32 s12, s12, s48
    v_mfma_f32_16x16x32_bf16 v[140:143], v[60:63], a[160:163], v[140:143]
    ds_read_b64_tr_b16 v[46:47], v15 offset:58368
    s_waitcnt lgkmcnt(5)
    v_mfma_f32_16x16x32_bf16 v[64:67], v[32:35], a[176:179], v[64:67]
    ds_read_b64_tr_b16 v[48:49], v14 offset:53248
    s_add_u32 s14, s12, 0x20000
    v_mfma_f32_16x16x32_bf16 v[80:83], v[32:35], a[180:183], v[80:83]
    buffer_load_dwordx4 v9, s[32:35], s52 offen offset:3072 lds
    v_mfma_f32_16x16x32_bf16 v[96:99], v[32:35], a[184:187], v[96:99]
    ds_read_b64_tr_b16 v[50:51], v14 offset:54272
    s_mov_b32 s88, 0x3fb8aa3b
    v_mfma_f32_16x16x32_bf16 v[112:115], v[32:35], a[188:191], v[112:115]
    ds_read_b64_tr_b16 v[52:53], v15 offset:53248
    s_waitcnt lgkmcnt(5)
    v_mfma_f32_16x16x32_bf16 v[116:119], v[36:39], a[188:191], v[116:119]
    ds_read_b64_tr_b16 v[54:55], v15 offset:54272
    s_add_u32 m0, s51, 49152
    v_mfma_f32_16x16x32_bf16 v[100:103], v[36:39], a[184:187], v[100:103]
    buffer_load_dwordx4 v4, s[28:31], s53 offen offset:2048 lds
    v_mfma_f32_16x16x32_bf16 v[84:87], v[36:39], a[180:183], v[84:87]
    ds_read_b64_tr_b16 v[56:57], v14 offset:61440
    s_mov_b32 s89, s88
    v_mfma_f32_16x16x32_bf16 v[68:71], v[36:39], a[176:179], v[68:71]
    ds_read_b64_tr_b16 v[58:59], v14 offset:62464
    v_mov_b32 v30, 0xc0135761
    v_mfma_f32_16x16x32_bf16 v[72:75], v[40:43], a[176:179], v[72:75]
    ds_read_b64_tr_b16 v[60:61], v15 offset:61440
    v_mov_b32 v31, 0xbdd2d3e8
    v_mfma_f32_16x16x32_bf16 v[88:91], v[40:43], a[180:183], v[88:91]
    buffer_load_dwordx4 v5, s[28:31], s53 offen offset:3072 lds
    v_mfma_f32_16x16x32_bf16 v[104:107], v[40:43], a[184:187], v[104:107]
    ds_read_b64_tr_b16 v[62:63], v15 offset:62464
    s_lshl4_add_u32 s0, s43, s44
    v_mfma_f32_16x16x32_bf16 v[120:123], v[40:43], a[188:191], v[120:123]
    s_lshl_b32 s0, s0, 7
    s_waitcnt lgkmcnt(4)
    v_mfma_f32_16x16x32_bf16 v[124:127], v[44:47], a[188:191], v[124:127]
    s_add_u32 m0, s50, 131072
    s_add_u32 s0, s0, 0x40000
    v_mfma_f32_16x16x32_bf16 v[108:111], v[44:47], a[184:187], v[108:111]
    buffer_load_dwordx4 v21, s[56:59], s84 offen offset:1024 lds
    v_mfma_f32_16x16x32_bf16 v[92:95], v[44:47], a[180:183], v[92:95]
    s_lshr_b32 s1, s90, 1
    s_waitcnt vmcnt(15) lgkmcnt(0)
    v_mfma_f32_16x16x32_bf16 v[76:79], v[44:47], a[176:179], v[76:79]
    s_barrier
    v_mfma_f32_16x16x32_bf16 v[128:131], v[48:51], a[176:179], v[128:131]
    ds_read_b128 a[192:195], v10 offset:32768
    s_add_u32 s98, s98, 1
    v_mfma_f32_16x16x32_bf16 v[144:147], v[48:51], a[180:183], v[144:147]
    ds_read_b64_tr_b16 v[32:33], v14 offset:0
    s_and_b32 s98, s98, 15
    v_mfma_f32_16x16x32_bf16 v[160:163], v[48:51], a[184:187], v[160:163]
    ds_read_b64_tr_b16 v[34:35], v14 offset:1024
    s_add_u32 m0, s50, 49152
    v_mfma_f32_16x16x32_bf16 v[176:179], v[48:51], a[188:191], v[176:179]
    ds_read_b128 a[196:199], v10 offset:34816
    s_mul_i32 s52, s98, 114688
    v_mfma_f32_16x16x32_bf16 v[180:183], v[52:55], a[188:191], v[180:183]
    buffer_load_dwordx4 v6, s[32:35], s52 offen offset:0 lds
    v_mfma_f32_16x16x32_bf16 v[164:167], v[52:55], a[184:187], v[164:167]
    ds_read_b128 a[200:203], v10 offset:36864
    s_lshl3_add_u32 s1, s1, s40
    v_mfma_f32_16x16x32_bf16 v[148:151], v[52:55], a[180:183], v[148:151]
    ds_read_b128 a[204:207], v10 offset:38912
    s_lshl_b32 s1, s1, 8
    v_mfma_f32_16x16x32_bf16 v[132:135], v[52:55], a[176:179], v[132:135]
    ds_read_b64_tr_b16 v[36:37], v15 offset:0
    s_add_u32 s1, s1, 0x40000
    v_mfma_f32_16x16x32_bf16 v[136:139], v[56:59], a[176:179], v[136:139]
    ds_read_b64_tr_b16 v[38:39], v15 offset:1024
    s_lshl_b32 s15, s44, 11
    v_mfma_f32_16x16x32_bf16 v[152:155], v[56:59], a[180:183], v[152:155]
    buffer_load_dwordx4 v7, s[32:35], s52 offen offset:1024 lds
    v_mfma_f32_16x16x32_bf16 v[168:171], v[56:59], a[184:187], v[168:171]
    ds_read_b64_tr_b16 v[40:41], v14 offset:8192
    s_add_u32 s15, s15, 0x50000
    v_mfma_f32_16x16x32_bf16 v[184:187], v[56:59], a[188:191], v[184:187]
    ds_read_b64_tr_b16 v[42:43], v14 offset:9216
    s_mul_i32 s54, s55, 294912
    v_mfma_f32_16x16x32_bf16 v[188:191], v[60:63], a[188:191], v[188:191]
    ds_read_b64_tr_b16 v[44:45], v15 offset:8192
    s_add_u32 s54, s54, 0x100000
    v_mfma_f32_16x16x32_bf16 v[172:175], v[60:63], a[184:187], v[172:175]
    ds_read_b64_tr_b16 v[46:47], v15 offset:9216
    v_and_b32 v218, 8, v0
    v_mfma_f32_16x16x32_bf16 v[156:159], v[60:63], a[180:183], v[156:159]
    buffer_load_dwordx4 v8, s[32:35], s52 offen offset:2048 lds
    v_mfma_f32_16x16x32_bf16 v[140:143], v[60:63], a[176:179], v[140:143]
    v_cmp_eq_u32 vcc, 0, v218
    s_waitcnt lgkmcnt(4)
    v_mfma_f32_16x16x32_bf16 v[64:67], v[32:35], a[192:195], v[64:67]
    ds_read_b64_tr_b16 v[48:49], v14 offset:4096
    v_mov_b32 v218, 0x0c0c0c0c
    v_mfma_f32_16x16x32_bf16 v[80:83], v[32:35], a[196:199], v[80:83]
    buffer_load_dwordx4 v9, s[32:35], s52 offen offset:3072 lds
    v_mfma_f32_16x16x32_bf16 v[96:99], v[32:35], a[200:203], v[96:99]
    ds_read_b64_tr_b16 v[50:51], v14 offset:5120
    v_mov_b32 v219, 0x05040100
    v_mfma_f32_16x16x32_bf16 v[112:115], v[32:35], a[204:207], v[112:115]
    ds_read_b64_tr_b16 v[52:53], v15 offset:4096
    v_mov_b32 v220, 0x07060302
    v_mfma_f32_16x16x32_bf16 v[116:119], v[36:39], a[204:207], v[116:119]
    ds_read_b64_tr_b16 v[54:55], v15 offset:5120
    s_add_u32 m0, s50, 131072
    v_mfma_f32_16x16x32_bf16 v[100:103], v[36:39], a[200:203], v[100:103]
    buffer_load_dwordx4 v22, s[56:59], s84 offen offset:2048 lds
    v_mfma_f32_16x16x32_bf16 v[84:87], v[36:39], a[196:199], v[84:87]
    ds_read_b64_tr_b16 v[56:57], v14 offset:12288
    v_cndmask_b32_e64 v248, v218, v219, vcc
    v_mfma_f32_16x16x32_bf16 v[68:71], v[36:39], a[192:195], v[68:71]
    ds_read_b64_tr_b16 v[58:59], v14 offset:13312
    s_waitcnt lgkmcnt(5)
    v_mfma_f32_16x16x32_bf16 v[72:75], v[40:43], a[192:195], v[72:75]
    ds_read_b64_tr_b16 v[60:61], v15 offset:12288
    v_cndmask_b32 v249, v218, v220, vcc
    v_mfma_f32_16x16x32_bf16 v[88:91], v[40:43], a[196:199], v[88:91]
    buffer_load_dwordx4 v23, s[56:59], s84 offen offset:3072 lds
    v_mfma_f32_16x16x32_bf16 v[104:107], v[40:43], a[200:203], v[104:107]
    ds_read_b64_tr_b16 v[62:63], v15 offset:13312
    s_add_u32 s84, s100, 32768
    s_and_b32 s84, s84, 229376
    v_mfma_f32_16x16x32_bf16 v[120:123], v[40:43], a[204:207], v[120:123]
    s_add_u32 m0, s50, 147456
    v_cndmask_b32_e64 v250, v219, v218, vcc
    v_mfma_f32_16x16x32_bf16 v[124:127], v[44:47], a[204:207], v[124:127]
    s_xor_b32 s84, s84, s4
    v_cndmask_b32 v251, v220, v218, vcc
    v_mfma_f32_16x16x32_bf16 v[108:111], v[44:47], a[200:203], v[108:111]
    buffer_load_dwordx4 v20, s[56:59], s84 offen offset:0 lds
    v_mfma_f32_16x16x32_bf16 v[92:95], v[44:47], a[196:199], v[92:95]
    v_bfe_u32 v252, v0, 2, 1
    s_waitcnt vmcnt(17) lgkmcnt(0)
    v_mfma_f32_16x16x32_bf16 v[76:79], v[44:47], a[192:195], v[76:79]
    s_barrier
    v_mfma_f32_16x16x32_bf16 v[128:131], v[48:51], a[192:195], v[128:131]
    ds_read_b128 a[208:211], v11 offset:32768
    v_add_u32 v9, 58368, v28
    v_add_u32 v8, 47104, v28
    v_mfma_f32_16x16x32_bf16 v[144:147], v[48:51], a[196:199], v[144:147]
    ds_read_b64_tr_b16 v[32:33], v14 offset:16384
    v_add_u32 v7, 11264, v28
    v_add_u32_e64 v6, 0, v28
    v_mfma_f32_16x16x32_bf16 v[160:163], v[48:51], a[200:203], v[160:163]
    ds_read_b64_tr_b16 v[34:35], v14 offset:17408
    s_add_u32 s98, s99, s40
    s_and_b32 s98, s98, 15
    v_mfma_f32_16x16x32_bf16 v[176:179], v[48:51], a[204:207], v[176:179]
    ds_read_b128 a[212:215], v11 offset:34816
    s_add_u32 m0, s50, 0
    s_mul_i32 s52, s98, 98304
    v_mfma_f32_16x16x32_bf16 v[180:183], v[52:55], a[204:207], v[180:183]
    buffer_load_dwordx4 v6, s[80:83], s52 offen offset:0 lds
    v_mfma_f32_16x16x32_bf16 v[164:167], v[52:55], a[200:203], v[164:167]
    ds_read_b128 a[216:219], v11 offset:36864
    v_mul_u32_u24 v252, 0x8000, v252
    v_mfma_f32_16x16x32_bf16 v[148:151], v[52:55], a[196:199], v[148:151]
    ds_read_b128 a[220:223], v11 offset:38912
    v_lshl_or_b32 v252, v252, 16, v252
    v_mfma_f32_16x16x32_bf16 v[132:135], v[52:55], a[192:195], v[132:135]
    ds_read_b64_tr_b16 v[36:37], v15 offset:16384
    v_xor_b32 v240, v252, v240
    v_mfma_f32_16x16x32_bf16 v[136:139], v[56:59], a[192:195], v[136:139]
    ds_read_b64_tr_b16 v[38:39], v15 offset:17408
    v_xor_b32_e64 v241, v252, v241
    v_mfma_f32_16x16x32_bf16 v[152:155], v[56:59], a[196:199], v[152:155]
    buffer_load_dwordx4 v7, s[80:83], s52 offen offset:1024 lds
    v_mfma_f32_16x16x32_bf16 v[168:171], v[56:59], a[200:203], v[168:171]
    ds_read_b64_tr_b16 v[40:41], v14 offset:24576
    v_xor_b32_e64 v242, v252, v242
    v_mfma_f32_16x16x32_bf16 v[184:187], v[56:59], a[204:207], v[184:187]
    ds_read_b64_tr_b16 v[42:43], v14 offset:25600
    v_xor_b32_e64 v243, v252, v243
    v_mfma_f32_16x16x32_bf16 v[188:191], v[60:63], a[204:207], v[188:191]
    ds_read_b64_tr_b16 v[44:45], v15 offset:24576
    v_xor_b32_e64 v244, v252, v244
    v_mfma_f32_16x16x32_bf16 v[172:175], v[60:63], a[200:203], v[172:175]
    ds_read_b64_tr_b16 v[46:47], v15 offset:25600
    v_xor_b32_e64 v245, v252, v245
    v_mfma_f32_16x16x32_bf16 v[156:159], v[60:63], a[196:199], v[156:159]
    buffer_load_dwordx4 v8, s[80:83], s52 offen offset:2048 lds
    v_mfma_f32_16x16x32_bf16 v[140:143], v[60:63], a[192:195], v[140:143]
    v_xor_b32 v246, v252, v246
    s_waitcnt lgkmcnt(4)
    v_mfma_f32_16x16x32_bf16 v[64:67], v[32:35], a[208:211], v[64:67]
    ds_read_b64_tr_b16 v[48:49], v14 offset:20480
L_qmain_s2:
    s_cbranch_execz L_qmain_ret
    v_xor_b32 v247, v252, v247
    v_mfma_f32_16x16x32_bf16 v[80:83], v[32:35], a[212:215], v[80:83]
    buffer_load_dwordx4 v9, s[80:83], s52 offen offset:3072 lds
    v_mfma_f32_16x16x32_bf16 v[96:99], v[32:35], a[216:219], v[96:99]
    ds_read_b64_tr_b16 v[50:51], v14 offset:21504
    v_perm_b32 v224, v242, v240, v248
    v_mfma_f32_16x16x32_bf16 v[112:115], v[32:35], a[220:223], v[112:115]
    ds_read_b64_tr_b16 v[52:53], v15 offset:20480
    v_perm_b32 v225, v246, v244, v248
    v_mfma_f32_16x16x32_bf16 v[116:119], v[36:39], a[220:223], v[116:119]
    ds_read_b64_tr_b16 v[54:55], v15 offset:21504
    s_add_u32 m0, s50, 147456
    v_mfma_f32_16x16x32_bf16 v[100:103], v[36:39], a[216:219], v[100:103]
    buffer_load_dwordx4 v21, s[56:59], s84 offen offset:1024 lds
    v_mfma_f32_16x16x32_bf16 v[84:87], v[36:39], a[212:215], v[84:87]
    ds_read_b64_tr_b16 v[56:57], v14 offset:28672
    v_perm_b32 v226, v242, v240, v250
    v_mfma_f32_16x16x32_bf16 v[68:71], v[36:39], a[208:211], v[68:71]
    ds_read_b64_tr_b16 v[58:59], v14 offset:29696
    s_waitcnt lgkmcnt(5)
    v_mfma_f32_16x16x32_bf16 v[72:75], v[40:43], a[208:211], v[72:75]
    ds_read_b64_tr_b16 v[60:61], v15 offset:28672
    v_perm_b32 v227, v246, v244, v250
    v_mfma_f32_16x16x32_bf16 v[88:91], v[40:43], a[212:215], v[88:91]
    buffer_load_dwordx4 v22, s[56:59], s84 offen offset:2048 lds
    v_mfma_f32_16x16x32_bf16 v[104:107], v[40:43], a[216:219], v[104:107]
    ds_read_b64_tr_b16 v[62:63], v15 offset:29696
    v_perm_b32 v228, v242, v240, v249
    v_mfma_f32_16x16x32_bf16 v[120:123], v[40:43], a[220:223], v[120:123]
    v_perm_b32 v229, v246, v244, v249
    v_perm_b32 v230, v242, v240, v251
    v_mfma_f32_16x16x32_bf16 v[124:127], v[44:47], a[220:223], v[124:127]
    v_perm_b32 v231, v246, v244, v251
    v_perm_b32 v232, v243, v241, v248
    v_mfma_f32_16x16x32_bf16 v[108:111], v[44:47], a[216:219], v[108:111]
    buffer_load_dwordx4 v23, s[56:59], s84 offen offset:3072 lds
    v_mfma_f32_16x16x32_bf16 v[92:95], v[44:47], a[212:215], v[92:95]
    v_perm_b32 v233, v247, v245, v248
    s_waitcnt vmcnt(15) lgkmcnt(0)
    v_mfma_f32_16x16x32_bf16 v[76:79], v[44:47], a[208:211], v[76:79]
    s_barrier
    v_mfma_f32_16x16x32_bf16 v[128:131], v[48:51], a[208:211], v[128:131]
    ds_read_b128 a[224:227], v10 offset:49152
    v_lshlrev_b32 v29, 2, v0
    v_mfma_f32_16x16x32_bf16 v[144:147], v[48:51], a[212:215], v[144:147]
    ds_read_b64_tr_b16 v[32:33], v14 offset:32768
    s_lshl_b32 s45, s55, 8
    v_mfma_f32_16x16x32_bf16 v[160:163], v[48:51], a[216:219], v[160:163]
    ds_read_b64_tr_b16 v[34:35], v14 offset:33792
    s_add_u32 s45, s45, 0x54000
    v_mfma_f32_16x16x32_bf16 v[176:179], v[48:51], a[220:223], v[176:179]
    buffer_load_dword v12, v29, s[36:39], s45 offen sc1
    v_mfma_f32_16x16x32_bf16 v[180:183], v[52:55], a[220:223], v[180:183]
    ds_read_b128 a[228:231], v10 offset:51200
    s_add_u32 s98, s98, 4
    v_mfma_f32_16x16x32_bf16 v[164:167], v[52:55], a[216:219], v[164:167]
    ds_read_b128 a[232:235], v10 offset:53248
    s_and_b32 s98, s98, 15
    v_mfma_f32_16x16x32_bf16 v[148:151], v[52:55], a[212:215], v[148:151]
    ds_read_b128 a[236:239], v10 offset:55296
    s_add_u32 m0, s50, 16384
    v_mfma_f32_16x16x32_bf16 v[132:135], v[52:55], a[208:211], v[132:135]
    ds_read_b64_tr_b16 v[36:37], v15 offset:32768
    s_mul_i32 s52, s98, 98304
    v_mfma_f32_16x16x32_bf16 v[136:139], v[56:59], a[208:211], v[136:139]
    buffer_load_dwordx4 v6, s[80:83], s52 offen offset:0 lds
    v_mfma_f32_16x16x32_bf16 v[152:155], v[56:59], a[212:215], v[152:155]
    ds_read_b64_tr_b16 v[38:39], v15 offset:33792
    v_perm_b32 v234, v243, v241, v250
    v_mfma_f32_16x16x32_bf16 v[168:171], v[56:59], a[216:219], v[168:171]
    ds_read_b64_tr_b16 v[40:41], v14 offset:40960
    v_perm_b32 v235, v247, v245, v250
    v_mfma_f32_16x16x32_bf16 v[184:187], v[56:59], a[220:223], v[184:187]
    ds_read_b64_tr_b16 v[42:43], v14 offset:41984
    v_perm_b32 v236, v243, v241, v249
    v_mfma_f32_16x16x32_bf16 v[188:191], v[60:63], a[220:223], v[188:191]
    ds_read_b64_tr_b16 v[44:45], v15 offset:40960
    v_perm_b32 v237, v247, v245, v249
    v_mfma_f32_16x16x32_bf16 v[172:175], v[60:63], a[216:219], v[172:175]
    buffer_load_dwordx4 v7, s[80:83], s52 offen offset:1024 lds
    v_mfma_f32_16x16x32_bf16 v[156:159], v[60:63], a[212:215], v[156:159]
    ds_read_b64_tr_b16 v[46:47], v15 offset:41984
    v_perm_b32 v238, v243, v241, v251
    v_mfma_f32_16x16x32_bf16 v[140:143], v[60:63], a[208:211], v[140:143]
    v_perm_b32 v239, v247, v245, v251
    s_waitcnt lgkmcnt(5)
    v_mfma_f32_16x16x32_bf16 v[64:67], v[32:35], a[224:227], v[64:67]
    ds_read_b64_tr_b16 v[48:49], v14 offset:36864
    v_mfma_f32_16x16x32_bf16 v[80:83], v[32:35], a[228:231], v[80:83]
    buffer_load_dwordx4 v8, s[80:83], s52 offen offset:2048 lds
    ds_read_b64_tr_b16 v[50:51], v14 offset:37888
    v_mfma_f32_16x16x32_bf16 v[96:99], v[32:35], a[232:235], v[96:99]
    ds_read_b64_tr_b16 v[52:53], v15 offset:36864
    v_mfma_f32_16x16x32_bf16 v[112:115], v[32:35], a[236:239], v[112:115]
    ds_read_b64_tr_b16 v[54:55], v15 offset:37888
    s_waitcnt lgkmcnt(5)
    v_mfma_f32_16x16x32_bf16 v[116:119], v[36:39], a[236:239], v[116:119]
    ds_read_b64_tr_b16 v[56:57], v14 offset:45056
    v_mfma_f32_16x16x32_bf16 v[100:103], v[36:39], a[232:235], v[100:103]
    buffer_load_dwordx4 v9, s[80:83], s52 offen offset:3072 lds
    v_mfma_f32_16x16x32_bf16 v[84:87], v[36:39], a[228:231], v[84:87]
    ds_read_b64_tr_b16 v[58:59], v14 offset:46080
    s_add_u32 s84, s100, 65536
    s_and_b32 s84, s84, 229376
    v_mfma_f32_16x16x32_bf16 v[68:71], v[36:39], a[224:227], v[68:71]
    ds_read_b64_tr_b16 v[60:61], v15 offset:45056
    s_add_u32 m0, s50, 65536
    v_mfma_f32_16x16x32_bf16 v[72:75], v[40:43], a[224:227], v[72:75]
    ds_read_b64_tr_b16 v[62:63], v15 offset:46080
    s_xor_b32 s84, s84, s4
    v_mfma_f32_16x16x32_bf16 v[88:91], v[40:43], a[228:231], v[88:91]
    buffer_load_dwordx4 v20, s[56:59], s84 offen offset:0 lds
    v_mfma_f32_16x16x32_bf16 v[104:107], v[40:43], a[232:235], v[104:107]
    s_waitcnt vmcnt(14)
    ds_read_b64_tr_b16 v[192:193], v24 offset:0
    v_mfma_f32_16x16x32_bf16 v[120:123], v[40:43], a[236:239], v[120:123]
    ds_read_b64_tr_b16 v[194:195], v24 offset:1024
    s_waitcnt lgkmcnt(5)
    v_mfma_f32_16x16x32_bf16 v[124:127], v[44:47], a[236:239], v[124:127]
    ds_read_b64_tr_b16 v[196:197], v25 offset:0
    v_mfma_f32_16x16x32_bf16 v[108:111], v[44:47], a[232:235], v[108:111]
    buffer_load_dwordx4 v21, s[56:59], s84 offen offset:1024 lds
    v_mfma_f32_16x16x32_bf16 v[92:95], v[44:47], a[228:231], v[92:95]
    ds_read_b64_tr_b16 v[198:199], v25 offset:1024
    s_waitcnt lgkmcnt(4)
    v_mfma_f32_16x16x32_bf16 v[76:79], v[44:47], a[224:227], v[76:79]
    s_barrier
    v_mfma_f32_16x16x32_bf16 v[128:131], v[48:51], a[224:227], v[128:131]
    ds_read_b128 a[240:243], v11 offset:49152
    v_mfma_f32_16x16x32_bf16 v[144:147], v[48:51], a[228:231], v[144:147]
    buffer_load_dwordx4 v22, s[56:59], s84 offen offset:2048 lds
    v_mfma_f32_16x16x32_bf16 v[160:163], v[48:51], a[232:235], v[160:163]
    ds_read_b64_tr_b16 v[32:33], v14 offset:49152
    s_add_u32 s98, s98, 4
    s_and_b32 s98, s98, 15
    v_mfma_f32_16x16x32_bf16 v[176:179], v[48:51], a[236:239], v[176:179]
    ds_read_b64_tr_b16 v[34:35], v14 offset:50176
    s_add_u32 m0, s50, 32768
    v_mfma_f32_16x16x32_bf16 v[180:183], v[52:55], a[236:239], v[180:183]
    ds_read_b128 a[244:247], v11 offset:51200
    s_mul_i32 s52, s98, 98304
    v_mfma_f32_16x16x32_bf16 v[164:167], v[52:55], a[232:235], v[164:167]
    buffer_load_dwordx4 v6, s[80:83], s52 offen offset:0 lds
    v_mfma_f32_16x16x32_bf16 v[148:151], v[52:55], a[228:231], v[148:151]
    ds_read_b128 a[248:251], v11 offset:53248
    v_mfma_f32_16x16x32_bf16 v[132:135], v[52:55], a[224:227], v[132:135]
    ds_read_b128 a[252:255], v11 offset:55296
    v_mfma_f32_16x16x32_bf16 v[136:139], v[56:59], a[224:227], v[136:139]
    ds_read_b64_tr_b16 v[36:37], v15 offset:49152
    v_mfma_f32_16x16x32_bf16 v[152:155], v[56:59], a[228:231], v[152:155]
    buffer_load_dwordx4 v7, s[80:83], s52 offen offset:1024 lds
    v_mfma_f32_16x16x32_bf16 v[168:171], v[56:59], a[232:235], v[168:171]
    ds_read_b64_tr_b16 v[38:39], v15 offset:50176
    v_mfma_f32_16x16x32_bf16 v[184:187], v[56:59], a[236:239], v[184:187]
    ds_read_b64_tr_b16 v[40:41], v14 offset:57344
    v_mfma_f32_16x16x32_bf16 v[188:191], v[60:63], a[236:239], v[188:191]
    ds_read_b64_tr_b16 v[42:43], v14 offset:58368
    v_mfma_f32_16x16x32_bf16 v[172:175], v[60:63], a[232:235], v[172:175]
    buffer_load_dwordx4 v8, s[80:83], s52 offen offset:2048 lds
    v_mfma_f32_16x16x32_bf16 v[156:159], v[60:63], a[228:231], v[156:159]
    ds_read_b64_tr_b16 v[44:45], v15 offset:57344
    v_mfma_f32_16x16x32_bf16 v[140:143], v[60:63], a[224:227], v[140:143]
    ds_read_b64_tr_b16 v[46:47], v15 offset:58368
    s_waitcnt lgkmcnt(5)
    v_mfma_f32_16x16x32_bf16 v[64:67], v[32:35], a[240:243], v[64:67]
    ds_read_b64_tr_b16 v[48:49], v14 offset:53248
    v_mfma_f32_16x16x32_bf16 v[80:83], v[32:35], a[244:247], v[80:83]
    ds_read_b64_tr_b16 v[50:51], v14 offset:54272
    v_mfma_f32_16x16x32_bf16 v[96:99], v[32:35], a[248:251], v[96:99]
    ds_read_b64_tr_b16 v[52:53], v15 offset:53248
    v_mfma_f32_16x16x32_bf16 v[112:115], v[32:35], a[252:255], v[112:115]
    buffer_load_dwordx4 v9, s[80:83], s52 offen offset:3072 lds
    s_waitcnt lgkmcnt(5)
    v_mfma_f32_16x16x32_bf16 v[116:119], v[36:39], a[252:255], v[116:119]
    ds_read_b64_tr_b16 v[54:55], v15 offset:54272
    v_mfma_f32_16x16x32_bf16 v[100:103], v[36:39], a[248:251], v[100:103]
    ds_read_b64_tr_b16 v[56:57], v14 offset:61440
    v_mfma_f32_16x16x32_bf16 v[84:87], v[36:39], a[244:247], v[84:87]
    ds_read_b64_tr_b16 v[58:59], v14 offset:62464
    v_mfma_f32_16x16x32_bf16 v[68:71], v[36:39], a[240:243], v[68:71]
    ds_read_b64_tr_b16 v[60:61], v15 offset:61440
    v_mfma_f32_16x16x32_bf16 v[72:75], v[40:43], a[240:243], v[72:75]
    ds_read_b64_tr_b16 v[62:63], v15 offset:62464
    v_mfma_f32_16x16x32_bf16 v[88:91], v[40:43], a[244:247], v[88:91]
    ds_read_b64_tr_b16 v[200:201], v26 offset:0
    v_mfma_f32_16x16x32_bf16 v[104:107], v[40:43], a[248:251], v[104:107]
    ds_read_b64_tr_b16 v[202:203], v26 offset:1024
    s_add_u32 m0, s50, 65536
    v_mfma_f32_16x16x32_bf16 v[120:123], v[40:43], a[252:255], v[120:123]
    buffer_load_dwordx4 v23, s[56:59], s84 offen offset:3072 lds
    s_waitcnt lgkmcnt(6)
    v_mfma_f32_16x16x32_bf16 v[124:127], v[44:47], a[252:255], v[124:127]
    ds_read_b64_tr_b16 v[204:205], v27 offset:0
    v_mfma_f32_16x16x32_bf16 v[108:111], v[44:47], a[248:251], v[108:111]
    ds_read_b64_tr_b16 v[206:207], v27 offset:1024
    v_mfma_f32_16x16x32_bf16 v[92:95], v[44:47], a[244:247], v[92:95]
    s_waitcnt vmcnt(16) lgkmcnt(4)
    v_mfma_f32_16x16x32_bf16 v[76:79], v[44:47], a[240:243], v[76:79]
    s_barrier
    s_waitcnt vmcnt(12)
    v_cmp_ne_u32 s[92:93], v12, 0
    s_nop 0
    s_cmp_eq_u64 s[92:93], -1
    s_cbranch_scc0 L_spgQ
L_okgQ:
    v_mfma_f32_16x16x32_bf16 v[128:131], v[48:51], a[240:243], v[128:131]
    ds_read_b64_tr_b16 v[32:33], v14 offset:0
    s_add_u32 s98, s98, 4
    v_mfma_f32_16x16x32_bf16 v[144:147], v[48:51], a[244:247], v[144:147]
    ds_read_b64_tr_b16 v[34:35], v14 offset:1024
    s_and_b32 s98, s98, 15
    v_mfma_f32_16x16x32_bf16 v[160:163], v[48:51], a[248:251], v[160:163]
    ds_read_b64_tr_b16 v[36:37], v15 offset:0
    s_add_u32 m0, s50, 49152
    v_mfma_f32_16x16x32_bf16 v[176:179], v[48:51], a[252:255], v[176:179]
    ds_read_b64_tr_b16 v[38:39], v15 offset:1024
    s_mul_i32 s52, s98, 98304
    v_mfma_f32_16x16x32_bf16 v[180:183], v[52:55], a[252:255], v[180:183]
    buffer_load_dwordx4 v6, s[80:83], s52 offen offset:0 lds
    ds_read_b64_tr_b16 v[40:41], v14 offset:4096
    v_mfma_f32_16x16x32_bf16 v[164:167], v[52:55], a[248:251], v[164:167]
    ds_read_b64_tr_b16 v[42:43], v14 offset:5120
    v_mfma_f32_16x16x32_bf16 v[148:151], v[52:55], a[244:247], v[148:151]
    ds_read_b64_tr_b16 v[44:45], v15 offset:4096
    v_mfma_f32_16x16x32_bf16 v[132:135], v[52:55], a[240:243], v[132:135]
    ds_read_b64_tr_b16 v[46:47], v15 offset:5120
    v_mfma_f32_16x16x32_bf16 v[136:139], v[56:59], a[240:243], v[136:139]
    ds_read_b64_tr_b16 v[208:209], v24 offset:16384
    v_mfma_f32_16x16x32_bf16 v[152:155], v[56:59], a[244:247], v[152:155]
    ds_read_b64_tr_b16 v[210:211], v24 offset:17408
    v_mfma_f32_16x16x32_bf16 v[168:171], v[56:59], a[248:251], v[168:171]
    ds_read_b64_tr_b16 v[212:213], v25 offset:16384
    v_mfma_f32_16x16x32_bf16 v[184:187], v[56:59], a[252:255], v[184:187]
    ds_read_b64_tr_b16 v[214:215], v25 offset:17408
    v_mfma_f32_16x16x32_bf16 v[188:191], v[60:63], a[252:255], v[188:191]
    buffer_load_dwordx4 v7, s[80:83], s52 offen offset:1024 lds
    ds_read_b64_tr_b16 v[216:217], v26 offset:16384
    v_mfma_f32_16x16x32_bf16 v[172:175], v[60:63], a[248:251], v[172:175]
    ds_read_b64_tr_b16 v[218:219], v26 offset:17408
    v_mfma_f32_16x16x32_bf16 v[156:159], v[60:63], a[244:247], v[156:159]
    ds_read_b64_tr_b16 v[220:221], v27 offset:16384
    v_mfma_f32_16x16x32_bf16 v[140:143], v[60:63], a[240:243], v[140:143]
    ds_read_b64_tr_b16 v[222:223], v27 offset:17408
    v_exp_f32_e64 v2, v12
    s_nop 0
    v_add_f32_e64 v2, 1.0, v2
    v_min_f32 v2, 0x7f000000, v2
    v_mov_b32 v3, v2
    s_nop 1
    v_permlane16_swap_b32 v2, v3
    v_mov_b32 v4, v2
    v_mov_b32_e64 v5, v3
    s_nop 0
    v_permlane32_swap_b32 v2, v4
    v_permlane32_swap_b32 v3, v5
    s_lshl2_add_u32 s48, s44, s47
    s_lshl_b32 s48, s48, 12
    s_add_u32 s16, s54, s48
    s_add_u32 s54, s16, 0x2000
.p2align 3
    v_pk_mul_f32 v[48:49], v[64:65], v[64:65]
    v_pk_mul_f32 v[50:51], v[66:67], v[66:67]
    v_pk_mul_f32 v[52:53], v[68:69], v[68:69]
    v_pk_mul_f32 v[54:55], v[70:71], v[70:71]
    v_pk_fma_f32 v[48:49], v[48:49], v[30:31], v[30:31] op_sel:[0,1,0] op_sel_hi:[1,1,0]
    buffer_load_dwordx4 v8, s[80:83], s52 offen offset:2048 lds
    v_pk_fma_f32 v[50:51], v[50:51], v[30:31], v[30:31] op_sel:[0,1,0] op_sel_hi:[1,1,0]
    v_pk_fma_f32 v[52:53], v[52:53], v[30:31], v[30:31] op_sel:[0,1,0] op_sel_hi:[1,1,0]
    v_pk_fma_f32 v[54:55], v[54:55], v[30:31], v[30:31] op_sel:[0,1,0] op_sel_hi:[1,1,0]
    v_pk_mul_f32 v[48:49], v[48:49], v[64:65]
    v_pk_mul_f32 v[50:51], v[50:51], v[66:67]
    v_pk_mul_f32 v[52:53], v[52:53], v[68:69]
    v_pk_mul_f32 v[54:55], v[54:55], v[70:71]
    v_exp_f32 v48, v48
    v_exp_f32 v49, v49
    v_exp_f32_e64 v50, v50
    buffer_load_dwordx4 v9, s[80:83], s52 offen offset:3072 lds
    v_exp_f32 v51, v51
    v_exp_f32 v52, v52
    v_exp_f32 v53, v53
    v_exp_f32 v54, v54
    v_exp_f32_e64 v55, v55
    v_pk_fma_f32 v[48:49], v[48:49], v[2:3], v[2:3] op_sel:[0,0,0] op_sel_hi:[1,0,0]
    v_pk_fma_f32 v[50:51], v[50:51], v[2:3], v[2:3] op_sel:[0,0,0] op_sel_hi:[1,0,0]
    s_waitcnt lgkmcnt(0)
    s_add_u32 s84, s100, 98304
    s_and_b32 s84, s84, 229376
    s_add_u32 m0, s50, 131072
    s_xor_b32 s84, s84, s4
    buffer_load_dwordx4 v20, s[56:59], s84 offen offset:0 lds
    v_pk_fma_f32 v[52:53], v[52:53], v[2:3], v[2:3] op_sel:[0,0,0] op_sel_hi:[1,0,0]
    v_pk_fma_f32 v[54:55], v[54:55], v[2:3], v[2:3] op_sel:[0,0,0] op_sel_hi:[1,0,0]
    v_rcp_f32 v48, v48
    v_rcp_f32 v49, v49
    v_rcp_f32 v50, v50
    v_rcp_f32 v51, v51
    v_rcp_f32_e64 v52, v52
    buffer_load_dwordx4 v21, s[56:59], s84 offen offset:1024 lds
    v_rcp_f32 v53, v53
    v_rcp_f32 v54, v54
    v_rcp_f32_e64 v55, v55
    v_pk_mul_f32 v[64:65], v[64:65], v[72:73]
    v_pk_mul_f32 v[66:67], v[66:67], v[74:75]
    v_pk_mul_f32 v[68:69], v[68:69], v[76:77]
    v_pk_mul_f32 v[70:71], v[70:71], v[78:79]
    v_pk_mul_f32 v[64:65], v[64:65], v[48:49]
    v_pk_mul_f32 v[66:67], v[66:67], v[50:51]
    buffer_load_dwordx4 v22, s[56:59], s84 offen offset:2048 lds
    v_pk_mul_f32 v[68:69], v[68:69], v[52:53]
    v_pk_mul_f32 v[70:71], v[70:71], v[54:55]
    v_cvt_pk_bf16_f32 v72, v64, v65
    v_cvt_pk_bf16_f32 v74, v68, v69
    v_cvt_pk_bf16_f32 v73, v66, v67
    v_cvt_pk_bf16_f32 v75, v70, v71
    buffer_store_dwordx4 v[72:75], v16, s[36:39], s16 offen offset:0 sc1
    v_pk_mul_f32 v[56:57], v[80:81], v[80:81]
    v_pk_mul_f32 v[58:59], v[82:83], v[82:83]
    v_pk_mul_f32 v[60:61], v[84:85], v[84:85]
    v_pk_mul_f32 v[62:63], v[86:87], v[86:87]
    v_pk_fma_f32 v[56:57], v[56:57], v[30:31], v[30:31] op_sel:[0,1,0] op_sel_hi:[1,1,0]
    buffer_load_dwordx4 v23, s[56:59], s84 offen offset:3072 lds
    v_pk_fma_f32 v[58:59], v[58:59], v[30:31], v[30:31] op_sel:[0,1,0] op_sel_hi:[1,1,0]
    v_pk_fma_f32 v[60:61], v[60:61], v[30:31], v[30:31] op_sel:[0,1,0] op_sel_hi:[1,1,0]
    v_pk_fma_f32 v[62:63], v[62:63], v[30:31], v[30:31] op_sel:[0,1,0] op_sel_hi:[1,1,0]
    v_pk_mul_f32 v[56:57], v[56:57], v[80:81]
    v_pk_mul_f32 v[58:59], v[58:59], v[82:83]
    v_pk_mul_f32 v[60:61], v[60:61], v[84:85]
    v_pk_mul_f32 v[62:63], v[62:63], v[86:87]
    v_exp_f32 v56, v56
    v_exp_f32 v57, v57
    v_exp_f32_e64 v58, v58
    s_add_u32 s84, s100, 131072
    s_and_b32 s84, s84, 229376
    s_add_u32 m0, s50, 147456
    s_xor_b32 s84, s84, s4
    buffer_load_dwordx4 v20, s[56:59], s84 offen offset:0 lds
    v_exp_f32 v59, v59
    v_exp_f32 v60, v60
    v_exp_f32 v61, v61
    v_exp_f32 v62, v62
    v_exp_f32 v63, v63
    v_pk_fma_f32 v[56:57], v[56:57], v[2:3], v[2:3] op_sel:[0,1,1] op_sel_hi:[1,1,1]
    v_pk_fma_f32 v[58:59], v[58:59], v[2:3], v[2:3] op_sel:[0,1,1] op_sel_hi:[1,1,1]
    buffer_load_dwordx4 v21, s[56:59], s84 offen offset:1024 lds
    v_pk_fma_f32 v[60:61], v[60:61], v[2:3], v[2:3] op_sel:[0,1,1] op_sel_hi:[1,1,1]
    v_pk_fma_f32 v[62:63], v[62:63], v[2:3], v[2:3] op_sel:[0,1,1] op_sel_hi:[1,1,1]
    v_rcp_f32 v56, v56
    v_rcp_f32 v57, v57
    v_rcp_f32 v58, v58
    v_rcp_f32 v59, v59
    v_rcp_f32_e64 v60, v60
    buffer_load_dwordx4 v22, s[56:59], s84 offen offset:2048 lds
    v_rcp_f32 v61, v61
    v_rcp_f32 v62, v62
    v_rcp_f32_e64 v63, v63
    v_pk_mul_f32 v[80:81], v[80:81], v[88:89]
    v_pk_mul_f32 v[82:83], v[82:83], v[90:91]
    v_pk_mul_f32 v[84:85], v[84:85], v[92:93]
    v_pk_mul_f32 v[86:87], v[86:87], v[94:95]
    v_pk_mul_f32 v[80:81], v[80:81], v[56:57]
    v_pk_mul_f32 v[82:83], v[82:83], v[58:59]
    buffer_load_dwordx4 v23, s[56:59], s84 offen offset:3072 lds
    v_pk_mul_f32 v[84:85], v[84:85], v[60:61]
    v_pk_mul_f32 v[86:87], v[86:87], v[62:63]
    v_cvt_pk_bf16_f32 v88, v80, v81
    v_cvt_pk_bf16_f32 v90, v84, v85
    v_cvt_pk_bf16_f32 v89, v82, v83
    v_cvt_pk_bf16_f32 v91, v86, v87
    v_pk_mul_f32 v[48:49], v[96:97], v[96:97]
    v_pk_mul_f32 v[50:51], v[98:99], v[98:99]
    v_pk_mul_f32 v[52:53], v[100:101], v[100:101]
    v_pk_mul_f32 v[54:55], v[102:103], v[102:103]
    v_pk_fma_f32 v[48:49], v[48:49], v[30:31], v[30:31] op_sel:[0,1,0] op_sel_hi:[1,1,0]
    v_pk_fma_f32 v[50:51], v[50:51], v[30:31], v[30:31] op_sel:[0,1,0] op_sel_hi:[1,1,0]
    v_pk_fma_f32 v[52:53], v[52:53], v[30:31], v[30:31] op_sel:[0,1,0] op_sel_hi:[1,1,0]
    s_add_u32 s84, s100, 32768
    s_and_b32 s84, s84, 98304
    s_add_u32 m0, s50, 81920
    s_xor_b32 s84, s84, s7
    buffer_load_dwordx4 v20, s[60:63], s84 offen offset:0 lds
    v_pk_fma_f32 v[54:55], v[54:55], v[30:31], v[30:31] op_sel:[0,1,0] op_sel_hi:[1,1,0]
    v_pk_mul_f32 v[48:49], v[48:49], v[96:97]
    v_pk_mul_f32 v[50:51], v[50:51], v[98:99]
    v_pk_mul_f32 v[52:53], v[52:53], v[100:101]
    v_pk_mul_f32 v[54:55], v[54:55], v[102:103]
    v_exp_f32 v48, v48
    v_exp_f32 v49, v49
    v_exp_f32 v50, v50
    v_exp_f32 v51, v51
    v_exp_f32 v52, v52
    buffer_load_dwordx4 v21, s[60:63], s84 offen offset:1024 lds
    v_exp_f32 v53, v53
    v_exp_f32 v54, v54
    v_exp_f32_e64 v55, v55
    v_pk_fma_f32 v[48:49], v[48:49], v[4:5], v[4:5] op_sel:[0,0,0] op_sel_hi:[1,0,0]
    v_pk_fma_f32 v[50:51], v[50:51], v[4:5], v[4:5] op_sel:[0,0,0] op_sel_hi:[1,0,0]
    v_pk_fma_f32 v[52:53], v[52:53], v[4:5], v[4:5] op_sel:[0,0,0] op_sel_hi:[1,0,0]
    v_pk_fma_f32 v[54:55], v[54:55], v[4:5], v[4:5] op_sel:[0,0,0] op_sel_hi:[1,0,0]
    v_rcp_f32 v48, v48
    v_rcp_f32 v49, v49
    buffer_load_dwordx4 v22, s[60:63], s84 offen offset:2048 lds
    v_rcp_f32 v50, v50
    v_rcp_f32 v51, v51
    v_rcp_f32 v52, v52
    v_rcp_f32 v53, v53
    v_rcp_f32 v54, v54
    v_rcp_f32 v55, v55
    v_pk_mul_f32 v[96:97], v[96:97], v[104:105]
    v_pk_mul_f32 v[98:99], v[98:99], v[106:107]
    v_pk_mul_f32 v[100:101], v[100:101], v[108:109]
    buffer_load_dwordx4 v23, s[60:63], s84 offen offset:3072 lds
    v_pk_mul_f32 v[102:103], v[102:103], v[110:111]
    v_pk_mul_f32 v[96:97], v[96:97], v[48:49]
    v_pk_mul_f32 v[98:99], v[98:99], v[50:51]
    v_pk_mul_f32 v[100:101], v[100:101], v[52:53]
    v_pk_mul_f32 v[102:103], v[102:103], v[54:55]
    v_cvt_pk_bf16_f32 v104, v96, v97
    v_cvt_pk_bf16_f32 v106, v100, v101
    v_cvt_pk_bf16_f32 v105, v98, v99
    v_cvt_pk_bf16_f32 v107, v102, v103
    v_pk_mul_f32 v[56:57], v[112:113], v[112:113]
    v_pk_mul_f32 v[58:59], v[114:115], v[114:115]
    v_pk_mul_f32 v[60:61], v[116:117], v[116:117]
    v_pk_mul_f32 v[62:63], v[118:119], v[118:119]
    s_add_u32 s84, s100, 65536
    s_and_b32 s84, s84, 98304
    s_add_u32 m0, s50, 98304
    s_xor_b32 s84, s84, s7
    buffer_load_dwordx4 v20, s[60:63], s84 offen offset:0 lds
    v_pk_fma_f32 v[56:57], v[56:57], v[30:31], v[30:31] op_sel:[0,1,0] op_sel_hi:[1,1,0]
    v_pk_fma_f32 v[58:59], v[58:59], v[30:31], v[30:31] op_sel:[0,1,0] op_sel_hi:[1,1,0]
    v_pk_fma_f32 v[60:61], v[60:61], v[30:31], v[30:31] op_sel:[0,1,0] op_sel_hi:[1,1,0]
    v_pk_fma_f32 v[62:63], v[62:63], v[30:31], v[30:31] op_sel:[0,1,0] op_sel_hi:[1,1,0]
    v_pk_mul_f32 v[56:57], v[56:57], v[112:113]
    v_pk_mul_f32 v[58:59], v[58:59], v[114:115]
    v_pk_mul_f32 v[60:61], v[60:61], v[116:117]
    v_pk_mul_f32 v[62:63], v[62:63], v[118:119]
    v_exp_f32 v56, v56
    buffer_load_dwordx4 v21, s[60:63], s84 offen offset:1024 lds
    v_exp_f32 v57, v57
    v_exp_f32 v58, v58
    v_exp_f32 v59, v59
    v_exp_f32 v60, v60
    v_exp_f32 v61, v61
    v_exp_f32 v62, v62
    buffer_load_dwordx4 v22, s[60:63], s84 offen offset:2048 lds
    v_exp_f32_e64 v63, v63
    v_pk_fma_f32 v[56:57], v[56:57], v[4:5], v[4:5] op_sel:[0,1,1] op_sel_hi:[1,1,1]
    v_pk_fma_f32 v[58:59], v[58:59], v[4:5], v[4:5] op_sel:[0,1,1] op_sel_hi:[1,1,1]
    v_pk_fma_f32 v[60:61], v[60:61], v[4:5], v[4:5] op_sel:[0,1,1] op_sel_hi:[1,1,1]
    v_pk_fma_f32 v[62:63], v[62:63], v[4:5], v[4:5] op_sel:[0,1,1] op_sel_hi:[1,1,1]
    v_rcp_f32 v56, v56
    v_rcp_f32 v57, v57
    buffer_load_dwordx4 v23, s[60:63], s84 offen offset:3072 lds
    v_rcp_f32 v58, v58
    v_rcp_f32 v59, v59
    v_rcp_f32 v60, v60
    v_rcp_f32 v61, v61
    v_rcp_f32 v62, v62
    v_rcp_f32 v63, v63
    s_add_u32 s84, s100, 98304
    s_and_b32 s84, s84, 98304
    s_add_u32 m0, s50, 114688
    s_xor_b32 s84, s84, s7
    buffer_load_dwordx4 v20, s[60:63], s84 offen offset:0 lds
    v_pk_mul_f32 v[112:113], v[112:113], v[120:121]
    v_pk_mul_f32 v[114:115], v[114:115], v[122:123]
    v_pk_mul_f32 v[116:117], v[116:117], v[124:125]
    v_pk_mul_f32 v[118:119], v[118:119], v[126:127]
    v_pk_mul_f32 v[112:113], v[112:113], v[56:57]
    v_pk_mul_f32 v[114:115], v[114:115], v[58:59]
    v_pk_mul_f32 v[116:117], v[116:117], v[60:61]
    v_pk_mul_f32 v[118:119], v[118:119], v[62:63]
    buffer_load_dwordx4 v21, s[60:63], s84 offen offset:1024 lds
    v_cvt_pk_bf16_f32 v120, v112, v113
    v_cvt_pk_bf16_f32 v122, v116, v117
    v_cvt_pk_bf16_f32 v121, v114, v115
    v_cvt_pk_bf16_f32 v123, v118, v119
    v_pk_mul_f32 v[48:49], v[128:129], v[128:129]
    v_pk_mul_f32 v[50:51], v[130:131], v[130:131]
    v_pk_mul_f32 v[52:53], v[132:133], v[132:133]
    v_pk_mul_f32 v[54:55], v[134:135], v[134:135]
    v_pk_fma_f32 v[48:49], v[48:49], v[30:31], v[30:31] op_sel:[0,1,0] op_sel_hi:[1,1,0]
    v_pk_fma_f32 v[50:51], v[50:51], v[30:31], v[30:31] op_sel:[0,1,0] op_sel_hi:[1,1,0]
    v_pk_fma_f32 v[52:53], v[52:53], v[30:31], v[30:31] op_sel:[0,1,0] op_sel_hi:[1,1,0]
    buffer_load_dwordx4 v22, s[60:63], s84 offen offset:2048 lds
    v_pk_fma_f32 v[54:55], v[54:55], v[30:31], v[30:31] op_sel:[0,1,0] op_sel_hi:[1,1,0]
    v_pk_mul_f32 v[48:49], v[48:49], v[128:129]
    v_pk_mul_f32 v[50:51], v[50:51], v[130:131]
    v_pk_mul_f32 v[52:53], v[52:53], v[132:133]
    v_pk_mul_f32 v[54:55], v[54:55], v[134:135]
    v_exp_f32 v48, v48
    v_exp_f32 v49, v49
    v_exp_f32 v50, v50
    v_exp_f32 v51, v51
    v_exp_f32 v52, v52
    buffer_load_dwordx4 v23, s[60:63], s84 offen offset:3072 lds
    v_exp_f32 v53, v53
    v_exp_f32 v54, v54
    v_exp_f32_e64 v55, v55
    v_pk_fma_f32 v[48:49], v[48:49], v[2:3], v[2:3] op_sel:[0,0,0] op_sel_hi:[1,0,0]
    v_pk_fma_f32 v[50:51], v[50:51], v[2:3], v[2:3] op_sel:[0,0,0] op_sel_hi:[1,0,0]
    v_pk_fma_f32 v[52:53], v[52:53], v[2:3], v[2:3] op_sel:[0,0,0] op_sel_hi:[1,0,0]
    v_pk_fma_f32 v[54:55], v[54:55], v[2:3], v[2:3] op_sel:[0,0,0] op_sel_hi:[1,0,0]
    v_rcp_f32 v48, v48
    v_rcp_f32 v49, v49
    buffer_store_dwordx4 v[88:91], v16, s[36:39], s16 offen offset:1024 sc1
    v_rcp_f32 v50, v50
    v_rcp_f32 v51, v51
    v_rcp_f32 v52, v52
    v_rcp_f32 v53, v53
    v_rcp_f32 v54, v54
    v_rcp_f32 v55, v55
    v_pk_mul_f32 v[128:129], v[128:129], v[136:137]
    v_pk_mul_f32 v[130:131], v[130:131], v[138:139]
    v_pk_mul_f32 v[132:133], v[132:133], v[140:141]
    buffer_store_dwordx4 v[104:107], v16, s[36:39], s16 offen offset:2048 sc1
    v_pk_mul_f32 v[134:135], v[134:135], v[142:143]
    v_pk_mul_f32 v[128:129], v[128:129], v[48:49]
    v_pk_mul_f32 v[130:131], v[130:131], v[50:51]
    v_pk_mul_f32 v[132:133], v[132:133], v[52:53]
    v_pk_mul_f32 v[134:135], v[134:135], v[54:55]
    v_cvt_pk_bf16_f32 v136, v128, v129
    v_cvt_pk_bf16_f32 v138, v132, v133
    v_cvt_pk_bf16_f32 v137, v130, v131
    v_cvt_pk_bf16_f32 v139, v134, v135
    v_pk_mul_f32 v[56:57], v[144:145], v[144:145]
    v_pk_mul_f32 v[58:59], v[146:147], v[146:147]
    v_pk_mul_f32 v[60:61], v[148:149], v[148:149]
    v_pk_mul_f32 v[62:63], v[150:151], v[150:151]
    v_pk_fma_f32 v[56:57], v[56:57], v[30:31], v[30:31] op_sel:[0,1,0] op_sel_hi:[1,1,0]
    v_pk_fma_f32 v[58:59], v[58:59], v[30:31], v[30:31] op_sel:[0,1,0] op_sel_hi:[1,1,0]
    v_pk_fma_f32 v[60:61], v[60:61], v[30:31], v[30:31] op_sel:[0,1,0] op_sel_hi:[1,1,0]
    v_pk_fma_f32 v[62:63], v[62:63], v[30:31], v[30:31] op_sel:[0,1,0] op_sel_hi:[1,1,0]
    v_pk_mul_f32 v[56:57], v[56:57], v[144:145]
    v_pk_mul_f32 v[58:59], v[58:59], v[146:147]
    v_pk_mul_f32 v[60:61], v[60:61], v[148:149]
    v_pk_mul_f32 v[62:63], v[62:63], v[150:151]
    v_exp_f32 v56, v56
    v_exp_f32 v57, v57
    buffer_store_dwordx4 v[120:123], v16, s[36:39], s16 offen offset:3072 sc1
    v_exp_f32 v58, v58
    v_exp_f32 v59, v59
    v_exp_f32 v60, v60
    v_exp_f32 v61, v61
    v_exp_f32 v62, v62
    v_exp_f32 v63, v63
    v_pk_fma_f32 v[56:57], v[56:57], v[2:3], v[2:3] op_sel:[0,1,1] op_sel_hi:[1,1,1]
    v_pk_fma_f32 v[58:59], v[58:59], v[2:3], v[2:3] op_sel:[0,1,1] op_sel_hi:[1,1,1]
    v_pk_fma_f32 v[60:61], v[60:61], v[2:3], v[2:3] op_sel:[0,1,1] op_sel_hi:[1,1,1]
    v_pk_fma_f32 v[62:63], v[62:63], v[2:3], v[2:3] op_sel:[0,1,1] op_sel_hi:[1,1,1]
    v_rcp_f32 v56, v56
    v_rcp_f32 v57, v57
    v_rcp_f32 v58, v58
    v_rcp_f32 v59, v59
    v_rcp_f32_e64 v60, v60
    buffer_store_dwordx4 v[136:139], v16, s[36:39], s54 offen offset:0 sc1
    v_rcp_f32 v61, v61
    v_rcp_f32 v62, v62
    v_rcp_f32_e64 v63, v63
    v_pk_mul_f32 v[144:145], v[144:145], v[152:153]
    v_pk_mul_f32 v[146:147], v[146:147], v[154:155]
    v_pk_mul_f32 v[148:149], v[148:149], v[156:157]
    v_pk_mul_f32 v[150:151], v[150:151], v[158:159]
    v_pk_mul_f32 v[144:145], v[144:145], v[56:57]
    v_pk_mul_f32 v[146:147], v[146:147], v[58:59]
    v_pk_mul_f32 v[148:149], v[148:149], v[60:61]
    v_pk_mul_f32 v[150:151], v[150:151], v[62:63]
    v_cvt_pk_bf16_f32 v152, v144, v145
    v_cvt_pk_bf16_f32 v154, v148, v149
    v_cvt_pk_bf16_f32 v153, v146, v147
    v_cvt_pk_bf16_f32 v155, v150, v151
    v_pk_mul_f32 v[48:49], v[160:161], v[160:161]
    v_pk_mul_f32 v[50:51], v[162:163], v[162:163]
    v_pk_mul_f32 v[52:53], v[164:165], v[164:165]
    v_pk_mul_f32 v[54:55], v[166:167], v[166:167]
    v_pk_fma_f32 v[48:49], v[48:49], v[30:31], v[30:31] op_sel:[0,1,0] op_sel_hi:[1,1,0]
    v_pk_fma_f32 v[50:51], v[50:51], v[30:31], v[30:31] op_sel:[0,1,0] op_sel_hi:[1,1,0]
L_qmain_s3:
    s_cbranch_execz L_qmain_ret
    v_pk_fma_f32 v[52:53], v[52:53], v[30:31], v[30:31] op_sel:[0,1,0] op_sel_hi:[1,1,0]
    v_pk_fma_f32 v[54:55], v[54:55], v[30:31], v[30:31] op_sel:[0,1,0] op_sel_hi:[1,1,0]
    v_pk_mul_f32 v[48:49], v[48:49], v[160:161]
    v_pk_mul_f32 v[50:51], v[50:51], v[162:163]
    v_pk_mul_f32 v[52:53], v[52:53], v[164:165]
    v_pk_mul_f32 v[54:55], v[54:55], v[166:167]
    v_exp_f32 v48, v48
    v_exp_f32_e64 v49, v49
    buffer_load_dword v19, v1, s[36:39], s15 offen offset:0 sc1
    v_exp_f32 v50, v50
    v_exp_f32 v51, v51
    v_exp_f32 v52, v52
    v_exp_f32 v53, v53
    v_exp_f32 v54, v54
    v_exp_f32 v55, v55
    v_pk_fma_f32 v[48:49], v[48:49], v[4:5], v[4:5] op_sel:[0,0,0] op_sel_hi:[1,0,0]
    v_pk_fma_f32 v[50:51], v[50:51], v[4:5], v[4:5] op_sel:[0,0,0] op_sel_hi:[1,0,0]
    v_pk_fma_f32 v[52:53], v[52:53], v[4:5], v[4:5] op_sel:[0,0,0] op_sel_hi:[1,0,0]
    v_pk_fma_f32 v[54:55], v[54:55], v[4:5], v[4:5] op_sel:[0,0,0] op_sel_hi:[1,0,0]
    v_rcp_f32 v48, v48
    v_rcp_f32 v49, v49
    v_rcp_f32 v50, v50
    v_rcp_f32 v51, v51
    v_rcp_f32_e64 v52, v52
    buffer_store_dwordx4 v[152:155], v16, s[36:39], s54 offen offset:1024 sc1
    v_rcp_f32 v53, v53
    v_rcp_f32 v54, v54
    v_rcp_f32_e64 v55, v55
    v_pk_mul_f32 v[160:161], v[160:161], v[168:169]
    v_pk_mul_f32 v[162:163], v[162:163], v[170:171]
    v_pk_mul_f32 v[164:165], v[164:165], v[172:173]
    v_pk_mul_f32 v[166:167], v[166:167], v[174:175]
    v_pk_mul_f32 v[160:161], v[160:161], v[48:49]
    v_pk_mul_f32 v[162:163], v[162:163], v[50:51]
    v_pk_mul_f32 v[164:165], v[164:165], v[52:53]
    v_pk_mul_f32 v[166:167], v[166:167], v[54:55]
    v_cvt_pk_bf16_f32 v168, v160, v161
    v_cvt_pk_bf16_f32 v170, v164, v165
    v_cvt_pk_bf16_f32 v169, v162, v163
    v_cvt_pk_bf16_f32 v171, v166, v167
    v_pk_mul_f32 v[56:57], v[176:177], v[176:177]
    v_pk_mul_f32 v[58:59], v[178:179], v[178:179]
    v_pk_mul_f32 v[60:61], v[180:181], v[180:181]
    v_pk_mul_f32 v[62:63], v[182:183], v[182:183]
    v_pk_fma_f32 v[56:57], v[56:57], v[30:31], v[30:31] op_sel:[0,1,0] op_sel_hi:[1,1,0]
    v_pk_fma_f32 v[58:59], v[58:59], v[30:31], v[30:31] op_sel:[0,1,0] op_sel_hi:[1,1,0]
    v_pk_fma_f32 v[60:61], v[60:61], v[30:31], v[30:31] op_sel:[0,1,0] op_sel_hi:[1,1,0]
    v_pk_fma_f32 v[62:63], v[62:63], v[30:31], v[30:31] op_sel:[0,1,0] op_sel_hi:[1,1,0]
    v_pk_mul_f32 v[56:57], v[56:57], v[176:177]
    v_pk_mul_f32 v[58:59], v[58:59], v[178:179]
    v_pk_mul_f32 v[60:61], v[60:61], v[180:181]
    v_pk_mul_f32 v[62:63], v[62:63], v[182:183]
    v_exp_f32 v56, v56
    v_exp_f32 v57, v57
    v_exp_f32 v58, v58
    v_exp_f32 v59, v59
    v_exp_f32 v60, v60
    v_exp_f32 v61, v61
    v_exp_f32 v62, v62
    v_exp_f32 v63, v63
    buffer_store_dwordx4 v[168:171], v16, s[36:39], s54 offen offset:2048 sc1
    v_pk_fma_f32 v[56:57], v[56:57], v[4:5], v[4:5] op_sel:[0,1,1] op_sel_hi:[1,1,1]
    v_pk_fma_f32 v[58:59], v[58:59], v[4:5], v[4:5] op_sel:[0,1,1] op_sel_hi:[1,1,1]
    v_pk_fma_f32 v[60:61], v[60:61], v[4:5], v[4:5] op_sel:[0,1,1] op_sel_hi:[1,1,1]
    v_pk_fma_f32 v[62:63], v[62:63], v[4:5], v[4:5] op_sel:[0,1,1] op_sel_hi:[1,1,1]
    v_rcp_f32 v56, v56
    v_rcp_f32 v57, v57
    v_rcp_f32 v58, v58
    v_rcp_f32 v59, v59
    v_rcp_f32 v60, v60
    v_rcp_f32 v61, v61
    v_rcp_f32 v62, v62
    v_rcp_f32 v63, v63
    v_pk_mul_f32 v[176:177], v[176:177], v[184:185]
    v_pk_mul_f32 v[178:179], v[178:179], v[186:187]
    v_pk_mul_f32 v[180:181], v[180:181], v[188:189]
    v_pk_mul_f32 v[182:183], v[182:183], v[190:191]
    v_pk_mul_f32 v[176:177], v[176:177], v[56:57]
    v_pk_mul_f32 v[178:179], v[178:179], v[58:59]
    v_pk_mul_f32 v[180:181], v[180:181], v[60:61]
    v_pk_mul_f32 v[182:183], v[182:183], v[62:63]
    v_cvt_pk_bf16_f32 v184, v176, v177
    v_cvt_pk_bf16_f32 v186, v180, v181
    v_cvt_pk_bf16_f32 v185, v178, v179
    v_cvt_pk_bf16_f32 v187, v182, v183
    buffer_store_dwordx4 v[184:187], v16, s[36:39], s54 offen offset:3072 sc1
    v_mfma_f32_16x16x32_bf16 v[128:131], v[32:35], a[0:3], 0
    ds_read_b64_tr_b16 v[48:49], v14 offset:8192
    ds_read_b64_tr_b16 v[50:51], v14 offset:9216
    v_mfma_f32_16x16x32_bf16 v[136:139], v[32:35], a[4:7], 0
    ds_read_b64_tr_b16 v[52:53], v15 offset:8192
    s_lshl_b32 s48, s40, 10
    v_mfma_f32_16x16x32_bf16 v[144:147], v[32:35], a[8:11], 0
    ds_read_b64_tr_b16 v[54:55], v15 offset:9216
    v_add_u32 v2, s48, v16
    v_mfma_f32_16x16x32_bf16 v[152:155], v[32:35], a[12:15], 0
    ds_read_b64_tr_b16 v[56:57], v14 offset:12288
    v_xor_b32 v3, 1024, v2
    v_mfma_f32_16x16x32_bf16 v[156:159], v[36:39], a[12:15], 0
    ds_read_b64_tr_b16 v[58:59], v14 offset:13312
    v_xor_b32 v4, 2048, v2
    v_mfma_f32_16x16x32_bf16 v[148:151], v[36:39], a[8:11], 0
    ds_read_b64_tr_b16 v[60:61], v15 offset:12288
    v_xor_b32 v5, 3072, v2
    v_mfma_f32_16x16x32_bf16 v[140:143], v[36:39], a[4:7], 0
    ds_read_b64_tr_b16 v[62:63], v15 offset:13312
    v_mfma_f32_16x16x32_bf16 v[132:135], v[36:39], a[0:3], 0
    s_waitcnt vmcnt(33)
    v_add_u32 v24, 0xffff0000, v24
    ds_read_b64_tr_b16 v[64:65], v24 offset:0
    v_mfma_f32_16x16x32_bf16 v[128:131], v[40:43], a[16:19], v[128:131]
    ds_read_b64_tr_b16 v[66:67], v24 offset:1024
    v_mfma_f32_16x16x32_bf16 v[136:139], v[40:43], a[20:23], v[136:139]
    v_add_u32 v25, 0xffff0000, v25
    ds_read_b64_tr_b16 v[68:69], v25 offset:0
    v_mfma_f32_16x16x32_bf16 v[144:147], v[40:43], a[24:27], v[144:147]
    ds_read_b64_tr_b16 v[70:71], v25 offset:1024
    v_mfma_f32_16x16x32_bf16 v[152:155], v[40:43], a[28:31], v[152:155]
    v_add_u32 v26, 0xffff0000, v26
    ds_read_b64_tr_b16 v[72:73], v26 offset:0
    v_mfma_f32_16x16x32_bf16 v[156:159], v[44:47], a[28:31], v[156:159]
    ds_read_b64_tr_b16 v[74:75], v26 offset:1024
    v_mfma_f32_16x16x32_bf16 v[148:151], v[44:47], a[24:27], v[148:151]
    v_add_u32 v27, 0xffff0000, v27
    ds_read_b64_tr_b16 v[76:77], v27 offset:0
    v_mfma_f32_16x16x32_bf16 v[140:143], v[44:47], a[20:23], v[140:143]
    ds_read_b64_tr_b16 v[78:79], v27 offset:1024
    s_waitcnt lgkmcnt(7)
    v_mfma_f32_16x16x32_bf16 v[132:135], v[44:47], a[16:19], v[132:135]
    s_barrier
    v_mfma_f32_16x16x32_bf16 v[128:131], v[48:51], a[32:35], v[128:131]
    ds_read_b64_tr_b16 v[32:33], v14 offset:16384
    s_add_u32 s84, s100, 163840
    s_and_b32 s84, s84, 229376
    v_mfma_f32_16x16x32_bf16 v[136:139], v[48:51], a[36:39], v[136:139]
    ds_read_b64_tr_b16 v[34:35], v14 offset:17408
    s_add_u32 m0, s50, 0
    v_mfma_f32_16x16x32_bf16 v[144:147], v[48:51], a[40:43], v[144:147]
    ds_read_b64_tr_b16 v[36:37], v15 offset:16384
    s_xor_b32 s84, s84, s4
    v_mfma_f32_16x16x32_bf16 v[152:155], v[48:51], a[44:47], v[152:155]
    buffer_load_dwordx4 v20, s[56:59], s84 offen offset:0 lds
    v_mfma_f32_16x16x32_bf16 v[156:159], v[52:55], a[44:47], v[156:159]
    ds_read_b64_tr_b16 v[38:39], v15 offset:17408
    v_mfma_f32_16x16x32_bf16 v[148:151], v[52:55], a[40:43], v[148:151]
    ds_read_b64_tr_b16 v[40:41], v14 offset:20480
    v_mfma_f32_16x16x32_bf16 v[140:143], v[52:55], a[36:39], v[140:143]
    ds_read_b64_tr_b16 v[42:43], v14 offset:21504
    v_mfma_f32_16x16x32_bf16 v[132:135], v[52:55], a[32:35], v[132:135]
    buffer_load_dwordx4 v21, s[56:59], s84 offen offset:1024 lds
    v_mfma_f32_16x16x32_bf16 v[128:131], v[56:59], a[48:51], v[128:131]
    ds_read_b64_tr_b16 v[44:45], v15 offset:20480
    v_mfma_f32_16x16x32_bf16 v[136:139], v[56:59], a[52:55], v[136:139]
    ds_read_b64_tr_b16 v[46:47], v15 offset:21504
    v_mfma_f32_16x16x32_bf16 v[144:147], v[56:59], a[56:59], v[144:147]
    v_exp_f32_e64 v28, -v12
    v_mfma_f32_16x16x32_bf16 v[152:155], v[56:59], a[60:63], v[152:155]
    buffer_load_dwordx4 v22, s[56:59], s84 offen offset:2048 lds
    v_mfma_f32_16x16x32_bf16 v[156:159], v[60:63], a[60:63], v[156:159]
    v_add_f32 v28, 1.0, v28
    v_min_f32 v28, 0x7f000000, v28
    v_mfma_f32_16x16x32_bf16 v[148:151], v[60:63], a[56:59], v[148:151]
    v_mov_b32_e64 v29, v28
    v_mfma_f32_16x16x32_bf16 v[140:143], v[60:63], a[52:55], v[140:143]
    v_mfma_f32_16x16x32_bf16 v[132:135], v[60:63], a[48:51], v[132:135]
    buffer_load_dwordx4 v23, s[56:59], s84 offen offset:3072 lds
    s_waitcnt lgkmcnt(1)
    v_mfma_f32_16x16x32_bf16 v[128:131], v[32:35], a[64:67], v[128:131]
    ds_read_b64_tr_b16 v[48:49], v14 offset:24576
    s_waitcnt vmcnt(7)
    v_cmp_ne_u32 s[92:93], 0, v19
    s_nop 0
    s_cmp_eq_u64 s[92:93], -1
    s_cbranch_scc0 L_sp2
L_ok2:
    v_lshrrev_b32 v1, 5, v0
    v_lshlrev_b32_e64 v1, 7, v1
    v_mfma_f32_16x16x32_bf16 v[136:139], v[32:35], a[68:71], v[136:139]
    ds_read_b64_tr_b16 v[50:51], v14 offset:25600
    s_cmp_ge_u32 s55, 2
    s_cbranch_scc1 L_nz1
    buffer_load_dwordx4 v[240:243], v16, s[36:39], s14 offen offset:0 sc1
    buffer_load_dwordx4 v[244:247], v16, s[36:39], s14 offen offset:1024 sc1
    buffer_load_dwordx4 v[248:251], v16, s[36:39], s14 offen offset:2048 sc1
    buffer_load_dwordx4 v[252:255], v16, s[36:39], s14 offen offset:3072 sc1
L_nz1:
    v_mfma_f32_16x16x32_bf16 v[144:147], v[32:35], a[72:75], v[144:147]
    buffer_load_dwordx4 v[176:179], v16, s[36:39], s12 offen offset:0 sc1
    ds_read_b64_tr_b16 v[52:53], v15 offset:24576
    v_mfma_f32_16x16x32_bf16 v[152:155], v[32:35], a[76:79], v[152:155]
    ds_read_b64_tr_b16 v[54:55], v15 offset:25600
    v_permlane16_swap_b32 v28, v29
    v_mfma_f32_16x16x32_bf16 v[156:159], v[36:39], a[76:79], v[156:159]
    ds_read_b64_tr_b16 v[56:57], v14 offset:28672
    v_mov_b32 v30, v28
    v_mfma_f32_16x16x32_bf16 v[148:151], v[36:39], a[72:75], v[148:151]
    ds_read_b64_tr_b16 v[58:59], v14 offset:29696
    v_mov_b32_e64 v31, v29
    v_mfma_f32_16x16x32_bf16 v[140:143], v[36:39], a[68:71], v[140:143]
    buffer_load_dwordx4 v[180:183], v16, s[36:39], s12 offen offset:1024 sc1
    v_mfma_f32_16x16x32_bf16 v[132:135], v[36:39], a[64:67], v[132:135]
    ds_read_b64_tr_b16 v[60:61], v15 offset:28672
    v_permlane32_swap_b32 v28, v30
    v_mfma_f32_16x16x32_bf16 v[128:131], v[40:43], a[80:83], v[128:131]
    ds_read_b64_tr_b16 v[62:63], v15 offset:29696
    v_permlane32_swap_b32 v29, v31
    v_mfma_f32_16x16x32_bf16 v[136:139], v[40:43], a[84:87], v[136:139]
    ds_read_b64_tr_b16 v[80:81], v24 offset:16384
    v_mfma_f32_16x16x32_bf16 v[144:147], v[40:43], a[88:91], v[144:147]
    buffer_load_dwordx4 v[184:187], v16, s[36:39], s12 offen offset:2048 sc1
    v_mfma_f32_16x16x32_bf16 v[152:155], v[40:43], a[92:95], v[152:155]
    ds_read_b64_tr_b16 v[82:83], v24 offset:17408
    s_waitcnt lgkmcnt(5)
    v_mfma_f32_16x16x32_bf16 v[156:159], v[44:47], a[92:95], v[156:159]
    ds_read_b64_tr_b16 v[84:85], v25 offset:16384
    v_mfma_f32_16x16x32_bf16 v[148:151], v[44:47], a[88:91], v[148:151]
    ds_read_b64_tr_b16 v[86:87], v25 offset:17408
    v_mfma_f32_16x16x32_bf16 v[140:143], v[44:47], a[84:87], v[140:143]
    buffer_load_dwordx4 v[188:191], v16, s[36:39], s12 offen offset:3072 sc1
    s_waitcnt vmcnt(8) lgkmcnt(4)
    v_mfma_f32_16x16x32_bf16 v[132:135], v[44:47], a[80:83], v[132:135]
    s_barrier
    v_mfma_f32_16x16x32_bf16 v[128:131], v[48:51], a[96:99], v[128:131]
    ds_read_b64_tr_b16 v[32:33], v14 offset:32768
    v_mfma_f32_16x16x32_bf16 v[136:139], v[48:51], a[100:103], v[136:139]
    buffer_store_dword v24, v18, s[36:39], s0 offen sc1
    v_mfma_f32_16x16x32_bf16 v[144:147], v[48:51], a[104:107], v[144:147]
    ds_read_b64_tr_b16 v[34:35], v14 offset:33792
    s_add_u32 s84, s100, 196608
    v_mfma_f32_16x16x32_bf16 v[152:155], v[48:51], a[108:111], v[152:155]
    ds_read_b64_tr_b16 v[36:37], v15 offset:32768
    s_and_b32 s84, s84, 229376
    s_add_u32 m0, s50, 65536
    v_mfma_f32_16x16x32_bf16 v[156:159], v[52:55], a[108:111], v[156:159]
    ds_read_b64_tr_b16 v[38:39], v15 offset:33792
    s_xor_b32 s84, s84, s4
    v_mfma_f32_16x16x32_bf16 v[148:151], v[52:55], a[104:107], v[148:151]
    buffer_load_dwordx4 v20, s[56:59], s84 offen offset:0 lds
    v_mfma_f32_16x16x32_bf16 v[140:143], v[52:55], a[100:103], v[140:143]
    ds_read_b64_tr_b16 v[40:41], v14 offset:36864
    v_mfma_f32_16x16x32_bf16 v[132:135], v[52:55], a[96:99], v[132:135]
    ds_read_b64_tr_b16 v[42:43], v14 offset:37888
    v_mfma_f32_16x16x32_bf16 v[128:131], v[56:59], a[112:115], v[128:131]
    ds_read_b64_tr_b16 v[44:45], v15 offset:36864
    v_mfma_f32_16x16x32_bf16 v[136:139], v[56:59], a[116:119], v[136:139]
    buffer_load_dwordx4 v21, s[56:59], s84 offen offset:1024 lds
    v_mfma_f32_16x16x32_bf16 v[144:147], v[56:59], a[120:123], v[144:147]
    ds_read_b64_tr_b16 v[46:47], v15 offset:37888
    v_mfma_f32_16x16x32_bf16 v[152:155], v[56:59], a[124:127], v[152:155]
    ds_read_b64_tr_b16 v[88:89], v26 offset:16384
    v_mfma_f32_16x16x32_bf16 v[156:159], v[60:63], a[124:127], v[156:159]
    ds_read_b64_tr_b16 v[90:91], v26 offset:17408
    v_mfma_f32_16x16x32_bf16 v[148:151], v[60:63], a[120:123], v[148:151]
    buffer_load_dwordx4 v22, s[56:59], s84 offen offset:2048 lds
    v_mfma_f32_16x16x32_bf16 v[140:143], v[60:63], a[116:119], v[140:143]
    ds_read_b64_tr_b16 v[92:93], v27 offset:16384
    v_mfma_f32_16x16x32_bf16 v[132:135], v[60:63], a[112:115], v[132:135]
    ds_read_b64_tr_b16 v[94:95], v27 offset:17408
    s_waitcnt lgkmcnt(5)
    v_mfma_f32_16x16x32_bf16 v[128:131], v[32:35], a[128:131], v[128:131]
    ds_read_b64_tr_b16 v[48:49], v14 offset:40960
    v_mfma_f32_16x16x32_bf16 v[136:139], v[32:35], a[132:135], v[136:139]
    buffer_load_dwordx4 v23, s[56:59], s84 offen offset:3072 lds
    ds_read_b64_tr_b16 v[50:51], v14 offset:41984
    v_mfma_f32_16x16x32_bf16 v[144:147], v[32:35], a[136:139], v[144:147]
    ds_read_b64_tr_b16 v[52:53], v15 offset:40960
    s_add_u32 s84, s100, 229376
    s_and_b32 s84, s84, 229376
    v_mfma_f32_16x16x32_bf16 v[152:155], v[32:35], a[140:143], v[152:155]
    ds_read_b64_tr_b16 v[54:55], v15 offset:41984
    s_add_u32 m0, s50, 16384
    v_mfma_f32_16x16x32_bf16 v[156:159], v[36:39], a[140:143], v[156:159]
    ds_read_b64_tr_b16 v[56:57], v14 offset:45056
    s_xor_b32 s84, s84, s4
    v_mfma_f32_16x16x32_bf16 v[148:151], v[36:39], a[136:139], v[148:151]
    buffer_load_dwordx4 v20, s[56:59], s84 offen offset:0 lds
    v_mfma_f32_16x16x32_bf16 v[140:143], v[36:39], a[132:135], v[140:143]
    ds_read_b64_tr_b16 v[58:59], v14 offset:46080
    v_mfma_f32_16x16x32_bf16 v[132:135], v[36:39], a[128:131], v[132:135]
    ds_read_b64_tr_b16 v[60:61], v15 offset:45056
    v_mfma_f32_16x16x32_bf16 v[128:131], v[40:43], a[144:147], v[128:131]
    ds_read_b64_tr_b16 v[62:63], v15 offset:46080
    v_mfma_f32_16x16x32_bf16 v[136:139], v[40:43], a[148:151], v[136:139]
    buffer_load_dwordx4 v21, s[56:59], s84 offen offset:1024 lds
    v_mfma_f32_16x16x32_bf16 v[144:147], v[40:43], a[152:155], v[144:147]
    ds_read_b64_tr_b16 v[96:97], v24 offset:32768
    v_mfma_f32_16x16x32_bf16 v[152:155], v[40:43], a[156:159], v[152:155]
    ds_read_b64_tr_b16 v[98:99], v24 offset:33792
    s_waitcnt lgkmcnt(5)
    v_mfma_f32_16x16x32_bf16 v[156:159], v[44:47], a[156:159], v[156:159]
    ds_read_b64_tr_b16 v[100:101], v25 offset:32768
    v_mfma_f32_16x16x32_bf16 v[148:151], v[44:47], a[152:155], v[148:151]
    buffer_load_dwordx4 v22, s[56:59], s84 offen offset:2048 lds
    v_mfma_f32_16x16x32_bf16 v[140:143], v[44:47], a[148:151], v[140:143]
    ds_read_b64_tr_b16 v[102:103], v25 offset:33792
    s_waitcnt lgkmcnt(4)
    v_mfma_f32_16x16x32_bf16 v[132:135], v[44:47], a[144:147], v[132:135]
    s_barrier
    v_mfma_f32_16x16x32_bf16 v[128:131], v[48:51], a[160:163], v[128:131]
    ds_read_b64_tr_b16 v[32:33], v14 offset:49152
    v_mfma_f32_16x16x32_bf16 v[136:139], v[48:51], a[164:167], v[136:139]
    buffer_load_dwordx4 v23, s[56:59], s84 offen offset:3072 lds
    v_mfma_f32_16x16x32_bf16 v[144:147], v[48:51], a[168:171], v[144:147]
    ds_read_b64_tr_b16 v[34:35], v14 offset:50176
    s_add_u32 s84, s100, 0
    v_mfma_f32_16x16x32_bf16 v[152:155], v[48:51], a[172:175], v[152:155]
    ds_read_b64_tr_b16 v[36:37], v15 offset:49152
    s_and_b32 s84, s84, 98304
    v_mfma_f32_16x16x32_bf16 v[156:159], v[52:55], a[172:175], v[156:159]
    ds_read_b64_tr_b16 v[38:39], v15 offset:50176
    s_add_u32 m0, s50, 81920
    v_mfma_f32_16x16x32_bf16 v[148:151], v[52:55], a[168:171], v[148:151]
    ds_read_b64_tr_b16 v[40:41], v14 offset:53248
    s_xor_b32 s84, s84, s5
    v_mfma_f32_16x16x32_bf16 v[140:143], v[52:55], a[164:167], v[140:143]
    buffer_load_dwordx4 v20, s[56:59], s84 offen offset:0 lds
    v_mfma_f32_16x16x32_bf16 v[132:135], v[52:55], a[160:163], v[132:135]
    ds_read_b64_tr_b16 v[42:43], v14 offset:54272
    v_mfma_f32_16x16x32_bf16 v[128:131], v[56:59], a[176:179], v[128:131]
    ds_read_b64_tr_b16 v[44:45], v15 offset:53248
    v_mfma_f32_16x16x32_bf16 v[136:139], v[56:59], a[180:183], v[136:139]
    ds_read_b64_tr_b16 v[46:47], v15 offset:54272
    v_mfma_f32_16x16x32_bf16 v[144:147], v[56:59], a[184:187], v[144:147]
    s_waitcnt vmcnt(12)
    v_add_f32_e64 v176, v176, v180
    v_mfma_f32_16x16x32_bf16 v[152:155], v[56:59], a[188:191], v[152:155]
    buffer_load_dwordx4 v21, s[56:59], s84 offen offset:1024 lds
    v_mfma_f32_16x16x32_bf16 v[156:159], v[60:63], a[188:191], v[156:159]
    v_add_f32 v177, v177, v181
    v_add_f32 v178, v178, v182
    v_mfma_f32_16x16x32_bf16 v[148:151], v[60:63], a[184:187], v[148:151]
    v_add_f32_e64 v179, v179, v183
    v_mfma_f32_16x16x32_bf16 v[140:143], v[60:63], a[180:183], v[140:143]
    s_waitcnt vmcnt(11)
    v_add_f32 v184, v184, v188
    v_mfma_f32_16x16x32_bf16 v[132:135], v[60:63], a[176:179], v[132:135]
    v_add_f32 v185, v185, v189
    v_add_f32 v186, v186, v190
    v_add_f32 v187, v187, v191
    v_add_f32 v176, v176, v184
    v_add_f32 v177, v177, v185
    v_add_f32 v178, v178, v186
    v_add_f32 v179, v179, v187
    v_permlane32_swap_b32 v176, v177
    s_nop 0
    v_permlane32_swap_b32 v178, v179
    v_add_f32 v176, v176, v177
    v_add_f32 v178, v178, v179
    s_nop 1
    v_permlane16_swap_b32 v176, v178
    v_add_f32 v176, v176, v178
    s_nop 1
    v_add_f32_dpp v176, v176, v176 row_ror:8 row_mask:0xf bank_mask:0xf
    s_nop 1
    v_mov_b32_dpp v177, v176 quad_perm:[1,0,3,2] row_mask:0xf bank_mask:0xf
    v_cvt_pk_bf16_f32 v176, v176, v177
    s_nop 1
    v_mov_b32_dpp v177, v176 row_ror:14 row_mask:0xf bank_mask:0xf
    v_mov_b32_dpp v178, v176 row_ror:12 row_mask:0xf bank_mask:0xf
    v_mov_b32_dpp v179, v176 row_ror:10 row_mask:0xf bank_mask:0xf
    s_waitcnt lgkmcnt(0)
    v_mfma_f32_16x16x32_bf16 v[128:131], v[32:35], a[192:195], v[128:131]
    ds_read_b64_tr_b16 v[48:49], v14 offset:57344
    s_cmp_ge_u32 s55, 2
    s_cbranch_scc1 L_nz2
    v_add_f32 v240, v240, v244
    v_add_f32 v241, v241, v245
    v_add_f32 v242, v242, v246
    v_add_f32 v243, v243, v247
    v_add_f32 v248, v248, v252
    v_add_f32 v249, v249, v253
    v_add_f32 v250, v250, v254
    v_add_f32 v251, v251, v255
    v_add_f32 v240, v240, v248
    v_add_f32 v241, v241, v249
    v_add_f32 v242, v242, v250
    v_add_f32 v243, v243, v251
    v_permlane32_swap_b32 v240, v241
    s_nop 0
    v_permlane32_swap_b32 v242, v243
    v_add_f32 v240, v240, v241
    v_add_f32 v242, v242, v243
    s_nop 1
    v_permlane16_swap_b32 v240, v242
    v_add_f32 v240, v240, v242
    s_nop 1
    v_add_f32_dpp v240, v240, v240 row_ror:8 row_mask:0xf bank_mask:0xf
    s_nop 1
    v_mov_b32_dpp v241, v240 quad_perm:[1,0,3,2] row_mask:0xf bank_mask:0xf
    v_cvt_pk_bf16_f32 v240, v240, v241
    s_nop 1
    v_mov_b32_dpp v241, v240 row_ror:14 row_mask:0xf bank_mask:0xf
    v_mov_b32_dpp v242, v240 row_ror:12 row_mask:0xf bank_mask:0xf
    v_mov_b32_dpp v243, v240 row_ror:10 row_mask:0xf bank_mask:0xf
    buffer_store_dwordx4 v[240:243], v17, s[36:39], s13 offen offset:64 sc1
L_nz2:
    v_mfma_f32_16x16x32_bf16 v[136:139], v[32:35], a[196:199], v[136:139]
    buffer_store_dwordx4 v[176:179], v17, s[36:39], s13 offen sc1
    ds_read_b64_tr_b16 v[50:51], v14 offset:58368
    v_mfma_f32_16x16x32_bf16 v[144:147], v[32:35], a[200:203], v[144:147]
    ds_read_b64_tr_b16 v[52:53], v15 offset:57344
    s_lshl_b32 s17, s85, 12
    v_mfma_f32_16x16x32_bf16 v[152:155], v[32:35], a[204:207], v[152:155]
    ds_read_b64_tr_b16 v[54:55], v15 offset:58368
    v_bfe_u32 v163, v0, 2, 2
    v_mfma_f32_16x16x32_bf16 v[156:159], v[36:39], a[204:207], v[156:159]
    ds_read_b64_tr_b16 v[56:57], v14 offset:61440
    v_and_b32 v165, 16, v0
    v_mfma_f32_16x16x32_bf16 v[148:151], v[36:39], a[200:203], v[148:151]
    buffer_load_dwordx4 v22, s[56:59], s84 offen offset:2048 lds
    v_mfma_f32_16x16x32_bf16 v[140:143], v[36:39], a[196:199], v[140:143]
    ds_read_b64_tr_b16 v[58:59], v14 offset:62464
    v_lshlrev_b32_e64 v165, 3, v165
    v_mfma_f32_16x16x32_bf16 v[132:135], v[36:39], a[192:195], v[132:135]
    ds_read_b64_tr_b16 v[60:61], v15 offset:61440
    v_lshl_add_u32 v163, v163, 8, v165
    v_mfma_f32_16x16x32_bf16 v[128:131], v[40:43], a[208:211], v[128:131]
    ds_read_b64_tr_b16 v[62:63], v15 offset:62464
    v_and_b32_e64 v166, 3, v0
    v_mfma_f32_16x16x32_bf16 v[136:139], v[40:43], a[212:215], v[136:139]
    buffer_load_dwordx4 v23, s[56:59], s84 offen offset:3072 lds
    v_mfma_f32_16x16x32_bf16 v[144:147], v[40:43], a[216:219], v[144:147]
    ds_read_b64_tr_b16 v[104:105], v26 offset:32768
    s_add_u32 s84, s100, 32768
    s_and_b32 s84, s84, 98304
    v_mfma_f32_16x16x32_bf16 v[152:155], v[40:43], a[220:223], v[152:155]
    ds_read_b64_tr_b16 v[106:107], v26 offset:33792
    s_add_u32 m0, s50, 32768
    v_mfma_f32_16x16x32_bf16 v[156:159], v[44:47], a[220:223], v[156:159]
    ds_read_b64_tr_b16 v[108:109], v27 offset:32768
    s_xor_b32 s84, s84, s5
    v_mfma_f32_16x16x32_bf16 v[148:151], v[44:47], a[216:219], v[148:151]
    buffer_load_dwordx4 v20, s[56:59], s84 offen offset:0 lds
    v_mfma_f32_16x16x32_bf16 v[140:143], v[44:47], a[212:215], v[140:143]
    ds_read_b64_tr_b16 v[110:111], v27 offset:33792
    s_waitcnt lgkmcnt(4)
    v_mfma_f32_16x16x32_bf16 v[132:135], v[44:47], a[208:211], v[132:135]
    s_barrier
    v_mfma_f32_16x16x32_bf16 v[128:131], v[48:51], a[224:227], v[128:131]
    ds_read_b64_tr_b16 v[112:113], v24 offset:49152
    v_lshl_add_u32 v163, v166, 4, v163
    v_mfma_f32_16x16x32_bf16 v[136:139], v[48:51], a[228:231], v[136:139]
    buffer_load_dwordx4 v21, s[56:59], s84 offen offset:1024 lds
    v_mfma_f32_16x16x32_bf16 v[144:147], v[48:51], a[232:235], v[144:147]
    ds_read_b64_tr_b16 v[114:115], v24 offset:50176
    v_mov_b32 v164, 0x7ffffff0
    v_mfma_f32_16x16x32_bf16 v[152:155], v[48:51], a[236:239], v[152:155]
    ds_read_b64_tr_b16 v[116:117], v25 offset:49152
    v_and_b32 v166, 32, v0
    v_mfma_f32_16x16x32_bf16 v[156:159], v[52:55], a[236:239], v[156:159]
    ds_read_b64_tr_b16 v[118:119], v25 offset:50176
    v_lshl_add_u32 v161, v166, 6, v163
    v_mfma_f32_16x16x32_bf16 v[148:151], v[52:55], a[232:235], v[148:151]
    buffer_load_dwordx4 v22, s[56:59], s84 offen offset:2048 lds
    v_mfma_f32_16x16x32_bf16 v[140:143], v[52:55], a[228:231], v[140:143]
    ds_read_b64_tr_b16 v[120:121], v26 offset:49152
    v_lshrrev_b32_e64 v163, 5, v0
    v_mfma_f32_16x16x32_bf16 v[132:135], v[52:55], a[224:227], v[132:135]
    ds_read_b64_tr_b16 v[122:123], v26 offset:50176
    v_and_b32_e64 v166, 1, v0
    v_mfma_f32_16x16x32_bf16 v[128:131], v[56:59], a[240:243], v[128:131]
    ds_read_b64_tr_b16 v[124:125], v27 offset:49152
    v_cmp_eq_u32_e64 vcc, v163, v166
    v_mfma_f32_16x16x32_bf16 v[136:139], v[56:59], a[244:247], v[136:139]
    buffer_load_dwordx4 v23, s[56:59], s84 offen offset:3072 lds
    v_mfma_f32_16x16x32_bf16 v[144:147], v[56:59], a[248:251], v[144:147]
    ds_read_b64_tr_b16 v[126:127], v27 offset:50176
    s_waitcnt lgkmcnt(5)
    s_add_u32 s84, s100, 65536
    v_mfma_f32_16x16x32_bf16 v[152:155], v[56:59], a[252:255], v[152:155]
    s_and_b32 s84, s84, 98304
    s_add_u32 m0, s50, 98304
    v_mfma_f32_16x16x32_bf16 v[156:159], v[60:63], a[252:255], v[156:159]
    s_xor_b32 s84, s84, s5
    v_lshl_add_u32 v163, v163, 5, v165
    v_mfma_f32_16x16x32_bf16 v[148:151], v[60:63], a[248:251], v[148:151]
    buffer_load_dwordx4 v20, s[56:59], s84 offen offset:0 lds
    v_mfma_f32_16x16x32_bf16 v[140:143], v[60:63], a[244:247], v[140:143]
    v_add_u32 v163, 64, v163
    v_cndmask_b32 v162, v164, v163, vcc
    v_mfma_f32_16x16x32_bf16 v[132:135], v[60:63], a[240:243], v[132:135]
    v_mov_b32 v168, 0
    v_mov_b32 v169, 0
    v_mov_b32 v170, 0
    v_mov_b32 v171, 0
    v_mov_b32 v172, 0
    v_mov_b32 v173, 0
    v_mov_b32 v174, 0
    v_mov_b32 v175, 0
.p2align 3
    v_cvt_pk_bf16_f32 v6, v128, v129
    v_cvt_pk_bf16_f32 v7, v130, v131
    v_cvt_pk_bf16_f32 v8, v132, v133
    v_cvt_pk_bf16_f32 v9, v134, v135
    s_nop 1
    v_mfma_f32_16x16x32_bf16 v[32:35], v[224:227], v[6:9], 0
    v_mfma_f32_16x16x32_bf16 v[36:39], v[228:231], v[6:9], 0
    v_mfma_f32_16x16x32_bf16 v[40:43], v[232:235], v[6:9], 0
    v_mfma_f32_16x16x32_bf16 v[44:47], v[236:239], v[6:9], 0
    buffer_load_dword v19, v1, s[36:39], s1 offen offset:0 sc1
    v_cvt_pk_bf16_f32 v6, v136, v137
    v_cvt_pk_bf16_f32 v7, v138, v139
    v_cvt_pk_bf16_f32 v8, v140, v141
    v_cvt_pk_bf16_f32 v9, v142, v143
    v_max3_f32 v164, v32, v33, v34
    v_max3_f32 v164, v164, v35, v36
    v_max3_f32 v164, v164, v37, v38
    v_max3_f32 v164, v164, v39, v40
    v_max3_f32 v164, v164, v41, v42
    buffer_load_dwordx4 v21, s[56:59], s84 offen offset:1024 lds
    v_max3_f32 v164, v164, v43, v44
    v_max3_f32 v164, v164, v45, v46
    v_max_f32 v164, v164, v47
    v_mul_f32 v164, 0xbfb8aa3b, v164
    v_pk_fma_f32 v[32:33], v[32:33], s[88:89], v[164:165] op_sel_hi:[1,1,0]
    v_pk_fma_f32 v[34:35], v[34:35], s[88:89], v[164:165] op_sel_hi:[1,1,0]
    v_pk_fma_f32 v[36:37], v[36:37], s[88:89], v[164:165] op_sel_hi:[1,1,0]
    v_pk_fma_f32 v[38:39], v[38:39], s[88:89], v[164:165] op_sel_hi:[1,1,0]
    v_pk_fma_f32 v[40:41], v[40:41], s[88:89], v[164:165] op_sel_hi:[1,1,0]
    v_pk_fma_f32 v[42:43], v[42:43], s[88:89], v[164:165] op_sel_hi:[1,1,0]
    v_pk_fma_f32 v[44:45], v[44:45], s[88:89], v[164:165] op_sel_hi:[1,1,0]
    v_pk_fma_f32 v[46:47], v[46:47], s[88:89], v[164:165] op_sel_hi:[1,1,0]
    v_mfma_f32_16x16x32_bf16 v[48:51], v[224:227], v[6:9], 0
    buffer_load_dwordx4 v22, s[56:59], s84 offen offset:2048 lds
    v_exp_f32 v32, v32
    v_exp_f32 v33, v33
    v_exp_f32_e64 v34, v34
    v_mfma_f32_16x16x32_bf16 v[52:55], v[228:231], v[6:9], 0
    v_exp_f32 v35, v35
    v_exp_f32 v36, v36
    v_exp_f32_e64 v37, v37
    v_mfma_f32_16x16x32_bf16 v[56:59], v[232:235], v[6:9], 0
    buffer_load_dwordx4 v23, s[56:59], s84 offen offset:3072 lds
    v_exp_f32 v38, v38
    v_exp_f32 v39, v39
    v_exp_f32_e64 v40, v40
    v_mfma_f32_16x16x32_bf16 v[60:63], v[236:239], v[6:9], 0
    v_exp_f32 v41, v41
    v_exp_f32 v42, v42
    v_exp_f32 v43, v43
    v_exp_f32 v44, v44
    v_exp_f32 v45, v45
    v_exp_f32 v46, v46
    v_exp_f32_e64 v47, v47
    s_add_u32 s84, s100, 98304
    s_and_b32 s84, s84, 98304
    s_add_u32 m0, s50, 49152
    s_xor_b32 s84, s84, s5
    buffer_load_dwordx4 v20, s[56:59], s84 offen offset:0 lds
    v_pk_add_f32 v[164:165], v[32:33], v[34:35]
    v_pk_add_f32 v[166:167], v[36:37], v[38:39]
    v_pk_add_f32 v[164:165], v[164:165], v[40:41]
    v_pk_add_f32 v[166:167], v[166:167], v[42:43]
    v_pk_add_f32 v[164:165], v[164:165], v[44:45]
    v_pk_add_f32 v[166:167], v[166:167], v[46:47]
    v_pk_add_f32 v[164:165], v[164:165], v[166:167]
    v_add_f32 v164, v164, v165
    v_rcp_f32 v164, v164
    s_nop 0
    v_pk_mul_f32 v[32:33], v[32:33], v[164:165] op_sel_hi:[1,0]
    v_pk_mul_f32 v[34:35], v[34:35], v[164:165] op_sel_hi:[1,0]
    v_pk_mul_f32 v[36:37], v[36:37], v[164:165] op_sel_hi:[1,0]
    v_pk_mul_f32 v[38:39], v[38:39], v[164:165] op_sel_hi:[1,0]
    buffer_load_dwordx4 v21, s[56:59], s84 offen offset:1024 lds
    v_pk_mul_f32 v[40:41], v[40:41], v[164:165] op_sel_hi:[1,0]
    v_pk_mul_f32 v[42:43], v[42:43], v[164:165] op_sel_hi:[1,0]
    v_pk_mul_f32 v[44:45], v[44:45], v[164:165] op_sel_hi:[1,0]
    v_pk_mul_f32 v[46:47], v[46:47], v[164:165] op_sel_hi:[1,0]
    v_cvt_pk_bf16_f32 v128, v32, v33
    v_cvt_pk_bf16_f32 v129, v34, v35
    v_cvt_pk_bf16_f32 v130, v36, v37
    v_cvt_pk_bf16_f32 v131, v38, v39
    v_cvt_pk_bf16_f32 v132, v40, v41
    v_cvt_pk_bf16_f32 v133, v42, v43
    v_cvt_pk_bf16_f32 v134, v44, v45
    v_cvt_pk_bf16_f32 v135, v46, v47
    v_cvt_pk_bf16_f32 v6, v144, v145
    v_cvt_pk_bf16_f32 v7, v146, v147
    v_cvt_pk_bf16_f32 v8, v148, v149
    v_cvt_pk_bf16_f32 v9, v150, v151
    v_max3_f32 v164, v48, v49, v50
    v_max3_f32 v164, v164, v51, v52
    v_max3_f32 v164, v164, v53, v54
    v_max3_f32 v164, v164, v55, v56
    v_max3_f32 v164, v164, v57, v58
    buffer_load_dwordx4 v22, s[56:59], s84 offen offset:2048 lds
    v_max3_f32 v164, v164, v59, v60
    v_max3_f32 v164, v164, v61, v62
L_qmain_s4:
    s_cbranch_execz L_qmain_ret
    v_max_f32 v164, v164, v63
    v_mul_f32 v164, 0xbfb8aa3b, v164
    v_pk_fma_f32 v[48:49], v[48:49], s[88:89], v[164:165] op_sel_hi:[1,1,0]
    v_pk_fma_f32 v[50:51], v[50:51], s[88:89], v[164:165] op_sel_hi:[1,1,0]
    v_pk_fma_f32 v[52:53], v[52:53], s[88:89], v[164:165] op_sel_hi:[1,1,0]
    v_pk_fma_f32 v[54:55], v[54:55], s[88:89], v[164:165] op_sel_hi:[1,1,0]
    v_pk_fma_f32 v[56:57], v[56:57], s[88:89], v[164:165] op_sel_hi:[1,1,0]
    v_pk_fma_f32 v[58:59], v[58:59], s[88:89], v[164:165] op_sel_hi:[1,1,0]
    v_pk_fma_f32 v[60:61], v[60:61], s[88:89], v[164:165] op_sel_hi:[1,1,0]
    v_pk_fma_f32 v[62:63], v[62:63], s[88:89], v[164:165] op_sel_hi:[1,1,0]
    v_mfma_f32_16x16x32_bf16 v[32:35], v[224:227], v[6:9], 0
    buffer_load_dwordx4 v23, s[56:59], s84 offen offset:3072 lds
    v_exp_f32 v48, v48
    v_exp_f32 v49, v49
    v_exp_f32_e64 v50, v50
    v_mfma_f32_16x16x32_bf16 v[36:39], v[228:231], v[6:9], 0
    v_exp_f32 v51, v51
    v_exp_f32 v52, v52
    v_exp_f32 v53, v53
    s_waitcnt vmcnt(7)
    v_cmp_ne_u32 s[92:93], 0, v19
    s_nop 0
    s_cmp_eq_u64 s[92:93], -1
    s_cbranch_scc0 L_sp3
L_ok3:
    s_add_u32 s86, s101, 0
    s_and_b32 s86, s86, 28672
    s_xor_b32 s86, s86, s8
    v_mfma_f32_16x16x32_bf16 v[40:43], v[232:235], v[6:9], 0
    buffer_load_dwordx4 a[0:3], v2, s[36:39], s86 offen sc1
    v_exp_f32 v54, v54
    v_exp_f32 v55, v55
    v_exp_f32 v56, v56
    v_mfma_f32_16x16x32_bf16 v[44:47], v[236:239], v[6:9], 0
    v_exp_f32 v57, v57
    v_exp_f32 v58, v58
    v_exp_f32 v59, v59
    v_exp_f32 v60, v60
    v_exp_f32 v61, v61
    v_exp_f32 v62, v62
    v_exp_f32_e64 v63, v63
    buffer_load_dwordx4 a[4:7], v3, s[36:39], s86 offen sc1
    v_pk_add_f32 v[164:165], v[48:49], v[50:51]
    v_pk_add_f32 v[166:167], v[52:53], v[54:55]
    v_pk_add_f32 v[164:165], v[164:165], v[56:57]
    v_pk_add_f32 v[166:167], v[166:167], v[58:59]
    v_pk_add_f32 v[164:165], v[164:165], v[60:61]
    v_pk_add_f32 v[166:167], v[166:167], v[62:63]
    v_pk_add_f32 v[164:165], v[164:165], v[166:167]
    v_add_f32 v164, v164, v165
    v_rcp_f32_e64 v164, v164
    s_nop 0
    v_pk_mul_f32 v[48:49], v[48:49], v[164:165] op_sel_hi:[1,0]
    v_pk_mul_f32 v[50:51], v[50:51], v[164:165] op_sel_hi:[1,0]
    v_pk_mul_f32 v[52:53], v[52:53], v[164:165] op_sel_hi:[1,0]
    v_pk_mul_f32 v[54:55], v[54:55], v[164:165] op_sel_hi:[1,0]
    buffer_load_dwordx4 a[8:11], v4, s[36:39], s86 offen sc1
    v_pk_mul_f32 v[56:57], v[56:57], v[164:165] op_sel_hi:[1,0]
    v_pk_mul_f32 v[58:59], v[58:59], v[164:165] op_sel_hi:[1,0]
    v_pk_mul_f32 v[60:61], v[60:61], v[164:165] op_sel_hi:[1,0]
    v_pk_mul_f32 v[62:63], v[62:63], v[164:165] op_sel_hi:[1,0]
    v_cvt_pk_bf16_f32 v136, v48, v49
    v_cvt_pk_bf16_f32 v137, v50, v51
    v_cvt_pk_bf16_f32 v138, v52, v53
    v_cvt_pk_bf16_f32 v139, v54, v55
    v_cvt_pk_bf16_f32 v140, v56, v57
    v_cvt_pk_bf16_f32 v141, v58, v59
    v_cvt_pk_bf16_f32 v142, v60, v61
    v_cvt_pk_bf16_f32 v143, v62, v63
    v_cvt_pk_bf16_f32 v6, v152, v153
    v_cvt_pk_bf16_f32 v7, v154, v155
    v_cvt_pk_bf16_f32 v8, v156, v157
    buffer_load_dwordx4 a[12:15], v5, s[36:39], s86 offen sc1
    v_cvt_pk_bf16_f32 v9, v158, v159
    v_max3_f32 v164, v32, v33, v34
    v_max3_f32 v164, v164, v35, v36
    v_max3_f32 v164, v164, v37, v38
    v_max3_f32 v164, v164, v39, v40
    v_max3_f32 v164, v164, v41, v42
    v_max3_f32 v164, v164, v43, v44
    v_max3_f32 v164, v164, v45, v46
    v_max_f32_e64 v164, v164, v47
    v_mul_f32 v164, 0xbfb8aa3b, v164
    v_pk_fma_f32 v[32:33], v[32:33], s[88:89], v[164:165] op_sel_hi:[1,1,0]
    v_pk_fma_f32 v[34:35], v[34:35], s[88:89], v[164:165] op_sel_hi:[1,1,0]
    buffer_load_dwordx4 v[176:179], v161, s[36:39], s17 offen offset:0 sc1
    v_pk_fma_f32 v[36:37], v[36:37], s[88:89], v[164:165] op_sel_hi:[1,1,0]
    v_pk_fma_f32 v[38:39], v[38:39], s[88:89], v[164:165] op_sel_hi:[1,1,0]
    v_pk_fma_f32 v[40:41], v[40:41], s[88:89], v[164:165] op_sel_hi:[1,1,0]
    v_pk_fma_f32 v[42:43], v[42:43], s[88:89], v[164:165] op_sel_hi:[1,1,0]
    v_pk_fma_f32 v[44:45], v[44:45], s[88:89], v[164:165] op_sel_hi:[1,1,0]
    v_pk_fma_f32 v[46:47], v[46:47], s[88:89], v[164:165] op_sel_hi:[1,1,0]
    v_mfma_f32_16x16x32_bf16 v[48:51], v[224:227], v[6:9], 0
    buffer_load_dwordx4 v[180:183], v161, s[36:39], s17 offen offset:1024 sc1
    v_exp_f32 v32, v32
    v_exp_f32 v33, v33
    v_exp_f32_e64 v34, v34
    v_mfma_f32_16x16x32_bf16 v[52:55], v[228:231], v[6:9], 0
    v_exp_f32 v35, v35
    v_exp_f32 v36, v36
    v_exp_f32_e64 v37, v37
    v_mfma_f32_16x16x32_bf16 v[56:59], v[232:235], v[6:9], 0
    buffer_load_dwordx4 v[184:187], v162, s[36:39], s17 offen offset:0 sc1
    v_exp_f32 v38, v38
    v_exp_f32 v39, v39
    v_exp_f32_e64 v40, v40
    v_mfma_f32_16x16x32_bf16 v[60:63], v[236:239], v[6:9], 0
    v_exp_f32 v41, v41
    v_exp_f32 v42, v42
    v_exp_f32 v43, v43
    v_exp_f32 v44, v44
    v_exp_f32 v45, v45
    v_exp_f32 v46, v46
    v_exp_f32_e64 v47, v47
    buffer_load_dwordx4 v[188:191], v162, s[36:39], s17 offen offset:16 sc1
    v_pk_add_f32 v[164:165], v[32:33], v[34:35]
    v_pk_add_f32 v[166:167], v[36:37], v[38:39]
    v_pk_add_f32 v[164:165], v[164:165], v[40:41]
    v_pk_add_f32 v[166:167], v[166:167], v[42:43]
    v_pk_add_f32 v[164:165], v[164:165], v[44:45]
    v_pk_add_f32 v[166:167], v[166:167], v[46:47]
    v_pk_add_f32 v[164:165], v[164:165], v[166:167]
    v_add_f32 v164, v164, v165
    v_rcp_f32_e64 v164, v164
    s_nop 0
    v_pk_mul_f32 v[32:33], v[32:33], v[164:165] op_sel_hi:[1,0]
    v_pk_mul_f32 v[34:35], v[34:35], v[164:165] op_sel_hi:[1,0]
    v_pk_mul_f32 v[36:37], v[36:37], v[164:165] op_sel_hi:[1,0]
    v_pk_mul_f32 v[38:39], v[38:39], v[164:165] op_sel_hi:[1,0]
    v_pk_mul_f32 v[40:41], v[40:41], v[164:165] op_sel_hi:[1,0]
    v_pk_mul_f32 v[42:43], v[42:43], v[164:165] op_sel_hi:[1,0]
    s_add_u32 s86, s101, 4096
    s_and_b32 s86, s86, 28672
    s_xor_b32 s86, s86, s8
    buffer_load_dwordx4 a[16:19], v2, s[36:39], s86 offen sc1
    v_pk_mul_f32 v[44:45], v[44:45], v[164:165] op_sel_hi:[1,0]
    v_pk_mul_f32 v[46:47], v[46:47], v[164:165] op_sel_hi:[1,0]
    v_cvt_pk_bf16_f32 v144, v32, v33
    v_cvt_pk_bf16_f32 v145, v34, v35
    v_cvt_pk_bf16_f32 v146, v36, v37
    v_cvt_pk_bf16_f32 v147, v38, v39
    v_cvt_pk_bf16_f32 v148, v40, v41
    v_cvt_pk_bf16_f32 v149, v42, v43
    v_cvt_pk_bf16_f32 v150, v44, v45
    v_cvt_pk_bf16_f32 v151, v46, v47
    v_max3_f32 v164, v48, v49, v50
    v_max3_f32 v164, v164, v51, v52
    v_max3_f32 v164, v164, v53, v54
    v_max3_f32 v164, v164, v55, v56
    v_max3_f32 v164, v164, v57, v58
    v_max3_f32 v164, v164, v59, v60
    v_max3_f32 v164, v164, v61, v62
    v_max_f32 v164, v164, v63
    v_mul_f32 v164, 0xbfb8aa3b, v164
    v_pk_fma_f32 v[48:49], v[48:49], s[88:89], v[164:165] op_sel_hi:[1,1,0]
    v_pk_fma_f32 v[50:51], v[50:51], s[88:89], v[164:165] op_sel_hi:[1,1,0]
    v_pk_fma_f32 v[52:53], v[52:53], s[88:89], v[164:165] op_sel_hi:[1,1,0]
    v_pk_fma_f32 v[54:55], v[54:55], s[88:89], v[164:165] op_sel_hi:[1,1,0]
    v_pk_fma_f32 v[56:57], v[56:57], s[88:89], v[164:165] op_sel_hi:[1,1,0]
    v_pk_fma_f32 v[58:59], v[58:59], s[88:89], v[164:165] op_sel_hi:[1,1,0]
    v_pk_fma_f32 v[60:61], v[60:61], s[88:89], v[164:165] op_sel_hi:[1,1,0]
    v_pk_fma_f32 v[62:63], v[62:63], s[88:89], v[164:165] op_sel_hi:[1,1,0]
    v_exp_f32_e64 v48, v48
    buffer_load_dwordx4 a[20:23], v3, s[36:39], s86 offen sc1
    v_exp_f32 v49, v49
    v_exp_f32 v50, v50
    v_exp_f32 v51, v51
    v_exp_f32 v52, v52
    v_exp_f32 v53, v53
    v_exp_f32 v54, v54
    v_exp_f32_e64 v55, v55
    buffer_load_dwordx4 a[24:27], v4, s[36:39], s86 offen sc1
    v_exp_f32 v56, v56
    v_exp_f32 v57, v57
    v_exp_f32 v58, v58
    v_exp_f32 v59, v59
    v_exp_f32 v60, v60
    v_exp_f32 v61, v61
    v_exp_f32 v62, v62
    v_exp_f32 v63, v63
    v_pk_add_f32 v[164:165], v[48:49], v[50:51]
    v_pk_add_f32 v[166:167], v[52:53], v[54:55]
    v_pk_add_f32 v[164:165], v[164:165], v[56:57]
    v_pk_add_f32 v[166:167], v[166:167], v[58:59]
    v_pk_add_f32 v[164:165], v[164:165], v[60:61]
    v_pk_add_f32 v[166:167], v[166:167], v[62:63]
    v_pk_add_f32 v[164:165], v[164:165], v[166:167]
    v_add_f32 v164, v164, v165
    v_rcp_f32_e64 v164, v164
    s_nop 0
    v_pk_mul_f32 v[48:49], v[48:49], v[164:165] op_sel_hi:[1,0]
    v_pk_mul_f32 v[50:51], v[50:51], v[164:165] op_sel_hi:[1,0]
    v_pk_mul_f32 v[52:53], v[52:53], v[164:165] op_sel_hi:[1,0]
    v_pk_mul_f32 v[54:55], v[54:55], v[164:165] op_sel_hi:[1,0]
    buffer_load_dwordx4 a[28:31], v5, s[36:39], s86 offen sc1
    v_pk_mul_f32 v[56:57], v[56:57], v[164:165] op_sel_hi:[1,0]
    v_pk_mul_f32 v[58:59], v[58:59], v[164:165] op_sel_hi:[1,0]
    v_pk_mul_f32 v[60:61], v[60:61], v[164:165] op_sel_hi:[1,0]
    v_pk_mul_f32 v[62:63], v[62:63], v[164:165] op_sel_hi:[1,0]
    v_cvt_pk_bf16_f32 v152, v48, v49
    v_cvt_pk_bf16_f32 v153, v50, v51
    v_cvt_pk_bf16_f32 v154, v52, v53
    v_cvt_pk_bf16_f32 v155, v54, v55
    v_cvt_pk_bf16_f32 v156, v56, v57
    v_cvt_pk_bf16_f32 v157, v58, v59
    v_cvt_pk_bf16_f32 v158, v60, v61
    v_cvt_pk_bf16_f32 v159, v62, v63
    s_lshl_b32 s48, s44, 13
    s_sub_u32 s54, s54, s48
    s_add_u32 s54, s54, 221184
    s_waitcnt vmcnt(7)
    v_max3_u32 v164, v176, v177, v178
    s_waitcnt vmcnt(6)
    v_max3_u32 v164, v164, v179, v180
    v_max3_u32 v164, v164, v181, v182
    s_waitcnt vmcnt(5)
    v_max3_u32 v164, v164, v183, v184
    v_max3_u32 v164, v164, v185, v186
    s_waitcnt vmcnt(4)
    v_max3_u32 v164, v164, v187, v188
    v_max3_u32 v164, v164, v189, v190
    v_max_u32_e64 v164, v164, v191
    v_cmp_ne_u32 s[92:93], -1, v164
    s_nop 0
    s_cmp_eq_u64 s[92:93], -1
    s_cbranch_scc0 L_spkv
L_okkv:
    s_mov_b32 exec_hi, 0
    v_swap_b32 v168, v176
    v_swap_b32 v169, v177
    v_swap_b32 v170, v178
    v_swap_b32 v171, v179
    v_swap_b32 v172, v180
    v_swap_b32 v173, v181
    v_swap_b32 v174, v182
    v_swap_b32 v175, v183
    s_mov_b32 exec_hi, -1
    v_mfma_f32_16x16x32_bf16 v[40:43], v[184:187], v[128:131], 0
    s_add_u32 s86, s101, 8192
    s_and_b32 s86, s86, 28672
    s_xor_b32 s86, s86, s8
    v_mfma_f32_16x16x32_bf16 v[32:35], v[168:171], v[128:131], 0
    buffer_load_dwordx4 a[32:35], v2, s[36:39], s86 offen sc1
    v_mfma_f32_16x16x32_bf16 v[36:39], v[176:179], v[128:131], 0
    v_mfma_f32_16x16x32_bf16 v[40:43], v[188:191], v[132:135], v[40:43]
    v_mfma_f32_16x16x32_bf16 v[32:35], v[172:175], v[132:135], v[32:35]
    v_mfma_f32_16x16x32_bf16 v[36:39], v[180:183], v[132:135], v[36:39]
    buffer_load_dwordx4 a[36:39], v3, s[36:39], s86 offen sc1
    v_mfma_f32_16x16x32_bf16 v[56:59], v[184:187], v[136:139], 0
    v_mfma_f32_16x16x32_bf16 v[48:51], v[168:171], v[136:139], 0
    v_mfma_f32_16x16x32_bf16 v[52:55], v[176:179], v[136:139], 0
    v_mfma_f32_16x16x32_bf16 v[56:59], v[188:191], v[140:143], v[56:59]
    s_nop 0
    v_add_f32 v40, 0x358637bd, v40
    v_add_f32 v41, 0x358637bd, v41
    v_mul_f32 v40, v40, v28
    v_mul_f32_e64 v41, v41, v28
    buffer_load_dwordx4 a[40:43], v4, s[36:39], s86 offen sc1
    v_mfma_f32_16x16x32_bf16 v[48:51], v[172:175], v[140:143], v[48:51]
    v_rcp_f32 v40, v40
    v_rcp_f32 v41, v41
    v_mul_f32_e64 v32, v32, v40
    v_mfma_f32_16x16x32_bf16 v[52:55], v[180:183], v[140:143], v[52:55]
    v_mul_f32 v33, v33, v40
    v_mul_f32 v34, v34, v40
    v_mul_f32 v35, v35, v40
    v_mul_f32 v36, v36, v41
    v_mul_f32 v37, v37, v41
    v_mul_f32 v38, v38, v41
    v_mul_f32_e64 v39, v39, v41
    v_cvt_pk_bf16_f32 v224, v32, v33
    v_cvt_pk_bf16_f32 v225, v34, v35
    v_cvt_pk_bf16_f32 v226, v36, v37
    v_cvt_pk_bf16_f32 v227, v38, v39
    v_mfma_f32_16x16x32_bf16 v[40:43], v[184:187], v[144:147], 0
    buffer_store_dwordx4 v[224:227], v16, s[36:39], s54 offen offset:0 sc1
    v_mfma_f32_16x16x32_bf16 v[32:35], v[168:171], v[144:147], 0
    v_mfma_f32_16x16x32_bf16 v[36:39], v[176:179], v[144:147], 0
    v_mfma_f32_16x16x32_bf16 v[40:43], v[188:191], v[148:151], v[40:43]
    v_add_f32 v56, 0x358637bd, v56
    v_add_f32 v57, 0x358637bd, v57
    v_mul_f32 v56, v56, v29
    v_mul_f32 v57, v57, v29
    buffer_load_dwordx4 a[44:47], v5, s[36:39], s86 offen sc1
    v_mfma_f32_16x16x32_bf16 v[32:35], v[172:175], v[148:151], v[32:35]
    v_rcp_f32 v56, v56
    v_rcp_f32 v57, v57
    v_mul_f32_e64 v48, v48, v56
    v_mfma_f32_16x16x32_bf16 v[36:39], v[180:183], v[148:151], v[36:39]
    v_mul_f32 v49, v49, v56
    v_mul_f32 v50, v50, v56
    v_mul_f32 v51, v51, v56
    v_mul_f32 v52, v52, v57
    v_mul_f32 v53, v53, v57
    v_mul_f32 v54, v54, v57
    v_mul_f32_e64 v55, v55, v57
    v_cvt_pk_bf16_f32 v228, v48, v49
    v_cvt_pk_bf16_f32 v229, v50, v51
    v_cvt_pk_bf16_f32 v230, v52, v53
    v_cvt_pk_bf16_f32 v231, v54, v55
    v_mfma_f32_16x16x32_bf16 v[56:59], v[184:187], v[152:155], 0
    buffer_store_dwordx4 v[228:231], v16, s[36:39], s54 offen offset:1024 sc1
    v_mfma_f32_16x16x32_bf16 v[48:51], v[168:171], v[152:155], 0
    v_mfma_f32_16x16x32_bf16 v[52:55], v[176:179], v[152:155], 0
    v_mfma_f32_16x16x32_bf16 v[56:59], v[188:191], v[156:159], v[56:59]
    v_add_f32 v40, 0x358637bd, v40
    v_add_f32 v41, 0x358637bd, v41
    v_mul_f32 v40, v40, v30
    v_mul_f32 v41, v41, v30
    s_add_u32 s86, s101, 12288
    s_and_b32 s86, s86, 28672
    s_xor_b32 s86, s86, s8
    buffer_load_dwordx4 a[48:51], v2, s[36:39], s86 offen sc1
    v_mfma_f32_16x16x32_bf16 v[48:51], v[172:175], v[156:159], v[48:51]
    v_rcp_f32 v40, v40
    v_rcp_f32 v41, v41
    v_mul_f32 v32, v32, v40
    v_mfma_f32_16x16x32_bf16 v[52:55], v[180:183], v[156:159], v[52:55]
    v_mul_f32 v33, v33, v40
    v_mul_f32 v34, v34, v40
    v_mul_f32 v35, v35, v40
    v_mul_f32 v36, v36, v41
    v_mul_f32 v37, v37, v41
    v_mul_f32 v38, v38, v41
    v_mul_f32_e64 v39, v39, v41
    v_cvt_pk_bf16_f32 v232, v32, v33
    v_cvt_pk_bf16_f32 v233, v34, v35
    v_cvt_pk_bf16_f32 v234, v36, v37
    v_cvt_pk_bf16_f32 v235, v38, v39
    buffer_store_dwordx4 v[232:235], v16, s[36:39], s54 offen offset:2048 sc1
    v_add_f32 v56, 0x358637bd, v56
    v_add_f32 v57, 0x358637bd, v57
    v_mul_f32 v56, v56, v31
    v_mul_f32 v57, v57, v31
    v_rcp_f32 v56, v56
    v_rcp_f32 v57, v57
    v_mul_f32_e64 v48, v48, v56
    buffer_load_dwordx4 a[52:55], v3, s[36:39], s86 offen sc1
    v_mul_f32 v49, v49, v56
    v_mul_f32 v50, v50, v56
    v_mul_f32 v51, v51, v56
    v_mul_f32 v52, v52, v57
    v_mul_f32 v53, v53, v57
    v_mul_f32 v54, v54, v57
    v_mul_f32_e64 v55, v55, v57
    v_cvt_pk_bf16_f32 v236, v48, v49
    v_cvt_pk_bf16_f32 v237, v50, v51
    v_cvt_pk_bf16_f32 v238, v52, v53
    v_cvt_pk_bf16_f32 v239, v54, v55
    buffer_store_dwordx4 v[236:239], v16, s[36:39], s54 offen offset:3072 sc1
    s_add_u32 s0, s0, 32768
    s_add_u32 s49, s1, 32768
    v_mfma_f32_16x16x32_bf16 v[128:131], v[192:195], a[0:3], 0
    v_add_u32 v6, 0xffff0000, v24
    v_add_u32 v7, 0xffff0000, v25
    v_mfma_f32_16x16x32_bf16 v[132:135], v[196:199], a[0:3], 0
    v_add_u32 v8, 0xffff0000, v26
    v_add_u32 v9, 0xffff0000, v27
    v_mfma_f32_16x16x32_bf16 v[136:139], v[200:203], a[0:3], 0
    buffer_load_dwordx4 a[56:59], v4, s[36:39], s86 offen sc1
    v_mfma_f32_16x16x32_bf16 v[140:143], v[204:207], a[0:3], 0
    v_add_u32 v28, 0x10000, v24
    v_add_u32 v29, 0x10000, v25
    v_mfma_f32_16x16x32_bf16 v[156:159], v[204:207], a[4:7], 0
    v_add_u32 v30, 0x10000, v26
    v_add_u32 v31, 0x10000, v27
    v_mfma_f32_16x16x32_bf16 v[152:155], v[200:203], a[4:7], 0
    buffer_load_dwordx4 a[60:63], v5, s[36:39], s86 offen sc1
    v_mfma_f32_16x16x32_bf16 v[148:151], v[196:199], a[4:7], 0
    s_add_u32 s86, s101, 16384
    s_and_b32 s86, s86, 28672
    v_mfma_f32_16x16x32_bf16 v[144:147], v[192:195], a[4:7], 0
    s_xor_b32 s86, s86, s8
    v_mfma_f32_16x16x32_bf16 v[160:163], v[192:195], a[8:11], 0
    buffer_load_dwordx4 a[64:67], v2, s[36:39], s86 offen sc1
    v_mfma_f32_16x16x32_bf16 v[164:167], v[196:199], a[8:11], 0
    v_mfma_f32_16x16x32_bf16 v[168:171], v[200:203], a[8:11], 0
    v_mfma_f32_16x16x32_bf16 v[172:175], v[204:207], a[8:11], 0
    buffer_load_dwordx4 a[68:71], v3, s[36:39], s86 offen sc1
    v_mfma_f32_16x16x32_bf16 v[188:191], v[204:207], a[12:15], 0
    v_mfma_f32_16x16x32_bf16 v[184:187], v[200:203], a[12:15], 0
    v_mfma_f32_16x16x32_bf16 v[180:183], v[196:199], a[12:15], 0
    buffer_load_dwordx4 a[72:75], v4, s[36:39], s86 offen sc1
    v_mfma_f32_16x16x32_bf16 v[176:179], v[192:195], a[12:15], 0
    s_waitcnt vmcnt(18)
    v_mfma_f32_16x16x32_bf16 v[128:131], v[208:211], a[16:19], v[128:131]
    v_mfma_f32_16x16x32_bf16 v[132:135], v[212:215], a[16:19], v[132:135]
    v_mfma_f32_16x16x32_bf16 v[136:139], v[216:219], a[16:19], v[136:139]
    buffer_load_dwordx4 a[76:79], v5, s[36:39], s86 offen sc1
    v_mfma_f32_16x16x32_bf16 v[140:143], v[220:223], a[16:19], v[140:143]
    s_add_u32 s86, s101, 20480
    s_and_b32 s86, s86, 28672
    s_waitcnt vmcnt(18)
    v_mfma_f32_16x16x32_bf16 v[156:159], v[220:223], a[20:23], v[156:159]
    s_xor_b32 s86, s86, s8
    v_mfma_f32_16x16x32_bf16 v[152:155], v[216:219], a[20:23], v[152:155]
    buffer_load_dwordx4 a[80:83], v2, s[36:39], s86 offen sc1
    v_mfma_f32_16x16x32_bf16 v[148:151], v[212:215], a[20:23], v[148:151]
    v_mfma_f32_16x16x32_bf16 v[144:147], v[208:211], a[20:23], v[144:147]
    s_waitcnt vmcnt(18)
    v_mfma_f32_16x16x32_bf16 v[160:163], v[208:211], a[24:27], v[160:163]
    buffer_load_dwordx4 a[84:87], v3, s[36:39], s86 offen sc1
    v_mfma_f32_16x16x32_bf16 v[164:167], v[212:215], a[24:27], v[164:167]
    v_mfma_f32_16x16x32_bf16 v[168:171], v[216:219], a[24:27], v[168:171]
    v_mfma_f32_16x16x32_bf16 v[172:175], v[220:223], a[24:27], v[172:175]
    buffer_load_dwordx4 a[88:91], v4, s[36:39], s86 offen sc1
    s_waitcnt vmcnt(19)
    v_mfma_f32_16x16x32_bf16 v[188:191], v[220:223], a[28:31], v[188:191]
    v_mfma_f32_16x16x32_bf16 v[184:187], v[216:219], a[28:31], v[184:187]
    v_mfma_f32_16x16x32_bf16 v[180:183], v[212:215], a[28:31], v[180:183]
    buffer_load_dwordx4 a[92:95], v5, s[36:39], s86 offen sc1
    v_mfma_f32_16x16x32_bf16 v[176:179], v[208:211], a[28:31], v[176:179]
    s_waitcnt vmcnt(19)
    v_mfma_f32_16x16x32_bf16 v[128:131], v[64:67], a[32:35], v[128:131]
    ds_read_b64_tr_b16 v[48:49], v28 offset:0
    s_add_u32 s86, s101, 24576
    s_and_b32 s86, s86, 28672
    v_mfma_f32_16x16x32_bf16 v[132:135], v[68:71], a[32:35], v[132:135]
    ds_read_b64_tr_b16 v[50:51], v28 offset:1024
    s_xor_b32 s86, s86, s8
    v_mfma_f32_16x16x32_bf16 v[136:139], v[72:75], a[32:35], v[136:139]
    buffer_load_dwordx4 a[96:99], v2, s[36:39], s86 offen sc1
    v_mfma_f32_16x16x32_bf16 v[140:143], v[76:79], a[32:35], v[140:143]
    ds_read_b64_tr_b16 v[52:53], v29 offset:0
    s_waitcnt vmcnt(19)
    v_mfma_f32_16x16x32_bf16 v[156:159], v[76:79], a[36:39], v[156:159]
    ds_read_b64_tr_b16 v[54:55], v29 offset:1024
    v_mfma_f32_16x16x32_bf16 v[152:155], v[72:75], a[36:39], v[152:155]
    buffer_load_dwordx4 a[100:103], v3, s[36:39], s86 offen sc1
    v_mfma_f32_16x16x32_bf16 v[148:151], v[68:71], a[36:39], v[148:151]
    ds_read_b64_tr_b16 v[56:57], v30 offset:0
    v_mfma_f32_16x16x32_bf16 v[144:147], v[64:67], a[36:39], v[144:147]
    ds_read_b64_tr_b16 v[58:59], v30 offset:1024
    s_waitcnt vmcnt(19)
    v_mfma_f32_16x16x32_bf16 v[160:163], v[64:67], a[40:43], v[160:163]
    buffer_load_dwordx4 a[104:107], v4, s[36:39], s86 offen sc1
    v_mfma_f32_16x16x32_bf16 v[164:167], v[68:71], a[40:43], v[164:167]
    ds_read_b64_tr_b16 v[60:61], v31 offset:0
    v_mfma_f32_16x16x32_bf16 v[168:171], v[72:75], a[40:43], v[168:171]
    ds_read_b64_tr_b16 v[62:63], v31 offset:1024
    v_mfma_f32_16x16x32_bf16 v[172:175], v[76:79], a[40:43], v[172:175]
    buffer_load_dwordx4 a[108:111], v5, s[36:39], s86 offen sc1
    s_waitcnt vmcnt(19)
    v_mfma_f32_16x16x32_bf16 v[188:191], v[76:79], a[44:47], v[188:191]
    v_add_u32 v20, v20, v13
    v_add_u32_e64 v21, v21, v13
    v_add_u32 v21, 0xffffd000, v21
    v_add_u32_e64 v22, v22, v13
    v_add_u32 v22, 0x2000, v22
    v_add_u32_e64 v23, v23, v13
    v_mfma_f32_16x16x32_bf16 v[184:187], v[72:75], a[44:47], v[184:187]
    v_add_u32 v23, 0xfffff000, v23
    s_waitcnt lgkmcnt(2)
    s_add_u32 s84, s100, 0
    s_and_b32 s84, s84, 32768
    s_add_u32 m0, s50, 114688
    s_xor_b32 s84, s84, s6
    v_mfma_f32_16x16x32_bf16 v[180:183], v[68:71], a[44:47], v[180:183]
    buffer_load_dwordx4 v20, s[56:59], s84 offen offset:0 lds
    v_mfma_f32_16x16x32_bf16 v[176:179], v[64:67], a[44:47], v[176:179]
    s_waitcnt vmcnt(15)
    s_barrier
    v_mfma_f32_16x16x32_bf16 v[128:131], v[48:51], a[48:51], v[128:131]
    ds_read_b64_tr_b16 v[32:33], v28 offset:16384
    v_mfma_f32_16x16x32_bf16 v[132:135], v[52:55], a[48:51], v[132:135]
    ds_read_b64_tr_b16 v[34:35], v28 offset:17408
    v_mfma_f32_16x16x32_bf16 v[136:139], v[56:59], a[48:51], v[136:139]
    buffer_store_dword v24, v18, s[36:39], s0 offen sc1
    s_waitcnt lgkmcnt(2)
    v_mfma_f32_16x16x32_bf16 v[140:143], v[60:63], a[48:51], v[140:143]
    ds_read_b64_tr_b16 v[36:37], v29 offset:16384
    v_mfma_f32_16x16x32_bf16 v[156:159], v[60:63], a[52:55], v[156:159]
    ds_read_b64_tr_b16 v[38:39], v29 offset:17408
    v_mfma_f32_16x16x32_bf16 v[152:155], v[56:59], a[52:55], v[152:155]
    buffer_load_dword v19, v1, s[36:39], s1 offen offset:1024 sc1
    v_mfma_f32_16x16x32_bf16 v[148:151], v[52:55], a[52:55], v[148:151]
    ds_read_b64_tr_b16 v[40:41], v30 offset:16384
    v_mfma_f32_16x16x32_bf16 v[144:147], v[48:51], a[52:55], v[144:147]
    ds_read_b64_tr_b16 v[42:43], v30 offset:17408
    s_waitcnt vmcnt(16)
    v_mfma_f32_16x16x32_bf16 v[160:163], v[48:51], a[56:59], v[160:163]
    buffer_load_dwordx4 v21, s[56:59], s84 offen offset:1024 lds
    v_mfma_f32_16x16x32_bf16 v[164:167], v[52:55], a[56:59], v[164:167]
    ds_read_b64_tr_b16 v[44:45], v31 offset:16384
    v_mfma_f32_16x16x32_bf16 v[168:171], v[56:59], a[56:59], v[168:171]
    ds_read_b64_tr_b16 v[46:47], v31 offset:17408
    v_mfma_f32_16x16x32_bf16 v[172:175], v[60:63], a[56:59], v[172:175]
    buffer_load_dwordx4 v22, s[56:59], s84 offen offset:2048 lds
    s_waitcnt vmcnt(17)
    v_mfma_f32_16x16x32_bf16 v[188:191], v[60:63], a[60:63], v[188:191]
    v_mfma_f32_16x16x32_bf16 v[184:187], v[56:59], a[60:63], v[184:187]
    v_mfma_f32_16x16x32_bf16 v[180:183], v[52:55], a[60:63], v[180:183]
    buffer_load_dwordx4 v23, s[56:59], s84 offen offset:3072 lds
    v_mfma_f32_16x16x32_bf16 v[176:179], v[48:51], a[60:63], v[176:179]
    s_waitcnt vmcnt(17) lgkmcnt(2)
    v_mfma_f32_16x16x32_bf16 v[128:131], v[32:35], a[64:67], v[128:131]
    ds_read_b64_tr_b16 v[48:49], v6 offset:0
    s_add_u32 s86, s101, 28672
    s_and_b32 s86, s86, 28672
    v_mfma_f32_16x16x32_bf16 v[132:135], v[36:39], a[64:67], v[132:135]
    ds_read_b64_tr_b16 v[50:51], v6 offset:1024
    s_xor_b32 s86, s86, s8
    v_mfma_f32_16x16x32_bf16 v[136:139], v[40:43], a[64:67], v[136:139]
    buffer_load_dwordx4 a[112:115], v2, s[36:39], s86 offen sc1
    s_waitcnt lgkmcnt(2)
    v_mfma_f32_16x16x32_bf16 v[140:143], v[44:47], a[64:67], v[140:143]
    ds_read_b64_tr_b16 v[52:53], v7 offset:0
    s_waitcnt vmcnt(17)
    v_mfma_f32_16x16x32_bf16 v[156:159], v[44:47], a[68:71], v[156:159]
    ds_read_b64_tr_b16 v[54:55], v7 offset:1024
    v_mfma_f32_16x16x32_bf16 v[152:155], v[40:43], a[68:71], v[152:155]
    buffer_load_dwordx4 a[116:119], v3, s[36:39], s86 offen sc1
    v_mfma_f32_16x16x32_bf16 v[148:151], v[36:39], a[68:71], v[148:151]
    ds_read_b64_tr_b16 v[56:57], v8 offset:0
    v_mfma_f32_16x16x32_bf16 v[144:147], v[32:35], a[68:71], v[144:147]
    ds_read_b64_tr_b16 v[58:59], v8 offset:1024
    s_waitcnt vmcnt(17)
    v_mfma_f32_16x16x32_bf16 v[160:163], v[32:35], a[72:75], v[160:163]
    buffer_load_dwordx4 a[120:123], v4, s[36:39], s86 offen sc1
    v_mfma_f32_16x16x32_bf16 v[164:167], v[36:39], a[72:75], v[164:167]
    ds_read_b64_tr_b16 v[60:61], v9 offset:0
    v_mfma_f32_16x16x32_bf16 v[168:171], v[40:43], a[72:75], v[168:171]
    ds_read_b64_tr_b16 v[62:63], v9 offset:1024
    v_mfma_f32_16x16x32_bf16 v[172:175], v[44:47], a[72:75], v[172:175]
    buffer_load_dwordx4 a[124:127], v5, s[36:39], s86 offen sc1
    s_waitcnt vmcnt(18)
    v_mfma_f32_16x16x32_bf16 v[188:191], v[44:47], a[76:79], v[188:191]
    s_add_u32 s84, s100, 32768
    s_and_b32 s84, s84, 32768
    v_mfma_f32_16x16x32_bf16 v[184:187], v[40:43], a[76:79], v[184:187]
    s_add_u32 m0, s50, 131072
    s_xor_b32 s84, s84, s6
    v_mfma_f32_16x16x32_bf16 v[180:183], v[36:39], a[76:79], v[180:183]
    buffer_load_dwordx4 v20, s[56:59], s84 offen offset:0 lds
    v_mfma_f32_16x16x32_bf16 v[176:179], v[32:35], a[76:79], v[176:179]
    s_waitcnt vmcnt(18) lgkmcnt(2)
    v_mfma_f32_16x16x32_bf16 v[128:131], v[48:51], a[80:83], v[128:131]
    ds_read_b64_tr_b16 v[32:33], v24 offset:0
    v_mfma_f32_16x16x32_bf16 v[132:135], v[52:55], a[80:83], v[132:135]
    ds_read_b64_tr_b16 v[34:35], v24 offset:1024
    s_waitcnt vmcnt(8)
    v_cmp_ne_u32 s[92:93], 0, v19
    s_nop 0
    s_cmp_eq_u64 s[92:93], -1
    s_cbranch_scc0 L_sp4
L_ok4:
    v_mfma_f32_16x16x32_bf16 v[136:139], v[56:59], a[80:83], v[136:139]
    buffer_load_dwordx4 v21, s[56:59], s84 offen offset:1024 lds
    s_waitcnt lgkmcnt(2)
    v_mfma_f32_16x16x32_bf16 v[140:143], v[60:63], a[80:83], v[140:143]
    ds_read_b64_tr_b16 v[36:37], v25 offset:0
    v_mfma_f32_16x16x32_bf16 v[156:159], v[60:63], a[84:87], v[156:159]
    ds_read_b64_tr_b16 v[38:39], v25 offset:1024
    v_mfma_f32_16x16x32_bf16 v[152:155], v[56:59], a[84:87], v[152:155]
    buffer_load_dwordx4 v22, s[56:59], s84 offen offset:2048 lds
    v_mfma_f32_16x16x32_bf16 v[148:151], v[52:55], a[84:87], v[148:151]
    ds_read_b64_tr_b16 v[40:41], v26 offset:0
    v_mfma_f32_16x16x32_bf16 v[144:147], v[48:51], a[84:87], v[144:147]
    ds_read_b64_tr_b16 v[42:43], v26 offset:1024
    v_mfma_f32_16x16x32_bf16 v[160:163], v[48:51], a[88:91], v[160:163]
    buffer_load_dwordx4 v23, s[56:59], s84 offen offset:3072 lds
    v_mfma_f32_16x16x32_bf16 v[164:167], v[52:55], a[88:91], v[164:167]
    ds_read_b64_tr_b16 v[44:45], v27 offset:0
    s_add_u32 s86, s101, 0
    s_and_b32 s86, s86, 12288
    v_mfma_f32_16x16x32_bf16 v[168:171], v[56:59], a[88:91], v[168:171]
    ds_read_b64_tr_b16 v[46:47], v27 offset:1024
    s_xor_b32 s86, s86, s9
    v_mfma_f32_16x16x32_bf16 v[172:175], v[60:63], a[88:91], v[172:175]
    buffer_load_dwordx4 a[128:131], v2, s[36:39], s86 offen sc1
    v_mfma_f32_16x16x32_bf16 v[188:191], v[60:63], a[92:95], v[188:191]
    v_mfma_f32_16x16x32_bf16 v[184:187], v[56:59], a[92:95], v[184:187]
    v_mfma_f32_16x16x32_bf16 v[180:183], v[52:55], a[92:95], v[180:183]
    buffer_load_dwordx4 a[132:135], v3, s[36:39], s86 offen sc1
    v_mfma_f32_16x16x32_bf16 v[176:179], v[48:51], a[92:95], v[176:179]
    s_waitcnt lgkmcnt(2)
    v_mfma_f32_16x16x32_bf16 v[128:131], v[32:35], a[96:99], v[128:131]
    ds_read_b64_tr_b16 v[48:49], v6 offset:16384
    v_mfma_f32_16x16x32_bf16 v[132:135], v[36:39], a[96:99], v[132:135]
    ds_read_b64_tr_b16 v[50:51], v6 offset:17408
    v_mfma_f32_16x16x32_bf16 v[136:139], v[40:43], a[96:99], v[136:139]
    buffer_load_dwordx4 a[136:139], v4, s[36:39], s86 offen sc1
    s_waitcnt lgkmcnt(2)
    v_mfma_f32_16x16x32_bf16 v[140:143], v[44:47], a[96:99], v[140:143]
    ds_read_b64_tr_b16 v[52:53], v7 offset:16384
    v_mfma_f32_16x16x32_bf16 v[156:159], v[44:47], a[100:103], v[156:159]
    ds_read_b64_tr_b16 v[54:55], v7 offset:17408
    v_mfma_f32_16x16x32_bf16 v[152:155], v[40:43], a[100:103], v[152:155]
    buffer_load_dwordx4 a[140:143], v5, s[36:39], s86 offen sc1
    v_mfma_f32_16x16x32_bf16 v[148:151], v[36:39], a[100:103], v[148:151]
    ds_read_b64_tr_b16 v[56:57], v8 offset:16384
    s_add_u32 s86, s101, 4096
L_qmain_s5:
    s_cbranch_execz L_qmain_ret
    s_and_b32 s86, s86, 12288
    v_mfma_f32_16x16x32_bf16 v[144:147], v[32:35], a[100:103], v[144:147]
    ds_read_b64_tr_b16 v[58:59], v8 offset:17408
    s_xor_b32 s86, s86, s9
    v_mfma_f32_16x16x32_bf16 v[160:163], v[32:35], a[104:107], v[160:163]
    buffer_load_dwordx4 a[144:147], v2, s[36:39], s86 offen sc1
    v_mfma_f32_16x16x32_bf16 v[164:167], v[36:39], a[104:107], v[164:167]
    ds_read_b64_tr_b16 v[60:61], v9 offset:16384
    v_mfma_f32_16x16x32_bf16 v[168:171], v[40:43], a[104:107], v[168:171]
    ds_read_b64_tr_b16 v[62:63], v9 offset:17408
    v_mfma_f32_16x16x32_bf16 v[172:175], v[44:47], a[104:107], v[172:175]
    buffer_load_dwordx4 a[148:151], v3, s[36:39], s86 offen sc1
    v_mfma_f32_16x16x32_bf16 v[188:191], v[44:47], a[108:111], v[188:191]
    v_mfma_f32_16x16x32_bf16 v[184:187], v[40:43], a[108:111], v[184:187]
    v_mfma_f32_16x16x32_bf16 v[180:183], v[36:39], a[108:111], v[180:183]
    buffer_load_dwordx4 a[152:155], v4, s[36:39], s86 offen sc1
    v_mfma_f32_16x16x32_bf16 v[176:179], v[32:35], a[108:111], v[176:179]
    s_waitcnt vmcnt(14) lgkmcnt(2)
    v_mfma_f32_16x16x32_bf16 v[128:131], v[48:51], a[112:115], v[128:131]
    ds_read_b64_tr_b16 v[32:33], v24 offset:16384
    v_mfma_f32_16x16x32_bf16 v[132:135], v[52:55], a[112:115], v[132:135]
    ds_read_b64_tr_b16 v[34:35], v24 offset:17408
    v_mfma_f32_16x16x32_bf16 v[136:139], v[56:59], a[112:115], v[136:139]
    buffer_load_dword v19, v1, s[36:39], s49 offen offset:1024 sc1
    s_waitcnt lgkmcnt(2)
    v_mfma_f32_16x16x32_bf16 v[140:143], v[60:63], a[112:115], v[140:143]
    ds_read_b64_tr_b16 v[36:37], v25 offset:16384
    s_waitcnt vmcnt(14)
    v_mfma_f32_16x16x32_bf16 v[156:159], v[60:63], a[116:119], v[156:159]
    ds_read_b64_tr_b16 v[38:39], v25 offset:17408
    v_mfma_f32_16x16x32_bf16 v[152:155], v[56:59], a[116:119], v[152:155]
    buffer_load_dwordx4 a[156:159], v5, s[36:39], s86 offen sc1
    v_mfma_f32_16x16x32_bf16 v[148:151], v[52:55], a[116:119], v[148:151]
    ds_read_b64_tr_b16 v[40:41], v26 offset:16384
    s_add_u32 s86, s101, 8192
    s_and_b32 s86, s86, 12288
    v_mfma_f32_16x16x32_bf16 v[144:147], v[48:51], a[116:119], v[144:147]
    ds_read_b64_tr_b16 v[42:43], v26 offset:17408
    s_xor_b32 s86, s86, s9
    s_waitcnt vmcnt(14)
    v_mfma_f32_16x16x32_bf16 v[160:163], v[48:51], a[120:123], v[160:163]
    buffer_load_dwordx4 a[160:163], v2, s[36:39], s86 offen sc1
    v_mfma_f32_16x16x32_bf16 v[164:167], v[52:55], a[120:123], v[164:167]
    ds_read_b64_tr_b16 v[44:45], v27 offset:16384
    v_mfma_f32_16x16x32_bf16 v[168:171], v[56:59], a[120:123], v[168:171]
    ds_read_b64_tr_b16 v[46:47], v27 offset:17408
    v_mfma_f32_16x16x32_bf16 v[172:175], v[60:63], a[120:123], v[172:175]
    buffer_load_dwordx4 a[164:167], v3, s[36:39], s86 offen sc1
    s_waitcnt vmcnt(15)
    v_mfma_f32_16x16x32_bf16 v[188:191], v[60:63], a[124:127], v[188:191]
    v_mfma_f32_16x16x32_bf16 v[184:187], v[56:59], a[124:127], v[184:187]
    v_mfma_f32_16x16x32_bf16 v[180:183], v[52:55], a[124:127], v[180:183]
    buffer_load_dwordx4 a[168:171], v4, s[36:39], s86 offen sc1
    v_mfma_f32_16x16x32_bf16 v[176:179], v[48:51], a[124:127], v[176:179]
    s_waitcnt vmcnt(11) lgkmcnt(2)
    v_mfma_f32_16x16x32_bf16 v[128:131], v[32:35], a[128:131], v[128:131]
    ds_read_b64_tr_b16 v[48:49], v6 offset:32768
    v_mfma_f32_16x16x32_bf16 v[132:135], v[36:39], a[128:131], v[132:135]
    ds_read_b64_tr_b16 v[50:51], v6 offset:33792
    v_mfma_f32_16x16x32_bf16 v[136:139], v[40:43], a[128:131], v[136:139]
    buffer_load_dwordx4 a[172:175], v5, s[36:39], s86 offen sc1
    s_waitcnt lgkmcnt(2)
    v_mfma_f32_16x16x32_bf16 v[140:143], v[44:47], a[128:131], v[140:143]
    ds_read_b64_tr_b16 v[52:53], v7 offset:32768
    v_sub_u32 v20, v20, v13
    v_sub_u32_e64 v21, v21, v13
    v_add_u32 v21, 0x3000, v21
    v_sub_u32_e64 v22, v22, v13
    v_add_u32 v22, 0xffffe000, v22
    v_sub_u32 v23, v23, v13
    s_waitcnt vmcnt(11)
    v_mfma_f32_16x16x32_bf16 v[156:159], v[44:47], a[132:135], v[156:159]
    ds_read_b64_tr_b16 v[54:55], v7 offset:33792
    v_add_u32 v23, 0x1000, v23
    s_add_u32 s84, s100, 0
    s_and_b32 s84, s84, 98304
    s_add_u32 m0, s50, 147456
    s_xor_b32 s84, s84, s7
    v_mfma_f32_16x16x32_bf16 v[152:155], v[40:43], a[132:135], v[152:155]
    buffer_load_dwordx4 v20, s[60:63], s84 offen offset:0 lds
    v_mfma_f32_16x16x32_bf16 v[148:151], v[36:39], a[132:135], v[148:151]
    ds_read_b64_tr_b16 v[56:57], v8 offset:32768
    v_mfma_f32_16x16x32_bf16 v[144:147], v[32:35], a[132:135], v[144:147]
    ds_read_b64_tr_b16 v[58:59], v8 offset:33792
    s_waitcnt vmcnt(11)
    v_mfma_f32_16x16x32_bf16 v[160:163], v[32:35], a[136:139], v[160:163]
    buffer_load_dwordx4 v21, s[60:63], s84 offen offset:1024 lds
    v_mfma_f32_16x16x32_bf16 v[164:167], v[36:39], a[136:139], v[164:167]
    ds_read_b64_tr_b16 v[60:61], v9 offset:32768
    v_mfma_f32_16x16x32_bf16 v[168:171], v[40:43], a[136:139], v[168:171]
    ds_read_b64_tr_b16 v[62:63], v9 offset:33792
    v_mfma_f32_16x16x32_bf16 v[172:175], v[44:47], a[136:139], v[172:175]
    buffer_load_dwordx4 v22, s[60:63], s84 offen offset:2048 lds
    s_waitcnt vmcnt(12)
    v_mfma_f32_16x16x32_bf16 v[188:191], v[44:47], a[140:143], v[188:191]
    v_mfma_f32_16x16x32_bf16 v[184:187], v[40:43], a[140:143], v[184:187]
    v_mfma_f32_16x16x32_bf16 v[180:183], v[36:39], a[140:143], v[180:183]
    buffer_load_dwordx4 v23, s[60:63], s84 offen offset:3072 lds
    v_mfma_f32_16x16x32_bf16 v[176:179], v[32:35], a[140:143], v[176:179]
    s_waitcnt vmcnt(12) lgkmcnt(2)
    v_mfma_f32_16x16x32_bf16 v[128:131], v[48:51], a[144:147], v[128:131]
    ds_read_b64_tr_b16 v[32:33], v24 offset:32768
    v_mfma_f32_16x16x32_bf16 v[132:135], v[52:55], a[144:147], v[132:135]
    ds_read_b64_tr_b16 v[34:35], v24 offset:33792
    v_mfma_f32_16x16x32_bf16 v[136:139], v[56:59], a[144:147], v[136:139]
    buffer_load_dword v10, v1, s[36:39], s49 offen offset:0 sc1
    s_waitcnt lgkmcnt(2)
    v_mfma_f32_16x16x32_bf16 v[140:143], v[60:63], a[144:147], v[140:143]
    ds_read_b64_tr_b16 v[36:37], v25 offset:32768
    s_add_u32 s86, s101, 12288
    s_and_b32 s86, s86, 12288
    s_waitcnt vmcnt(12)
    v_mfma_f32_16x16x32_bf16 v[156:159], v[60:63], a[148:151], v[156:159]
    ds_read_b64_tr_b16 v[38:39], v25 offset:33792
    s_xor_b32 s86, s86, s9
    v_mfma_f32_16x16x32_bf16 v[152:155], v[56:59], a[148:151], v[152:155]
    buffer_load_dwordx4 a[176:179], v2, s[36:39], s86 offen sc1
    v_mfma_f32_16x16x32_bf16 v[148:151], v[52:55], a[148:151], v[148:151]
    ds_read_b64_tr_b16 v[40:41], v26 offset:32768
    v_mfma_f32_16x16x32_bf16 v[144:147], v[48:51], a[148:151], v[144:147]
    ds_read_b64_tr_b16 v[42:43], v26 offset:33792
    s_waitcnt vmcnt(12)
    v_mfma_f32_16x16x32_bf16 v[160:163], v[48:51], a[152:155], v[160:163]
    buffer_load_dwordx4 a[180:183], v3, s[36:39], s86 offen sc1
    v_mfma_f32_16x16x32_bf16 v[164:167], v[52:55], a[152:155], v[164:167]
    ds_read_b64_tr_b16 v[44:45], v27 offset:32768
    v_mfma_f32_16x16x32_bf16 v[168:171], v[56:59], a[152:155], v[168:171]
    ds_read_b64_tr_b16 v[46:47], v27 offset:33792
    v_mfma_f32_16x16x32_bf16 v[172:175], v[60:63], a[152:155], v[172:175]
    buffer_load_dwordx4 a[184:187], v4, s[36:39], s86 offen sc1
    s_waitcnt vmcnt(12)
    v_mfma_f32_16x16x32_bf16 v[188:191], v[60:63], a[156:159], v[188:191]
    v_mfma_f32_16x16x32_bf16 v[184:187], v[56:59], a[156:159], v[184:187]
    v_mfma_f32_16x16x32_bf16 v[180:183], v[52:55], a[156:159], v[180:183]
    buffer_load_dwordx4 a[188:191], v5, s[36:39], s86 offen sc1
    v_mfma_f32_16x16x32_bf16 v[176:179], v[48:51], a[156:159], v[176:179]
    s_waitcnt vmcnt(12) lgkmcnt(2)
    v_mfma_f32_16x16x32_bf16 v[128:131], v[32:35], a[160:163], v[128:131]
    ds_read_b64_tr_b16 v[48:49], v6 offset:49152
    v_cmp_ne_u32 s[92:93], 0, v19
    s_nop 0
    s_cmp_eq_u64 s[92:93], -1
    s_cbranch_scc0 L_sp5
L_ok5:
    s_add_u32 s86, s101, 0
    v_mfma_f32_16x16x32_bf16 v[132:135], v[36:39], a[160:163], v[132:135]
    ds_read_b64_tr_b16 v[50:51], v6 offset:50176
    s_and_b32 s86, s86, 4096
    s_xor_b32 s86, s86, s10
    v_mfma_f32_16x16x32_bf16 v[136:139], v[40:43], a[160:163], v[136:139]
    buffer_load_dwordx4 a[192:195], v2, s[36:39], s86 offen sc1
    s_waitcnt lgkmcnt(2)
    v_mfma_f32_16x16x32_bf16 v[140:143], v[44:47], a[160:163], v[140:143]
    ds_read_b64_tr_b16 v[52:53], v7 offset:49152
    s_waitcnt vmcnt(12)
    v_mfma_f32_16x16x32_bf16 v[156:159], v[44:47], a[164:167], v[156:159]
    ds_read_b64_tr_b16 v[54:55], v7 offset:50176
    v_mfma_f32_16x16x32_bf16 v[152:155], v[40:43], a[164:167], v[152:155]
    buffer_load_dwordx4 a[196:199], v3, s[36:39], s86 offen sc1
    v_mfma_f32_16x16x32_bf16 v[148:151], v[36:39], a[164:167], v[148:151]
    ds_read_b64_tr_b16 v[56:57], v8 offset:49152
    v_mfma_f32_16x16x32_bf16 v[144:147], v[32:35], a[164:167], v[144:147]
    ds_read_b64_tr_b16 v[58:59], v8 offset:50176
    s_waitcnt vmcnt(12)
    v_mfma_f32_16x16x32_bf16 v[160:163], v[32:35], a[168:171], v[160:163]
    buffer_load_dwordx4 a[200:203], v4, s[36:39], s86 offen sc1
    v_mfma_f32_16x16x32_bf16 v[164:167], v[36:39], a[168:171], v[164:167]
    ds_read_b64_tr_b16 v[60:61], v9 offset:49152
    v_mfma_f32_16x16x32_bf16 v[168:171], v[40:43], a[168:171], v[168:171]
    ds_read_b64_tr_b16 v[62:63], v9 offset:50176
    v_mfma_f32_16x16x32_bf16 v[172:175], v[44:47], a[168:171], v[172:175]
    buffer_load_dwordx4 a[204:207], v5, s[36:39], s86 offen sc1
    s_waitcnt vmcnt(13)
    v_mfma_f32_16x16x32_bf16 v[188:191], v[44:47], a[172:175], v[188:191]
    s_add_u32 s86, s101, 4096
    s_and_b32 s86, s86, 4096
    v_mfma_f32_16x16x32_bf16 v[184:187], v[40:43], a[172:175], v[184:187]
    s_xor_b32 s86, s86, s10
    v_mfma_f32_16x16x32_bf16 v[180:183], v[36:39], a[172:175], v[180:183]
    buffer_load_dwordx4 a[208:211], v2, s[36:39], s86 offen sc1
    v_mfma_f32_16x16x32_bf16 v[176:179], v[32:35], a[172:175], v[176:179]
    s_waitcnt vmcnt(8) lgkmcnt(2)
    v_mfma_f32_16x16x32_bf16 v[128:131], v[48:51], a[176:179], v[128:131]
    ds_read_b64_tr_b16 v[32:33], v24 offset:49152
    v_add_u32_e64 v14, s51, v16
    v_mfma_f32_16x16x32_bf16 v[132:135], v[52:55], a[176:179], v[132:135]
    ds_read_b64_tr_b16 v[34:35], v24 offset:50176
    v_cmp_ne_u32 s[92:93], 0, v10
    s_nop 0
    s_cmp_eq_u64 s[92:93], -1
    s_cbranch_scc0 L_sp6
L_ok6:
    v_mfma_f32_16x16x32_bf16 v[136:139], v[56:59], a[176:179], v[136:139]
    buffer_load_dwordx4 a[212:215], v3, s[36:39], s86 offen sc1
    s_waitcnt lgkmcnt(2)
    v_mfma_f32_16x16x32_bf16 v[140:143], v[60:63], a[176:179], v[140:143]
    ds_read_b64_tr_b16 v[36:37], v25 offset:49152
    s_waitcnt vmcnt(8)
    v_mfma_f32_16x16x32_bf16 v[156:159], v[60:63], a[180:183], v[156:159]
    ds_read_b64_tr_b16 v[38:39], v25 offset:50176
    v_xor_b32 v15, 0x1000, v14
    v_mfma_f32_16x16x32_bf16 v[152:155], v[56:59], a[180:183], v[152:155]
    buffer_load_dwordx4 a[216:219], v4, s[36:39], s86 offen sc1
    v_mfma_f32_16x16x32_bf16 v[148:151], v[52:55], a[180:183], v[148:151]
    ds_read_b64_tr_b16 v[40:41], v26 offset:49152
    v_xor_b32 v11, 0x2000, v14
    v_mfma_f32_16x16x32_bf16 v[144:147], v[48:51], a[180:183], v[144:147]
    ds_read_b64_tr_b16 v[42:43], v26 offset:50176
    s_waitcnt vmcnt(8)
    v_mfma_f32_16x16x32_bf16 v[160:163], v[48:51], a[184:187], v[160:163]
    buffer_load_dwordx4 a[220:223], v5, s[36:39], s86 offen sc1
    v_mfma_f32_16x16x32_bf16 v[164:167], v[52:55], a[184:187], v[164:167]
    ds_read_b64_tr_b16 v[44:45], v27 offset:49152
    s_add_u32 s12, s101, 0
    s_and_b32 s12, s12, 12288
    s_xor_b32 s12, s12, s11
    s_add_u32 s13, s101, 4096
    s_and_b32 s13, s13, 12288
    s_xor_b32 s13, s13, s11
    v_mfma_f32_16x16x32_bf16 v[168:171], v[56:59], a[184:187], v[168:171]
    ds_read_b64_tr_b16 v[46:47], v27 offset:50176
    s_add_u32 s14, s101, 8192
    s_and_b32 s14, s14, 12288
    s_xor_b32 s14, s14, s11
    s_add_u32 s15, s101, 12288
    s_and_b32 s15, s15, 12288
    s_xor_b32 s15, s15, s11
    v_mfma_f32_16x16x32_bf16 v[172:175], v[60:63], a[184:187], v[172:175]
    buffer_load_dwordx4 a[228:231], v3, s[36:39], s12 offen sc1
    s_waitcnt vmcnt(9)
    v_mfma_f32_16x16x32_bf16 v[188:191], v[60:63], a[188:191], v[188:191]
    v_xor_b32 v12, 0x3000, v14
    v_and_b32_e64 v18, 60, v0
    v_mfma_f32_16x16x32_bf16 v[184:187], v[56:59], a[188:191], v[184:187]
    v_and_b32 v13, 3, v0
    v_lshlrev_b32 v17, 8, v18
    v_mfma_f32_16x16x32_bf16 v[180:183], v[52:55], a[188:191], v[180:183]
    buffer_load_dwordx4 a[244:247], v3, s[36:39], s13 offen sc1
    v_mfma_f32_16x16x32_bf16 v[176:179], v[48:51], a[188:191], v[176:179]
    v_lshl_add_u32 v17, v13, 4, v17
    s_waitcnt vmcnt(9) lgkmcnt(1)
    v_mfma_f32_16x16x32_bf16 v[128:131], v[32:35], a[192:195], v[128:131]
    ds_read_b64_tr_b16 v[48:49], v28 offset:0
    v_and_b32 v13, 1, v0
    v_mfma_f32_16x16x32_bf16 v[132:135], v[36:39], a[192:195], v[132:135]
    ds_read_b64_tr_b16 v[50:51], v28 offset:1024
    v_lshl_add_u32 v18, v13, 7, v18
    v_mfma_f32_16x16x32_bf16 v[136:139], v[40:43], a[192:195], v[136:139]
    buffer_load_dwordx4 a[4:7], v3, s[36:39], s14 offen sc1
    s_waitcnt lgkmcnt(2)
    v_mfma_f32_16x16x32_bf16 v[140:143], v[44:47], a[192:195], v[140:143]
    ds_read_b64_tr_b16 v[52:53], v29 offset:0
    s_waitcnt vmcnt(9)
    v_mfma_f32_16x16x32_bf16 v[156:159], v[44:47], a[196:199], v[156:159]
    ds_read_b64_tr_b16 v[54:55], v29 offset:1024
    v_bfe_u32 v13, v0, 1, 1
    v_mfma_f32_16x16x32_bf16 v[152:155], v[40:43], a[196:199], v[152:155]
    buffer_load_dwordx4 a[20:23], v3, s[36:39], s15 offen sc1
    v_mfma_f32_16x16x32_bf16 v[148:151], v[36:39], a[196:199], v[148:151]
    ds_read_b64_tr_b16 v[56:57], v30 offset:0
    v_lshl_add_u32 v18, v13, 6, v18
    v_mfma_f32_16x16x32_bf16 v[144:147], v[32:35], a[196:199], v[144:147]
    ds_read_b64_tr_b16 v[58:59], v30 offset:1024
    s_waitcnt vmcnt(9)
    v_mfma_f32_16x16x32_bf16 v[160:163], v[32:35], a[200:203], v[160:163]
    buffer_load_dwordx4 a[232:235], v4, s[36:39], s12 offen sc1
    v_mfma_f32_16x16x32_bf16 v[164:167], v[36:39], a[200:203], v[164:167]
    ds_read_b64_tr_b16 v[60:61], v31 offset:0
    s_lshl2_add_u32 s48, s90, s40
    v_mfma_f32_16x16x32_bf16 v[168:171], v[40:43], a[200:203], v[168:171]
    ds_read_b64_tr_b16 v[62:63], v31 offset:1024
    s_lshl_b32 s48, s48, 14
    v_mfma_f32_16x16x32_bf16 v[172:175], v[44:47], a[200:203], v[172:175]
    buffer_load_dwordx4 a[248:251], v4, s[36:39], s13 offen sc1
    s_waitcnt vmcnt(10)
    v_mfma_f32_16x16x32_bf16 v[188:191], v[44:47], a[204:207], v[188:191]
    s_lshl_b32 s53, s91, 7
    s_add_u32 s53, s48, s53
    v_mfma_f32_16x16x32_bf16 v[184:187], v[40:43], a[204:207], v[184:187]
    v_mfma_f32_16x16x32_bf16 v[180:183], v[36:39], a[204:207], v[180:183]
    buffer_load_dwordx4 a[8:11], v4, s[36:39], s14 offen sc1
    v_mfma_f32_16x16x32_bf16 v[176:179], v[32:35], a[204:207], v[176:179]
    s_waitcnt vmcnt(9) lgkmcnt(2)
    v_mfma_f32_16x16x32_bf16 v[144:147], v[48:51], a[212:215], v[144:147]
    ds_read_b64_tr_b16 v[32:33], v28 offset:16384
    v_mfma_f32_16x16x32_bf16 v[148:151], v[52:55], a[212:215], v[148:151]
    buffer_load_dwordx4 a[24:27], v4, s[36:39], s15 offen sc1
    ds_read_b64_tr_b16 v[34:35], v28 offset:17408
    v_mfma_f32_16x16x32_bf16 v[152:155], v[56:59], a[212:215], v[152:155]
    ds_read_b64_tr_b16 v[36:37], v29 offset:16384
    s_waitcnt lgkmcnt(3)
    v_mfma_f32_16x16x32_bf16 v[156:159], v[60:63], a[212:215], v[156:159]
    buffer_load_dwordx4 a[236:239], v5, s[36:39], s12 offen sc1
    s_waitcnt vmcnt(10)
    v_mfma_f32_16x16x32_bf16 v[172:175], v[60:63], a[216:219], v[172:175]
    ds_read_b64_tr_b16 v[38:39], v29 offset:17408
    v_mfma_f32_16x16x32_bf16 v[168:171], v[56:59], a[216:219], v[168:171]
    buffer_load_dwordx4 a[252:255], v5, s[36:39], s13 offen sc1
    v_mfma_f32_16x16x32_bf16 v[164:167], v[52:55], a[216:219], v[164:167]
    ds_read_b64_tr_b16 v[40:41], v30 offset:16384
    v_mfma_f32_16x16x32_bf16 v[160:163], v[48:51], a[216:219], v[160:163]
    ds_read_b64_tr_b16 v[42:43], v30 offset:17408
    s_waitcnt vmcnt(10)
    v_mfma_f32_16x16x32_bf16 v[176:179], v[48:51], a[220:223], v[176:179]
    buffer_load_dwordx4 a[12:15], v5, s[36:39], s14 offen sc1
    v_mfma_f32_16x16x32_bf16 v[180:183], v[52:55], a[220:223], v[180:183]
    ds_read_b64_tr_b16 v[44:45], v31 offset:16384
    v_mfma_f32_16x16x32_bf16 v[184:187], v[56:59], a[220:223], v[184:187]
    buffer_load_dwordx4 a[28:31], v5, s[36:39], s15 offen sc1
    v_mfma_f32_16x16x32_bf16 v[188:191], v[60:63], a[220:223], v[188:191]
    ds_read_b64_tr_b16 v[46:47], v31 offset:17408
    s_waitcnt vmcnt(11) lgkmcnt(4)
    v_mfma_f32_16x16x32_bf16 v[144:147], v[32:35], a[228:231], v[144:147]
    v_mfma_f32_16x16x32_bf16 v[148:151], v[36:39], a[228:231], v[148:151]
    buffer_load_dwordx4 a[224:227], v2, s[36:39], s12 offen sc1
    s_waitcnt lgkmcnt(2)
    v_mfma_f32_16x16x32_bf16 v[152:155], v[40:43], a[228:231], v[152:155]
    s_waitcnt lgkmcnt(0)
    v_mfma_f32_16x16x32_bf16 v[156:159], v[44:47], a[228:231], v[156:159]
    s_waitcnt vmcnt(11)
    v_mfma_f32_16x16x32_bf16 v[144:147], v[80:83], a[244:247], v[144:147]
    v_mfma_f32_16x16x32_bf16 v[148:151], v[84:87], a[244:247], v[148:151]
    buffer_load_dwordx4 a[240:243], v2, s[36:39], s13 offen sc1
    v_mfma_f32_16x16x32_bf16 v[152:155], v[88:91], a[244:247], v[152:155]
    v_mfma_f32_16x16x32_bf16 v[156:159], v[92:95], a[244:247], v[156:159]
    s_waitcnt vmcnt(11)
    v_mfma_f32_16x16x32_bf16 v[144:147], v[96:99], a[4:7], v[144:147]
    v_mfma_f32_16x16x32_bf16 v[148:151], v[100:103], a[4:7], v[148:151]
    buffer_load_dwordx4 a[0:3], v2, s[36:39], s14 offen sc1
    v_mfma_f32_16x16x32_bf16 v[152:155], v[104:107], a[4:7], v[152:155]
    v_mfma_f32_16x16x32_bf16 v[156:159], v[108:111], a[4:7], v[156:159]
    s_waitcnt vmcnt(11)
    v_mfma_f32_16x16x32_bf16 v[144:147], v[112:115], a[20:23], v[144:147]
    v_mfma_f32_16x16x32_bf16 v[148:151], v[116:119], a[20:23], v[148:151]
    buffer_load_dwordx4 a[16:19], v2, s[36:39], s15 offen sc1
    v_mfma_f32_16x16x32_bf16 v[152:155], v[120:123], a[20:23], v[152:155]
    v_mfma_f32_16x16x32_bf16 v[156:159], v[124:127], a[20:23], v[156:159]
    s_waitcnt vmcnt(11)
    v_mfma_f32_16x16x32_bf16 v[160:163], v[32:35], a[232:235], v[160:163]
    v_mfma_f32_16x16x32_bf16 v[164:167], v[36:39], a[232:235], v[164:167]
    v_mfma_f32_16x16x32_bf16 v[168:171], v[40:43], a[232:235], v[168:171]
    v_mfma_f32_16x16x32_bf16 v[172:175], v[44:47], a[232:235], v[172:175]
    s_waitcnt vmcnt(10)
    v_mfma_f32_16x16x32_bf16 v[160:163], v[80:83], a[248:251], v[160:163]
    ds_write_b128 v14, v[144:147] offset:0
    v_mfma_f32_16x16x32_bf16 v[164:167], v[84:87], a[248:251], v[164:167]
    v_mfma_f32_16x16x32_bf16 v[168:171], v[88:91], a[248:251], v[168:171]
    v_mfma_f32_16x16x32_bf16 v[172:175], v[92:95], a[248:251], v[172:175]
    ds_write_b128 v14, v[148:151] offset:1024
    s_waitcnt vmcnt(9)
    v_mfma_f32_16x16x32_bf16 v[160:163], v[96:99], a[8:11], v[160:163]
    v_mfma_f32_16x16x32_bf16 v[164:167], v[100:103], a[8:11], v[164:167]
    v_mfma_f32_16x16x32_bf16 v[168:171], v[104:107], a[8:11], v[168:171]
    ds_write_b128 v14, v[152:155] offset:2048
    v_mfma_f32_16x16x32_bf16 v[172:175], v[108:111], a[8:11], v[172:175]
    s_waitcnt vmcnt(8)
    v_mfma_f32_16x16x32_bf16 v[160:163], v[112:115], a[24:27], v[160:163]
    v_mfma_f32_16x16x32_bf16 v[164:167], v[116:119], a[24:27], v[164:167]
    ds_write_b128 v14, v[156:159] offset:3072
    v_mfma_f32_16x16x32_bf16 v[168:171], v[120:123], a[24:27], v[168:171]
    v_mfma_f32_16x16x32_bf16 v[172:175], v[124:127], a[24:27], v[172:175]
    s_waitcnt vmcnt(7)
    v_mfma_f32_16x16x32_bf16 v[176:179], v[32:35], a[236:239], v[176:179]
    v_mfma_f32_16x16x32_bf16 v[180:183], v[36:39], a[236:239], v[180:183]
    v_mfma_f32_16x16x32_bf16 v[184:187], v[40:43], a[236:239], v[184:187]
    v_mfma_f32_16x16x32_bf16 v[188:191], v[44:47], a[236:239], v[188:191]
    ds_write_b128 v14, v[160:163] offset:16384
    s_waitcnt vmcnt(6)
    v_mfma_f32_16x16x32_bf16 v[176:179], v[80:83], a[252:255], v[176:179]
    v_mfma_f32_16x16x32_bf16 v[180:183], v[84:87], a[252:255], v[180:183]
    v_mfma_f32_16x16x32_bf16 v[184:187], v[88:91], a[252:255], v[184:187]
    ds_write_b128 v14, v[164:167] offset:17408
    v_mfma_f32_16x16x32_bf16 v[188:191], v[92:95], a[252:255], v[188:191]
    s_waitcnt vmcnt(5)
    v_mfma_f32_16x16x32_bf16 v[176:179], v[96:99], a[12:15], v[176:179]
    v_mfma_f32_16x16x32_bf16 v[180:183], v[100:103], a[12:15], v[180:183]
    ds_write_b128 v14, v[168:171] offset:18432
    v_mfma_f32_16x16x32_bf16 v[184:187], v[104:107], a[12:15], v[184:187]
    v_mfma_f32_16x16x32_bf16 v[188:191], v[108:111], a[12:15], v[188:191]
    s_waitcnt vmcnt(4)
    v_mfma_f32_16x16x32_bf16 v[176:179], v[112:115], a[28:31], v[176:179]
    ds_write_b128 v14, v[172:175] offset:19456
    v_mfma_f32_16x16x32_bf16 v[180:183], v[116:119], a[28:31], v[180:183]
    v_mfma_f32_16x16x32_bf16 v[184:187], v[120:123], a[28:31], v[184:187]
    v_mfma_f32_16x16x32_bf16 v[188:191], v[124:127], a[28:31], v[188:191]
    s_waitcnt lgkmcnt(0)
    s_barrier
    v_mfma_f32_16x16x32_bf16 v[140:143], v[60:63], a[208:211], v[140:143]
    ds_read_b128 v[192:195], v15 offset:0
    v_mfma_f32_16x16x32_bf16 v[136:139], v[56:59], a[208:211], v[136:139]
    ds_write_b128 v14, v[176:179] offset:32768
    v_mfma_f32_16x16x32_bf16 v[132:135], v[52:55], a[208:211], v[132:135]
    ds_read_b128 v[196:199], v15 offset:1024
    v_mfma_f32_16x16x32_bf16 v[128:131], v[48:51], a[208:211], v[128:131]
    ds_read_b128 v[200:203], v15 offset:2048
    s_waitcnt vmcnt(3)
    v_mfma_f32_16x16x32_bf16 v[128:131], v[32:35], a[224:227], v[128:131]
    ds_write_b128 v14, v[180:183] offset:33792
    v_mfma_f32_16x16x32_bf16 v[132:135], v[36:39], a[224:227], v[132:135]
    ds_read_b128 v[204:207], v15 offset:3072
    v_mfma_f32_16x16x32_bf16 v[136:139], v[40:43], a[224:227], v[136:139]
    ds_read_b128 v[208:211], v11 offset:16384
    v_mfma_f32_16x16x32_bf16 v[140:143], v[44:47], a[224:227], v[140:143]
    ds_write_b128 v14, v[184:187] offset:34816
    s_waitcnt vmcnt(2)
    v_mfma_f32_16x16x32_bf16 v[128:131], v[80:83], a[240:243], v[128:131]
    ds_read_b128 v[212:215], v11 offset:17408
    v_mfma_f32_16x16x32_bf16 v[132:135], v[84:87], a[240:243], v[132:135]
    ds_read_b128 v[216:219], v11 offset:18432
    v_mfma_f32_16x16x32_bf16 v[136:139], v[88:91], a[240:243], v[136:139]
    ds_write_b128 v14, v[188:191] offset:35840
    v_mfma_f32_16x16x32_bf16 v[140:143], v[92:95], a[240:243], v[140:143]
    ds_read_b128 v[220:223], v11 offset:19456
    s_waitcnt lgkmcnt(5)
    v_add_f32_e64 v192, v192, v208
    s_waitcnt vmcnt(1)
    v_mfma_f32_16x16x32_bf16 v[128:131], v[96:99], a[0:3], v[128:131]
    v_add_f32 v193, v193, v209
    v_add_f32 v194, v194, v210
    v_mfma_f32_16x16x32_bf16 v[132:135], v[100:103], a[0:3], v[132:135]
    v_add_f32 v195, v195, v211
    s_waitcnt lgkmcnt(3)
    v_add_f32 v196, v196, v212
    s_waitcnt lgkmcnt(0)
    v_mfma_f32_16x16x32_bf16 v[136:139], v[104:107], a[0:3], v[136:139]
    s_barrier
    v_mfma_f32_16x16x32_bf16 v[140:143], v[108:111], a[0:3], v[140:143]
    ds_read_b128 v[224:227], v12 offset:32768
    v_add_f32_e64 v197, v197, v213
    s_waitcnt vmcnt(0)
    v_mfma_f32_16x16x32_bf16 v[128:131], v[112:115], a[16:19], v[128:131]
    ds_read_b128 v[228:231], v12 offset:33792
    v_add_f32_e64 v198, v198, v214
    v_mfma_f32_16x16x32_bf16 v[132:135], v[116:119], a[16:19], v[132:135]
    ds_read_b128 v[232:235], v12 offset:34816
    v_add_f32_e64 v199, v199, v215
    v_mfma_f32_16x16x32_bf16 v[136:139], v[120:123], a[16:19], v[136:139]
    ds_read_b128 v[236:239], v12 offset:35840
    v_add_f32_e64 v200, v200, v216
    v_mfma_f32_16x16x32_bf16 v[140:143], v[124:127], a[16:19], v[140:143]
    v_add_f32 v201, v201, v217
    v_add_f32 v202, v202, v218
    v_add_f32_e64 v203, v203, v219
    v_pk_add_f32 v[204:205], v[204:205], v[220:221]
    v_pk_add_f32 v[206:207], v[206:207], v[222:223]
    s_waitcnt lgkmcnt(3)
    v_pk_add_f32 v[192:193], v[192:193], v[224:225]
    v_pk_add_f32 v[194:195], v[194:195], v[226:227]
    s_waitcnt lgkmcnt(2)
    v_pk_add_f32 v[196:197], v[196:197], v[228:229]
    v_pk_add_f32 v[198:199], v[198:199], v[230:231]
    s_waitcnt lgkmcnt(1)
    v_pk_add_f32 v[200:201], v[200:201], v[232:233]
    v_pk_add_f32 v[202:203], v[202:203], v[234:235]
    s_waitcnt lgkmcnt(0)
    v_pk_add_f32 v[204:205], v[204:205], v[236:237]
    v_pk_add_f32 v[206:207], v[206:207], v[238:239]
    v_pk_add_f32 v[128:129], v[128:129], v[192:193]
    v_pk_add_f32 v[130:131], v[130:131], v[194:195]
    v_cvt_pk_bf16_f32 v32, v128, v129
    v_cvt_pk_bf16_f32 v33, v130, v131
    v_pk_add_f32 v[132:133], v[132:133], v[196:197]
    v_pk_add_f32 v[134:135], v[134:135], v[198:199]
    v_cvt_pk_bf16_f32 v34, v132, v133
    v_cvt_pk_bf16_f32 v35, v134, v135
    s_nop 0
    v_permlane16_swap_b32 v32, v34
    v_permlane16_swap_b32 v33, v35
    ds_bpermute_b32 v40, v18, v32
    ds_bpermute_b32 v41, v18, v33
    ds_bpermute_b32 v42, v18, v34
    ds_bpermute_b32 v43, v18, v35
    v_pk_add_f32 v[136:137], v[136:137], v[200:201]
    v_pk_add_f32 v[138:139], v[138:139], v[202:203]
    v_cvt_pk_bf16_f32 v36, v136, v137
    v_cvt_pk_bf16_f32 v37, v138, v139
    v_pk_add_f32 v[140:141], v[140:141], v[204:205]
    v_pk_add_f32 v[142:143], v[142:143], v[206:207]
    v_cvt_pk_bf16_f32 v38, v140, v141
    v_cvt_pk_bf16_f32 v39, v142, v143
    s_nop 0
    v_permlane16_swap_b32 v36, v38
    v_permlane16_swap_b32 v37, v39
    ds_bpermute_b32 v44, v18, v36
    ds_bpermute_b32 v45, v18, v37
    ds_bpermute_b32 v46, v18, v38
    ds_bpermute_b32 v47, v18, v39
    s_waitcnt lgkmcnt(4)
    buffer_store_dwordx4 v[40:43], v17, s[76:79], s53 offen offset:0 sc1
    s_waitcnt lgkmcnt(0)
    buffer_store_dwordx4 v[44:47], v17, s[76:79], s53 offen offset:64 sc1
    s_endpgm
.p2align 12
L_kvmain:
    buffer_load_dwordx4 v8, s[80:83], s52 offen offset:2048 lds
    buffer_load_dwordx4 v9, s[80:83], s52 offen offset:3072 lds
    s_addk_i32 s53, 128
    s_and_b32 s53, s53, 0x3ff
    s_add_u32 m0, s51, 32768
    s_waitcnt vmcnt(12)
    s_barrier
    ds_read_b128 a[0:3], v10 offset:0
    ds_read_b128 a[4:7], v10 offset:2048
    ds_read_b128 a[8:11], v10 offset:4096
    ds_read_b128 a[12:15], v10 offset:6144
    ds_read_b64_tr_b16 v[32:33], v14 offset:0
    ds_read_b64_tr_b16 v[34:35], v14 offset:1024
    ds_read_b64_tr_b16 v[36:37], v15 offset:0
    ds_read_b64_tr_b16 v[38:39], v15 offset:1024
    ds_read_b64_tr_b16 v[40:41], v14 offset:4096
    ds_read_b64_tr_b16 v[42:43], v14 offset:5120
    ds_read_b64_tr_b16 v[44:45], v15 offset:4096
    ds_read_b64_tr_b16 v[46:47], v15 offset:5120
    buffer_load_dwordx4 v2, s[28:31], s53 offen offset:0 lds
    buffer_load_dwordx4 v3, s[28:31], s53 offen offset:1024 lds
    buffer_load_dwordx4 v4, s[28:31], s53 offen offset:2048 lds
    buffer_load_dwordx4 v5, s[28:31], s53 offen offset:3072 lds
    s_add_u32 s98, s98, 2
    s_and_b32 s98, s98, 15
    s_add_u32 m0, s50, 32768
    s_mul_i32 s52, s98, 98304
    s_waitcnt lgkmcnt(6)
    v_mfma_f32_16x16x32_bf16 v[192:195], v[32:35], a[0:3], 0
    buffer_load_dwordx4 v6, s[80:83], s52 offen offset:0 lds
    ds_read_b64_tr_b16 v[48:49], v14 offset:8192
    v_mfma_f32_16x16x32_bf16 v[200:203], v[32:35], a[4:7], 0
    ds_read_b64_tr_b16 v[50:51], v14 offset:9216
    v_mfma_f32_16x16x32_bf16 v[208:211], v[32:35], a[8:11], 0
    ds_read_b128 a[16:19], v11 offset:0
    v_mfma_f32_16x16x32_bf16 v[216:219], v[32:35], a[12:15], 0
    buffer_load_dwordx4 v7, s[80:83], s52 offen offset:1024 lds
    ds_read_b128 a[20:23], v11 offset:2048
    s_waitcnt lgkmcnt(6)
    v_mfma_f32_16x16x32_bf16 v[220:223], v[36:39], a[12:15], 0
    ds_read_b128 a[24:27], v11 offset:4096
    v_mfma_f32_16x16x32_bf16 v[212:215], v[36:39], a[8:11], 0
    ds_read_b128 a[28:31], v11 offset:6144
    v_mfma_f32_16x16x32_bf16 v[204:207], v[36:39], a[4:7], 0
    buffer_load_dwordx4 v8, s[80:83], s52 offen offset:2048 lds
    v_mfma_f32_16x16x32_bf16 v[196:199], v[36:39], a[0:3], 0
    ds_read_b64_tr_b16 v[52:53], v15 offset:8192
    v_mfma_f32_16x16x32_bf16 v[224:227], a[0:3], v[40:43], 0
    ds_read_b64_tr_b16 v[54:55], v15 offset:9216
    v_mfma_f32_16x16x32_bf16 v[228:231], a[4:7], v[40:43], 0
    buffer_load_dwordx4 v9, s[80:83], s52 offen offset:3072 lds
    v_mfma_f32_16x16x32_bf16 v[232:235], a[8:11], v[40:43], 0
    ds_read_b64_tr_b16 v[56:57], v14 offset:12288
    s_addk_i32 s53, 128
    s_and_b32 s53, s53, 0x3ff
    v_mfma_f32_16x16x32_bf16 v[236:239], a[12:15], v[40:43], 0
    ds_read_b64_tr_b16 v[58:59], v14 offset:13312
    s_add_u32 m0, s51, 49152
    s_waitcnt lgkmcnt(5)
    v_mfma_f32_16x16x32_bf16 v[252:255], a[12:15], v[44:47], 0
    buffer_load_dwordx4 v2, s[28:31], s53 offen offset:0 lds
    v_mfma_f32_16x16x32_bf16 v[248:251], a[8:11], v[44:47], 0
    ds_read_b64_tr_b16 v[60:61], v15 offset:12288
    v_mfma_f32_16x16x32_bf16 v[244:247], a[4:7], v[44:47], 0
    ds_read_b64_tr_b16 v[62:63], v15 offset:13312
    s_waitcnt vmcnt(9) lgkmcnt(0)
    v_mfma_f32_16x16x32_bf16 v[240:243], a[0:3], v[44:47], 0
    s_barrier
    v_mfma_f32_16x16x32_bf16 v[192:195], v[48:51], a[16:19], v[192:195]
    buffer_load_dwordx4 v3, s[28:31], s53 offen offset:1024 lds
    ds_read_b128 a[32:35], v10 offset:16384
    v_mfma_f32_16x16x32_bf16 v[200:203], v[48:51], a[20:23], v[200:203]
    ds_read_b64_tr_b16 v[32:33], v14 offset:16384
    v_mfma_f32_16x16x32_bf16 v[208:211], v[48:51], a[24:27], v[208:211]
    ds_read_b64_tr_b16 v[34:35], v14 offset:17408
    v_mfma_f32_16x16x32_bf16 v[216:219], v[48:51], a[28:31], v[216:219]
    buffer_load_dwordx4 v4, s[28:31], s53 offen offset:2048 lds
    v_mfma_f32_16x16x32_bf16 v[220:223], v[52:55], a[28:31], v[220:223]
    ds_read_b128 a[36:39], v10 offset:18432
    v_mfma_f32_16x16x32_bf16 v[212:215], v[52:55], a[24:27], v[212:215]
    ds_read_b128 a[40:43], v10 offset:20480
    v_mfma_f32_16x16x32_bf16 v[204:207], v[52:55], a[20:23], v[204:207]
    buffer_load_dwordx4 v5, s[28:31], s53 offen offset:3072 lds
    v_mfma_f32_16x16x32_bf16 v[196:199], v[52:55], a[16:19], v[196:199]
    ds_read_b128 a[44:47], v10 offset:22528
    s_add_u32 s98, s98, 2
    s_and_b32 s98, s98, 15
    v_mfma_f32_16x16x32_bf16 v[224:227], a[16:19], v[56:59], v[224:227]
    ds_read_b64_tr_b16 v[36:37], v15 offset:16384
    s_add_u32 m0, s50, 49152
    s_mul_i32 s52, s98, 98304
    v_mfma_f32_16x16x32_bf16 v[228:231], a[20:23], v[56:59], v[228:231]
    buffer_load_dwordx4 v6, s[80:83], s52 offen offset:0 lds
    v_mfma_f32_16x16x32_bf16 v[232:235], a[24:27], v[56:59], v[232:235]
    ds_read_b64_tr_b16 v[38:39], v15 offset:17408
    v_mfma_f32_16x16x32_bf16 v[236:239], a[28:31], v[56:59], v[236:239]
    ds_read_b64_tr_b16 v[40:41], v14 offset:20480
    v_mfma_f32_16x16x32_bf16 v[252:255], a[28:31], v[60:63], v[252:255]
    buffer_load_dwordx4 v7, s[80:83], s52 offen offset:1024 lds
    v_mfma_f32_16x16x32_bf16 v[248:251], a[24:27], v[60:63], v[248:251]
    ds_read_b64_tr_b16 v[42:43], v14 offset:21504
    v_mfma_f32_16x16x32_bf16 v[244:247], a[20:23], v[60:63], v[244:247]
    ds_read_b64_tr_b16 v[44:45], v15 offset:20480
    v_mfma_f32_16x16x32_bf16 v[240:243], a[16:19], v[60:63], v[240:243]
    ds_read_b64_tr_b16 v[46:47], v15 offset:21504
    s_waitcnt lgkmcnt(5)
    v_mfma_f32_16x16x32_bf16 v[192:195], v[32:35], a[32:35], v[192:195]
    buffer_load_dwordx4 v8, s[80:83], s52 offen offset:2048 lds
    ds_read_b64_tr_b16 v[48:49], v14 offset:24576
    v_mfma_f32_16x16x32_bf16 v[200:203], v[32:35], a[36:39], v[200:203]
    ds_read_b64_tr_b16 v[50:51], v14 offset:25600
    v_mfma_f32_16x16x32_bf16 v[208:211], v[32:35], a[40:43], v[208:211]
    ds_read_b128 a[48:51], v11 offset:16384
    v_mfma_f32_16x16x32_bf16 v[216:219], v[32:35], a[44:47], v[216:219]
    buffer_load_dwordx4 v9, s[80:83], s52 offen offset:3072 lds
    ds_read_b128 a[52:55], v11 offset:18432
    s_waitcnt lgkmcnt(7)
    v_mfma_f32_16x16x32_bf16 v[220:223], v[36:39], a[44:47], v[220:223]
    ds_read_b128 a[56:59], v11 offset:20480
    s_and_b32 s87, s2, 0x87
    s_cbranch_scc1 L_nosigKV
    s_lshl_b32 s87, s42, 4
    buffer_store_dwordx4 v[24:27], v18, s[72:75], s87 offen sc1
L_nosigKV:
    s_addk_i32 s53, 128
    v_mfma_f32_16x16x32_bf16 v[212:215], v[36:39], a[40:43], v[212:215]
    ds_read_b128 a[60:63], v11 offset:22528
    s_and_b32 s53, s53, 0x3ff
    s_add_u32 m0, s51, 0
    v_mfma_f32_16x16x32_bf16 v[204:207], v[36:39], a[36:39], v[204:207]
    buffer_load_dwordx4 v2, s[28:31], s53 offen offset:0 lds
    v_mfma_f32_16x16x32_bf16 v[196:199], v[36:39], a[32:35], v[196:199]
    ds_read_b64_tr_b16 v[52:53], v15 offset:24576
    s_waitcnt lgkmcnt(5)
    v_mfma_f32_16x16x32_bf16 v[224:227], a[32:35], v[40:43], v[224:227]
    ds_read_b64_tr_b16 v[54:55], v15 offset:25600
    v_mfma_f32_16x16x32_bf16 v[228:231], a[36:39], v[40:43], v[228:231]
    buffer_load_dwordx4 v3, s[28:31], s53 offen offset:1024 lds
    v_mfma_f32_16x16x32_bf16 v[232:235], a[40:43], v[40:43], v[232:235]
    ds_read_b64_tr_b16 v[56:57], v14 offset:28672
    v_mfma_f32_16x16x32_bf16 v[236:239], a[44:47], v[40:43], v[236:239]
    ds_read_b64_tr_b16 v[58:59], v14 offset:29696
    v_mfma_f32_16x16x32_bf16 v[252:255], a[44:47], v[44:47], v[252:255]
    buffer_load_dwordx4 v4, s[28:31], s53 offen offset:2048 lds
    v_mfma_f32_16x16x32_bf16 v[248:251], a[40:43], v[44:47], v[248:251]
    ds_read_b64_tr_b16 v[60:61], v15 offset:28672
    v_mfma_f32_16x16x32_bf16 v[244:247], a[36:39], v[44:47], v[244:247]
    ds_read_b64_tr_b16 v[62:63], v15 offset:29696
    s_waitcnt vmcnt(11) lgkmcnt(0)
    v_mfma_f32_16x16x32_bf16 v[240:243], a[32:35], v[44:47], v[240:243]
    s_barrier
    v_mfma_f32_16x16x32_bf16 v[192:195], v[48:51], a[48:51], v[192:195]
    buffer_load_dwordx4 v5, s[28:31], s53 offen offset:3072 lds
    ds_read_b128 a[64:67], v10 offset:32768
    v_mfma_f32_16x16x32_bf16 v[200:203], v[48:51], a[52:55], v[200:203]
    ds_read_b64_tr_b16 v[32:33], v14 offset:32768
    s_add_u32 s98, s98, 2
    s_and_b32 s98, s98, 15
    v_mfma_f32_16x16x32_bf16 v[208:211], v[48:51], a[56:59], v[208:211]
    ds_read_b64_tr_b16 v[34:35], v14 offset:33792
    s_add_u32 m0, s50, 0
    s_mul_i32 s52, s98, 98304
    v_mfma_f32_16x16x32_bf16 v[216:219], v[48:51], a[60:63], v[216:219]
    buffer_load_dwordx4 v6, s[80:83], s52 offen offset:0 lds
    v_mfma_f32_16x16x32_bf16 v[220:223], v[52:55], a[60:63], v[220:223]
    ds_read_b128 a[68:71], v10 offset:34816
    v_mfma_f32_16x16x32_bf16 v[212:215], v[52:55], a[56:59], v[212:215]
    ds_read_b128 a[72:75], v10 offset:36864
    v_mfma_f32_16x16x32_bf16 v[204:207], v[52:55], a[52:55], v[204:207]
    buffer_load_dwordx4 v7, s[80:83], s52 offen offset:1024 lds
    v_mfma_f32_16x16x32_bf16 v[196:199], v[52:55], a[48:51], v[196:199]
    ds_read_b128 a[76:79], v10 offset:38912
    v_mfma_f32_16x16x32_bf16 v[224:227], a[48:51], v[56:59], v[224:227]
    ds_read_b64_tr_b16 v[36:37], v15 offset:32768
    v_mfma_f32_16x16x32_bf16 v[228:231], a[52:55], v[56:59], v[228:231]
    buffer_load_dwordx4 v8, s[80:83], s52 offen offset:2048 lds
    v_mfma_f32_16x16x32_bf16 v[232:235], a[56:59], v[56:59], v[232:235]
    ds_read_b64_tr_b16 v[38:39], v15 offset:33792
    v_mfma_f32_16x16x32_bf16 v[236:239], a[60:63], v[56:59], v[236:239]
    ds_read_b64_tr_b16 v[40:41], v14 offset:36864
    v_mfma_f32_16x16x32_bf16 v[252:255], a[60:63], v[60:63], v[252:255]
    buffer_load_dwordx4 v9, s[80:83], s52 offen offset:3072 lds
    v_mfma_f32_16x16x32_bf16 v[248:251], a[56:59], v[60:63], v[248:251]
    ds_read_b64_tr_b16 v[42:43], v14 offset:37888
    s_addk_i32 s53, 128
    v_mfma_f32_16x16x32_bf16 v[244:247], a[52:55], v[60:63], v[244:247]
    ds_read_b64_tr_b16 v[44:45], v15 offset:36864
    s_and_b32 s53, s53, 0x3ff
    v_mfma_f32_16x16x32_bf16 v[240:243], a[48:51], v[60:63], v[240:243]
    ds_read_b64_tr_b16 v[46:47], v15 offset:37888
    s_add_u32 m0, s51, 16384
    s_waitcnt lgkmcnt(5)
    v_mfma_f32_16x16x32_bf16 v[192:195], v[32:35], a[64:67], v[192:195]
    buffer_load_dwordx4 v2, s[28:31], s53 offen offset:0 lds
    ds_read_b64_tr_b16 v[48:49], v14 offset:40960
    v_mfma_f32_16x16x32_bf16 v[200:203], v[32:35], a[68:71], v[200:203]
    ds_read_b64_tr_b16 v[50:51], v14 offset:41984
    v_mfma_f32_16x16x32_bf16 v[208:211], v[32:35], a[72:75], v[208:211]
    ds_read_b128 a[80:83], v11 offset:32768
    v_mfma_f32_16x16x32_bf16 v[216:219], v[32:35], a[76:79], v[216:219]
    buffer_load_dwordx4 v3, s[28:31], s53 offen offset:1024 lds
    ds_read_b128 a[84:87], v11 offset:34816
    s_waitcnt lgkmcnt(7)
    v_mfma_f32_16x16x32_bf16 v[220:223], v[36:39], a[76:79], v[220:223]
    ds_read_b128 a[88:91], v11 offset:36864
    v_mfma_f32_16x16x32_bf16 v[212:215], v[36:39], a[72:75], v[212:215]
    ds_read_b128 a[92:95], v11 offset:38912
    v_mfma_f32_16x16x32_bf16 v[204:207], v[36:39], a[68:71], v[204:207]
    buffer_load_dwordx4 v4, s[28:31], s53 offen offset:2048 lds
    v_mfma_f32_16x16x32_bf16 v[196:199], v[36:39], a[64:67], v[196:199]
    ds_read_b64_tr_b16 v[52:53], v15 offset:40960
    s_waitcnt lgkmcnt(6)
    v_mfma_f32_16x16x32_bf16 v[224:227], a[64:67], v[40:43], v[224:227]
    ds_read_b64_tr_b16 v[54:55], v15 offset:41984
    v_mfma_f32_16x16x32_bf16 v[228:231], a[68:71], v[40:43], v[228:231]
    buffer_load_dwordx4 v5, s[28:31], s53 offen offset:3072 lds
    v_mfma_f32_16x16x32_bf16 v[232:235], a[72:75], v[40:43], v[232:235]
    ds_read_b64_tr_b16 v[56:57], v14 offset:45056
    s_add_u32 s98, s98, 2
    s_and_b32 s98, s98, 15
    v_mfma_f32_16x16x32_bf16 v[236:239], a[76:79], v[40:43], v[236:239]
    ds_read_b64_tr_b16 v[58:59], v14 offset:46080
    s_add_u32 m0, s50, 16384
    s_mul_i32 s52, s98, 98304
    v_mfma_f32_16x16x32_bf16 v[252:255], a[76:79], v[44:47], v[252:255]
    buffer_load_dwordx4 v6, s[80:83], s52 offen offset:0 lds
    v_mfma_f32_16x16x32_bf16 v[248:251], a[72:75], v[44:47], v[248:251]
    ds_read_b64_tr_b16 v[60:61], v15 offset:45056
    v_mfma_f32_16x16x32_bf16 v[244:247], a[68:71], v[44:47], v[244:247]
    ds_read_b64_tr_b16 v[62:63], v15 offset:46080
    s_waitcnt vmcnt(13) lgkmcnt(0)
    v_mfma_f32_16x16x32_bf16 v[240:243], a[64:67], v[44:47], v[240:243]
    s_barrier
    v_mfma_f32_16x16x32_bf16 v[192:195], v[48:51], a[80:83], v[192:195]
    buffer_load_dwordx4 v7, s[80:83], s52 offen offset:1024 lds
    ds_read_b128 a[96:99], v10 offset:49152
    v_mfma_f32_16x16x32_bf16 v[200:203], v[48:51], a[84:87], v[200:203]
    ds_read_b64_tr_b16 v[32:33], v14 offset:49152
    v_mfma_f32_16x16x32_bf16 v[208:211], v[48:51], a[88:91], v[208:211]
    ds_read_b64_tr_b16 v[34:35], v14 offset:50176
    v_mfma_f32_16x16x32_bf16 v[216:219], v[48:51], a[92:95], v[216:219]
    buffer_load_dwordx4 v8, s[80:83], s52 offen offset:2048 lds
    v_mfma_f32_16x16x32_bf16 v[220:223], v[52:55], a[92:95], v[220:223]
    ds_read_b128 a[100:103], v10 offset:51200
    v_mfma_f32_16x16x32_bf16 v[212:215], v[52:55], a[88:91], v[212:215]
    ds_read_b128 a[104:107], v10 offset:53248
    v_mfma_f32_16x16x32_bf16 v[204:207], v[52:55], a[84:87], v[204:207]
    buffer_load_dwordx4 v9, s[80:83], s52 offen offset:3072 lds
    v_mfma_f32_16x16x32_bf16 v[196:199], v[52:55], a[80:83], v[196:199]
    ds_read_b128 a[108:111], v10 offset:55296
    s_addk_i32 s53, 128
    s_and_b32 s53, s53, 0x3ff
    v_mfma_f32_16x16x32_bf16 v[224:227], a[80:83], v[56:59], v[224:227]
    ds_read_b64_tr_b16 v[36:37], v15 offset:49152
    s_add_u32 m0, s51, 32768
    v_mfma_f32_16x16x32_bf16 v[228:231], a[84:87], v[56:59], v[228:231]
    buffer_load_dwordx4 v2, s[28:31], s53 offen offset:0 lds
    v_mfma_f32_16x16x32_bf16 v[232:235], a[88:91], v[56:59], v[232:235]
    ds_read_b64_tr_b16 v[38:39], v15 offset:50176
    v_mfma_f32_16x16x32_bf16 v[236:239], a[92:95], v[56:59], v[236:239]
    ds_read_b64_tr_b16 v[40:41], v14 offset:53248
    v_mfma_f32_16x16x32_bf16 v[252:255], a[92:95], v[60:63], v[252:255]
    buffer_load_dwordx4 v3, s[28:31], s53 offen offset:1024 lds
    v_mfma_f32_16x16x32_bf16 v[248:251], a[88:91], v[60:63], v[248:251]
    ds_read_b64_tr_b16 v[42:43], v14 offset:54272
    v_mfma_f32_16x16x32_bf16 v[244:247], a[84:87], v[60:63], v[244:247]
    ds_read_b64_tr_b16 v[44:45], v15 offset:53248
    v_mfma_f32_16x16x32_bf16 v[240:243], a[80:83], v[60:63], v[240:243]
    ds_read_b64_tr_b16 v[46:47], v15 offset:54272
    s_lshl_b32 s48, s44, 7
    s_addk_i32 s48, 2048
    v_add_u32 v28, s48, v28
    s_lshl3_add_u32 s48, s43, s44
    s_lshl2_add_u32 s48, s48, s40
    s_mul_i32 s49, s48, 12
    s_addk_i32 s49, 8192
    s_lshl_b32 s48, s48, 3
    v_add_lshl_u32 v120, v0, s49, 7
    v_cmp_gt_u32_e64 vcc, 12, v0
    v_add_lshl_u32 v122, v0, s48, 7
    s_nop 0
    v_cndmask_b32 v184, v121, v120, vcc
    v_cmp_gt_u32 vcc, 8, v0
    s_lshl2_add_u32 s48, s43, s40
    s_lshl_b32 s48, s48, 3
    v_cndmask_b32 v185, v121, v122, vcc
    v_add_u32_e64 v120, s48, v0
    v_mul_u32_u24 v120, 3072, v120
    s_lshl_b32 s48, s44, 7
    v_add_u32 v120, s48, v120
    v_cndmask_b32 v187, v121, v120, vcc
    s_lshl1_add_u32 s48, s43, s47
    s_lshl_b32 s48, s48, 4
    v_add_u32 v120, s48, v0
    v_mul_u32_u24 v120, 3584, v120
    v_cmp_gt_u32 vcc, 16, v0
    s_lshl_b32 s48, s44, 6
    s_addk_i32 s48, 3072
    v_add_u32 v120, s48, v120
    v_cndmask_b32 v186, v121, v120, vcc
    s_lshr_b32 s48, s42, 4
    s_lshl3_add_u32 s48, s48, s91
    s_lshl2_add_u32 s48, s48, s40
    s_mul_i32 s49, s48, 28
    s_sub_u32 s49, s49, 12
    v_subrev_u32 v122, 12, v0
    v_cmp_gt_u32 vcc, 28, v122
    v_add_lshl_u32 v120, v0, s49, 10
    v_add_u32 v120, 0x180, v120
    v_cndmask_b32 v184, v184, v120, vcc
    s_lshl_b32 s49, s48, 3
    s_sub_u32 s49, s49, 8
    v_subrev_u32 v122, 8, v0
    v_cmp_gt_u32_e64 vcc, 8, v122
    v_add_lshl_u32 v120, v0, s49, 10
    v_add_u32 v120, 0x180, v120
    v_cndmask_b32 v185, v185, v120, vcc
    s_and_b32 s48, s2, 7
    s_lshr_b32 s90, s42, 3
    s_lshl2_add_u32 s90, s48, s90
    s_bfe_u32 s48, s91, 0x10000
    s_xor_b32 s90, s90, s48
    s_lshl_b32 s4, s40, 18
    s_lshl_b32 s7, s40, 17
    s_add_u32 s5, s7, 1048576
    s_lshl_b32 s6, s40, 16
    s_add_u32 s6, s6, 1572864
    s_mul_i32 s48, s90, 294912
    s_add_u32 s48, s48, 0x100000
    s_lshr_b32 s8, s4, 3
    s_add_u32 s8, s8, s48
    s_lshr_b32 s9, s5, 3
    s_add_u32 s9, s9, s48
    s_lshr_b32 s10, s6, 3
    s_add_u32 s10, s10, s48
    s_add_u32 s11, s9, 98304
    s_and_b32 s48, s2, 7
    s_lshl_b32 s100, s48, 15
    s_lshl_b32 s101, s48, 12
    s_bfe_u32 s48, s90, 0x10001
    s_lshl_b32 s49, s48, 17
    s_add_u32 s4, s4, s49
    s_lshl_b32 s49, s48, 14
    s_add_u32 s8, s8, s49
    s_lshl_b32 s49, s48, 16
    s_add_u32 s7, s7, s49
    s_lshl_b32 s49, s48, 13
    s_add_u32 s11, s11, s49
    v_add_u32 v21, 15360, v20
    v_add_u32 v22, 6144, v20
    s_waitcnt lgkmcnt(0)
    v_mfma_f32_16x16x32_bf16 v[192:195], v[32:35], a[96:99], v[192:195]
    buffer_load_dwordx4 v4, s[28:31], s53 offen offset:2048 lds
    ds_read_b64_tr_b16 v[48:49], v14 offset:57344
    v_mfma_f32_16x16x32_bf16 v[200:203], v[32:35], a[100:103], v[200:203]
    ds_read_b64_tr_b16 v[50:51], v14 offset:58368
    v_add_u32 v23, 21504, v20
    v_mfma_f32_16x16x32_bf16 v[208:211], v[32:35], a[104:107], v[208:211]
    ds_read_b128 a[112:115], v11 offset:49152
    s_mov_b32 s88, 0x3fb8aa3b
    v_mfma_f32_16x16x32_bf16 v[216:219], v[32:35], a[108:111], v[216:219]
    buffer_load_dwordx4 v5, s[28:31], s53 offen offset:3072 lds
    ds_read_b128 a[116:119], v11 offset:51200
    v_mfma_f32_16x16x32_bf16 v[220:223], v[36:39], a[108:111], v[220:223]
    ds_read_b128 a[120:123], v11 offset:53248
    s_add_u32 s98, s98, 2
    s_and_b32 s98, s98, 15
    v_mfma_f32_16x16x32_bf16 v[212:215], v[36:39], a[104:107], v[212:215]
    ds_read_b128 a[124:127], v11 offset:55296
    s_add_u32 m0, s50, 32768
    s_mul_i32 s52, s98, 98304
    v_mfma_f32_16x16x32_bf16 v[204:207], v[36:39], a[100:103], v[204:207]
    buffer_load_dwordx4 v6, s[80:83], s52 offen offset:0 lds
    v_mfma_f32_16x16x32_bf16 v[196:199], v[36:39], a[96:99], v[196:199]
    ds_read_b64_tr_b16 v[52:53], v15 offset:57344
    s_mov_b32 s89, s88
    v_mfma_f32_16x16x32_bf16 v[224:227], a[96:99], v[40:43], v[224:227]
    ds_read_b64_tr_b16 v[54:55], v15 offset:58368
    v_mov_b32 v30, 0xc0135761
    v_mfma_f32_16x16x32_bf16 v[228:231], a[100:103], v[40:43], v[228:231]
    buffer_load_dwordx4 v7, s[80:83], s52 offen offset:1024 lds
    v_mfma_f32_16x16x32_bf16 v[232:235], a[104:107], v[40:43], v[232:235]
    ds_read_b64_tr_b16 v[56:57], v14 offset:61440
    v_mov_b32 v31, 0xbdd2d3e8
    v_mfma_f32_16x16x32_bf16 v[236:239], a[108:111], v[40:43], v[236:239]
    ds_read_b64_tr_b16 v[58:59], v14 offset:62464
    s_lshl4_add_u32 s0, s43, s44
    v_mfma_f32_16x16x32_bf16 v[252:255], a[108:111], v[44:47], v[252:255]
    buffer_load_dwordx4 v8, s[80:83], s52 offen offset:2048 lds
    v_mfma_f32_16x16x32_bf16 v[248:251], a[104:107], v[44:47], v[248:251]
    ds_read_b64_tr_b16 v[60:61], v15 offset:61440
    s_lshl_b32 s0, s0, 7
    v_mfma_f32_16x16x32_bf16 v[244:247], a[100:103], v[44:47], v[244:247]
    ds_read_b64_tr_b16 v[62:63], v15 offset:62464
    s_waitcnt vmcnt(15) lgkmcnt(0)
    v_mfma_f32_16x16x32_bf16 v[240:243], a[96:99], v[44:47], v[240:243]
    s_barrier
    v_mfma_f32_16x16x32_bf16 v[192:195], v[48:51], a[112:115], v[192:195]
    buffer_load_dwordx4 v9, s[80:83], s52 offen offset:3072 lds
    ds_read_b128 a[128:131], v10 offset:0
    v_mfma_f32_16x16x32_bf16 v[200:203], v[48:51], a[116:119], v[200:203]
    ds_read_b64_tr_b16 v[32:33], v14 offset:0
    s_addk_i32 s53, 128
    s_and_b32 s53, s53, 0x3ff
    v_mfma_f32_16x16x32_bf16 v[208:211], v[48:51], a[120:123], v[208:211]
    ds_read_b64_tr_b16 v[34:35], v14 offset:1024
    s_add_u32 m0, s51, 49152
    v_mfma_f32_16x16x32_bf16 v[216:219], v[48:51], a[124:127], v[216:219]
    buffer_load_dwordx4 v2, s[28:31], s53 offen offset:0 lds
    v_mfma_f32_16x16x32_bf16 v[220:223], v[52:55], a[124:127], v[220:223]
    ds_read_b128 a[132:135], v10 offset:2048
    s_add_u32 s0, s0, 0x40400
    v_mfma_f32_16x16x32_bf16 v[212:215], v[52:55], a[120:123], v[212:215]
    ds_read_b128 a[136:139], v10 offset:4096
    s_lshr_b32 s1, s90, 1
    v_mfma_f32_16x16x32_bf16 v[204:207], v[52:55], a[116:119], v[204:207]
    buffer_load_dwordx4 v3, s[28:31], s53 offen offset:1024 lds
    v_mfma_f32_16x16x32_bf16 v[196:199], v[52:55], a[112:115], v[196:199]
    ds_read_b128 a[140:143], v10 offset:6144
    s_lshl3_add_u32 s1, s1, s40
    v_mfma_f32_16x16x32_bf16 v[224:227], a[112:115], v[56:59], v[224:227]
    ds_read_b64_tr_b16 v[36:37], v15 offset:0
    s_lshl_b32 s1, s1, 8
    v_mfma_f32_16x16x32_bf16 v[228:231], a[116:119], v[56:59], v[228:231]
    buffer_load_dwordx4 v4, s[28:31], s53 offen offset:2048 lds
    v_mfma_f32_16x16x32_bf16 v[232:235], a[120:123], v[56:59], v[232:235]
    ds_read_b64_tr_b16 v[38:39], v15 offset:1024
    s_add_u32 s1, s1, 0x40000
    v_mfma_f32_16x16x32_bf16 v[236:239], a[124:127], v[56:59], v[236:239]
    ds_read_b64_tr_b16 v[40:41], v14 offset:4096
    s_lshl_b32 s15, s44, 11
    v_mfma_f32_16x16x32_bf16 v[252:255], a[124:127], v[60:63], v[252:255]
    buffer_load_dwordx4 v5, s[28:31], s53 offen offset:3072 lds
    v_mfma_f32_16x16x32_bf16 v[248:251], a[120:123], v[60:63], v[248:251]
    ds_read_b64_tr_b16 v[42:43], v14 offset:5120
    s_add_u32 s98, s98, 2
    v_mfma_f32_16x16x32_bf16 v[244:247], a[116:119], v[60:63], v[244:247]
    ds_read_b64_tr_b16 v[44:45], v15 offset:4096
    s_and_b32 s98, s98, 15
    v_mfma_f32_16x16x32_bf16 v[240:243], a[112:115], v[60:63], v[240:243]
    ds_read_b64_tr_b16 v[46:47], v15 offset:5120
    s_add_u32 m0, s50, 49152
    s_mul_i32 s52, s98, 98304
    s_waitcnt lgkmcnt(5)
    v_mfma_f32_16x16x32_bf16 v[192:195], v[32:35], a[128:131], v[192:195]
    ds_read_b64_tr_b16 v[48:49], v14 offset:8192
    s_add_u32 s15, s15, 0x50000
    v_mfma_f32_16x16x32_bf16 v[200:203], v[32:35], a[132:135], v[200:203]
    buffer_load_dwordx4 v6, s[80:83], s52 offen offset:0 lds
    ds_read_b64_tr_b16 v[50:51], v14 offset:9216
    v_mfma_f32_16x16x32_bf16 v[208:211], v[32:35], a[136:139], v[208:211]
    ds_read_b128 a[144:147], v11 offset:0
    s_lshl_b32 s16, s43, 7
    v_mfma_f32_16x16x32_bf16 v[216:219], v[32:35], a[140:143], v[216:219]
    ds_read_b128 a[148:151], v11 offset:2048
    s_waitcnt lgkmcnt(7)
    v_mfma_f32_16x16x32_bf16 v[220:223], v[36:39], a[140:143], v[220:223]
    ds_read_b128 a[152:155], v11 offset:4096
    s_add_u32 s16, s16, s15
    v_mfma_f32_16x16x32_bf16 v[212:215], v[36:39], a[136:139], v[212:215]
    buffer_load_dwordx4 v7, s[80:83], s52 offen offset:1024 lds
    v_mfma_f32_16x16x32_bf16 v[204:207], v[36:39], a[132:135], v[204:207]
    ds_read_b128 a[156:159], v11 offset:6144
    s_mul_i32 s54, s55, 294912
    v_mfma_f32_16x16x32_bf16 v[196:199], v[36:39], a[128:131], v[196:199]
    ds_read_b64_tr_b16 v[52:53], v15 offset:8192
    s_waitcnt lgkmcnt(6)
    v_mfma_f32_16x16x32_bf16 v[224:227], a[128:131], v[40:43], v[224:227]
    ds_read_b64_tr_b16 v[54:55], v15 offset:9216
    s_add_u32 s54, s54, 0x100000
    v_mfma_f32_16x16x32_bf16 v[228:231], a[132:135], v[40:43], v[228:231]
    buffer_load_dwordx4 v8, s[80:83], s52 offen offset:2048 lds
    v_mfma_f32_16x16x32_bf16 v[232:235], a[136:139], v[40:43], v[232:235]
    ds_read_b64_tr_b16 v[56:57], v14 offset:12288
    v_and_b32 v120, 8, v0
    v_mfma_f32_16x16x32_bf16 v[236:239], a[140:143], v[40:43], v[236:239]
    ds_read_b64_tr_b16 v[58:59], v14 offset:13312
    v_cmp_eq_u32_e64 vcc, 0, v120
    v_mfma_f32_16x16x32_bf16 v[252:255], a[140:143], v[44:47], v[252:255]
    ds_read_b64_tr_b16 v[60:61], v15 offset:12288
    v_mov_b32 v120, 0x0c0c0c0c
    v_mfma_f32_16x16x32_bf16 v[248:251], a[136:139], v[44:47], v[248:251]
    buffer_load_dwordx4 v9, s[80:83], s52 offen offset:3072 lds
    v_mfma_f32_16x16x32_bf16 v[244:247], a[132:135], v[44:47], v[244:247]
    ds_read_b64_tr_b16 v[62:63], v15 offset:13312
    s_waitcnt vmcnt(16) lgkmcnt(0)
    v_mfma_f32_16x16x32_bf16 v[240:243], a[128:131], v[44:47], v[240:243]
    s_barrier
    v_mfma_f32_16x16x32_bf16 v[192:195], v[48:51], a[144:147], v[192:195]
    ds_read_b128 a[160:163], v10 offset:16384
    v_add_u32 v9, 68608, v28
    v_add_u32 v8, 55296, v28
    v_add_u32 v7, 13312, v28
    v_mfma_f32_16x16x32_bf16 v[200:203], v[48:51], a[148:151], v[200:203]
    ds_read_b64_tr_b16 v[32:33], v14 offset:16384
    v_add_u32_e64 v6, 0, v28
    s_add_u32 s98, s98, 2
    s_and_b32 s98, s98, 15
    v_mfma_f32_16x16x32_bf16 v[208:211], v[48:51], a[152:155], v[208:211]
    ds_read_b64_tr_b16 v[34:35], v14 offset:17408
    s_add_u32 m0, s50, 0
    s_mul_i32 s52, s98, 114688
    v_mfma_f32_16x16x32_bf16 v[216:219], v[48:51], a[156:159], v[216:219]
    buffer_load_dwordx4 v6, s[32:35], s52 offen offset:0 lds
    v_mfma_f32_16x16x32_bf16 v[220:223], v[52:55], a[156:159], v[220:223]
    ds_read_b128 a[164:167], v10 offset:18432
    v_mov_b32 v121, 0x05040100
    v_mfma_f32_16x16x32_bf16 v[212:215], v[52:55], a[152:155], v[212:215]
    ds_read_b128 a[168:171], v10 offset:20480
    v_mov_b32 v122, 0x07060302
    v_mfma_f32_16x16x32_bf16 v[204:207], v[52:55], a[148:151], v[204:207]
    ds_read_b128 a[172:175], v10 offset:22528
    v_cndmask_b32 v112, v120, v121, vcc
    v_mfma_f32_16x16x32_bf16 v[196:199], v[52:55], a[144:147], v[196:199]
    buffer_load_dwordx4 v7, s[32:35], s52 offen offset:1024 lds
    v_mfma_f32_16x16x32_bf16 v[224:227], a[144:147], v[56:59], v[224:227]
    ds_read_b64_tr_b16 v[36:37], v15 offset:16384
    v_cndmask_b32_e64 v113, v120, v122, vcc
    v_mfma_f32_16x16x32_bf16 v[228:231], a[148:151], v[56:59], v[228:231]
    ds_read_b64_tr_b16 v[38:39], v15 offset:17408
    v_cndmask_b32_e64 v114, v121, v120, vcc
    v_mfma_f32_16x16x32_bf16 v[232:235], a[152:155], v[56:59], v[232:235]
    ds_read_b64_tr_b16 v[40:41], v14 offset:20480
    v_cndmask_b32_e64 v115, v122, v120, vcc
    v_mfma_f32_16x16x32_bf16 v[236:239], a[156:159], v[56:59], v[236:239]
    buffer_load_dwordx4 v8, s[32:35], s52 offen offset:2048 lds
    v_mfma_f32_16x16x32_bf16 v[252:255], a[156:159], v[60:63], v[252:255]
    ds_read_b64_tr_b16 v[42:43], v14 offset:21504
    v_bfe_u32 v116, v0, 2, 1
    v_mfma_f32_16x16x32_bf16 v[248:251], a[152:155], v[60:63], v[248:251]
    ds_read_b64_tr_b16 v[44:45], v15 offset:20480
    v_mul_u32_u24 v116, 0x8000, v116
    v_mfma_f32_16x16x32_bf16 v[244:247], a[148:151], v[60:63], v[244:247]
    ds_read_b64_tr_b16 v[46:47], v15 offset:21504
    v_lshl_or_b32 v116, v116, 16, v116
    v_mfma_f32_16x16x32_bf16 v[240:243], a[144:147], v[60:63], v[240:243]
    buffer_load_dwordx4 v9, s[32:35], s52 offen offset:3072 lds
    s_waitcnt lgkmcnt(5)
    v_mfma_f32_16x16x32_bf16 v[192:195], v[32:35], a[160:163], v[192:195]
    ds_read_b64_tr_b16 v[48:49], v14 offset:24576
    v_xor_b32 v104, v116, v104
    v_mfma_f32_16x16x32_bf16 v[200:203], v[32:35], a[164:167], v[200:203]
    ds_read_b64_tr_b16 v[50:51], v14 offset:25600
    v_xor_b32_e64 v105, v116, v105
    v_mfma_f32_16x16x32_bf16 v[208:211], v[32:35], a[168:171], v[208:211]
    ds_read_b128 a[176:179], v11 offset:16384
    v_xor_b32_e64 v106, v116, v106
    v_mfma_f32_16x16x32_bf16 v[216:219], v[32:35], a[172:175], v[216:219]
    buffer_load_dword v187, v187, s[80:83], 0 offen
    s_waitcnt lgkmcnt(5)
    v_mfma_f32_16x16x32_bf16 v[220:223], v[36:39], a[172:175], v[220:223]
    ds_read_b128 a[180:183], v11 offset:18432
    v_xor_b32 v107, v116, v107
    v_mfma_f32_16x16x32_bf16 v[212:215], v[36:39], a[168:171], v[212:215]
    ds_read_b128 a[184:187], v11 offset:20480
    v_xor_b32_e64 v108, v116, v108
    v_mfma_f32_16x16x32_bf16 v[204:207], v[36:39], a[164:167], v[204:207]
    ds_read_b128 a[188:191], v11 offset:22528
    v_xor_b32_e64 v109, v116, v109
    v_mfma_f32_16x16x32_bf16 v[196:199], v[36:39], a[160:163], v[196:199]
    ds_read_b64_tr_b16 v[52:53], v15 offset:24576
    v_xor_b32_e64 v110, v116, v110
    v_mfma_f32_16x16x32_bf16 v[224:227], a[160:163], v[40:43], v[224:227]
    ds_read_b64_tr_b16 v[54:55], v15 offset:25600
    v_xor_b32_e64 v111, v116, v111
    v_mfma_f32_16x16x32_bf16 v[228:231], a[164:167], v[40:43], v[228:231]
    ds_read_b64_tr_b16 v[56:57], v14 offset:28672
    v_perm_b32 v64, v106, v104, v112
    v_mfma_f32_16x16x32_bf16 v[232:235], a[168:171], v[40:43], v[232:235]
    ds_read_b64_tr_b16 v[58:59], v14 offset:29696
    v_perm_b32 v65, v110, v108, v112
    v_mfma_f32_16x16x32_bf16 v[236:239], a[172:175], v[40:43], v[236:239]
    buffer_load_dword v184, v184, s[56:59], 0 offen
    s_waitcnt lgkmcnt(6)
    v_mfma_f32_16x16x32_bf16 v[252:255], a[172:175], v[44:47], v[252:255]
    ds_read_b64_tr_b16 v[60:61], v15 offset:28672
    v_perm_b32 v66, v106, v104, v114
L_kvmain_s1:
    s_cbranch_execz L_kvmain_s5
    v_mfma_f32_16x16x32_bf16 v[248:251], a[168:171], v[44:47], v[248:251]
    ds_read_b64_tr_b16 v[62:63], v15 offset:29696
    v_perm_b32 v67, v110, v108, v114
    v_mfma_f32_16x16x32_bf16 v[244:247], a[164:167], v[44:47], v[244:247]
    v_perm_b32 v68, v106, v104, v113
    s_waitcnt vmcnt(14) lgkmcnt(0)
    v_mfma_f32_16x16x32_bf16 v[240:243], a[160:163], v[44:47], v[240:243]
    s_barrier
    v_mfma_f32_16x16x32_bf16 v[192:195], v[48:51], a[176:179], v[192:195]
    ds_read_b128 a[192:195], v10 offset:32768
    v_perm_b32 v69, v110, v108, v113
    v_mfma_f32_16x16x32_bf16 v[200:203], v[48:51], a[180:183], v[200:203]
    ds_read_b64_tr_b16 v[32:33], v14 offset:32768
    v_perm_b32 v70, v106, v104, v115
    v_mfma_f32_16x16x32_bf16 v[208:211], v[48:51], a[184:187], v[208:211]
    ds_read_b64_tr_b16 v[34:35], v14 offset:33792
    v_perm_b32 v71, v110, v108, v115
    v_mfma_f32_16x16x32_bf16 v[216:219], v[48:51], a[188:191], v[216:219]
    buffer_load_dword v185, v185, s[60:63], 0 offen
    v_mfma_f32_16x16x32_bf16 v[220:223], v[52:55], a[188:191], v[220:223]
    ds_read_b128 a[196:199], v10 offset:34816
    v_perm_b32 v72, v107, v105, v112
    v_mfma_f32_16x16x32_bf16 v[212:215], v[52:55], a[184:187], v[212:215]
    ds_read_b128 a[200:203], v10 offset:36864
    v_perm_b32 v73, v111, v109, v112
    v_mfma_f32_16x16x32_bf16 v[204:207], v[52:55], a[180:183], v[204:207]
    ds_read_b128 a[204:207], v10 offset:38912
    v_perm_b32 v74, v107, v105, v114
    v_mfma_f32_16x16x32_bf16 v[196:199], v[52:55], a[176:179], v[196:199]
    ds_read_b64_tr_b16 v[36:37], v15 offset:32768
    v_perm_b32 v75, v111, v109, v114
    v_mfma_f32_16x16x32_bf16 v[224:227], a[176:179], v[56:59], v[224:227]
    ds_read_b64_tr_b16 v[38:39], v15 offset:33792
    v_perm_b32 v76, v107, v105, v113
    v_mfma_f32_16x16x32_bf16 v[228:231], a[180:183], v[56:59], v[228:231]
    ds_read_b64_tr_b16 v[40:41], v14 offset:36864
    v_perm_b32 v77, v111, v109, v113
    v_mfma_f32_16x16x32_bf16 v[232:235], a[184:187], v[56:59], v[232:235]
    ds_read_b64_tr_b16 v[42:43], v14 offset:37888
    v_perm_b32 v78, v107, v105, v115
    v_mfma_f32_16x16x32_bf16 v[236:239], a[188:191], v[56:59], v[236:239]
    buffer_load_dword v186, v186, s[32:35], 0 offen
    v_mfma_f32_16x16x32_bf16 v[252:255], a[188:191], v[60:63], v[252:255]
    ds_read_b64_tr_b16 v[44:45], v15 offset:36864
    v_perm_b32 v79, v111, v109, v115
    v_mfma_f32_16x16x32_bf16 v[248:251], a[184:187], v[60:63], v[248:251]
    ds_read_b64_tr_b16 v[46:47], v15 offset:37888
    v_bfe_u32 v121, v0, 4, 1
    v_mfma_f32_16x16x32_bf16 v[244:247], a[180:183], v[60:63], v[244:247]
    v_bfe_u32 v122, v0, 3, 1
    v_cmp_eq_u32_e64 vcc, v121, v122
    v_mfma_f32_16x16x32_bf16 v[240:243], a[176:179], v[60:63], v[240:243]
    v_and_b32 v120, 1, v0
    s_waitcnt lgkmcnt(4)
    v_mfma_f32_16x16x32_bf16 v[192:195], v[32:35], a[192:195], v[192:195]
    ds_read_b64_tr_b16 v[48:49], v14 offset:40960
    v_lshlrev_b32_e64 v120, 4, v120
    v_mfma_f32_16x16x32_bf16 v[200:203], v[32:35], a[196:199], v[200:203]
    ds_read_b64_tr_b16 v[50:51], v14 offset:41984
    v_mov_b32 v121, 0x3f80
    v_mfma_f32_16x16x32_bf16 v[208:211], v[32:35], a[200:203], v[208:211]
    ds_read_b128 a[208:211], v11 offset:32768
    v_lshlrev_b32_e64 v120, v120, v121
    v_mfma_f32_16x16x32_bf16 v[216:219], v[32:35], a[204:207], v[216:219]
    ds_read_b128 a[212:215], v11 offset:34816
    v_cndmask_b32_e64 v120, 0, v120, vcc
    v_mfma_f32_16x16x32_bf16 v[220:223], v[36:39], a[204:207], v[220:223]
    ds_read_b128 a[216:219], v11 offset:36864
    v_bfe_u32 v121, v0, 1, 2
    v_mfma_f32_16x16x32_bf16 v[212:215], v[36:39], a[200:203], v[212:215]
    ds_read_b128 a[220:223], v11 offset:38912
    v_lshrrev_b32_e64 v122, 5, v0
    v_mfma_f32_16x16x32_bf16 v[204:207], v[36:39], a[196:199], v[204:207]
    ds_read_b64_tr_b16 v[52:53], v15 offset:40960
    v_lshl_add_u32 v121, v122, 2, v121
    v_mfma_f32_16x16x32_bf16 v[196:199], v[36:39], a[192:195], v[196:199]
    ds_read_b64_tr_b16 v[54:55], v15 offset:41984
    s_waitcnt lgkmcnt(7)
    v_mfma_f32_16x16x32_bf16 v[224:227], a[192:195], v[40:43], v[224:227]
    ds_read_b64_tr_b16 v[56:57], v14 offset:45056
    v_cmp_eq_u32 vcc, 0, v121
    v_mfma_f32_16x16x32_bf16 v[228:231], a[196:199], v[40:43], v[228:231]
    ds_read_b64_tr_b16 v[58:59], v14 offset:46080
    v_cmp_eq_u32 s[48:49], 1, v121
    v_mfma_f32_16x16x32_bf16 v[232:235], a[200:203], v[40:43], v[232:235]
    ds_read_b64_tr_b16 v[60:61], v15 offset:45056
    v_cndmask_b32_e64 v80, 0, v120, vcc
    v_mfma_f32_16x16x32_bf16 v[236:239], a[204:207], v[40:43], v[236:239]
    ds_read_b64_tr_b16 v[62:63], v15 offset:46080
    v_cndmask_b32_e64 v81, 0, v120, s[48:49]
    v_mfma_f32_16x16x32_bf16 v[252:255], a[204:207], v[44:47], v[252:255]
    v_cmp_eq_u32_e64 vcc, 2, v121
    v_cmp_eq_u32 s[48:49], 3, v121
    v_mfma_f32_16x16x32_bf16 v[248:251], a[200:203], v[44:47], v[248:251]
    v_cndmask_b32_e64 v82, 0, v120, vcc
    v_cndmask_b32_e64 v83, 0, v120, s[48:49]
    v_mfma_f32_16x16x32_bf16 v[244:247], a[196:199], v[44:47], v[244:247]
    v_cmp_eq_u32 vcc, 4, v121
    s_waitcnt vmcnt(8) lgkmcnt(0)
    v_mfma_f32_16x16x32_bf16 v[240:243], a[192:195], v[44:47], v[240:243]
    s_barrier
    v_mfma_f32_16x16x32_bf16 v[192:195], v[48:51], a[208:211], v[192:195]
    ds_read_b128 a[224:227], v10 offset:49152
    v_cmp_eq_u32 s[48:49], 5, v121
    v_mfma_f32_16x16x32_bf16 v[200:203], v[48:51], a[212:215], v[200:203]
    ds_read_b64_tr_b16 v[32:33], v14 offset:49152
    v_cndmask_b32 v84, 0, v120, vcc
    v_mfma_f32_16x16x32_bf16 v[208:211], v[48:51], a[216:219], v[208:211]
    ds_read_b64_tr_b16 v[34:35], v14 offset:50176
    v_cndmask_b32_e64 v85, 0, v120, s[48:49]
    v_mfma_f32_16x16x32_bf16 v[216:219], v[48:51], a[220:223], v[216:219]
    ds_read_b128 a[228:231], v10 offset:51200
    v_cmp_eq_u32_e64 vcc, 6, v121
    v_mfma_f32_16x16x32_bf16 v[220:223], v[52:55], a[220:223], v[220:223]
    ds_read_b128 a[232:235], v10 offset:53248
    v_cmp_eq_u32 s[48:49], 7, v121
    v_mfma_f32_16x16x32_bf16 v[212:215], v[52:55], a[216:219], v[212:215]
    ds_read_b128 a[236:239], v10 offset:55296
    v_cndmask_b32_e64 v86, 0, v120, vcc
    v_mfma_f32_16x16x32_bf16 v[204:207], v[52:55], a[212:215], v[204:207]
    ds_read_b64_tr_b16 v[36:37], v15 offset:49152
    v_cndmask_b32_e64 v87, 0, v120, s[48:49]
    v_mfma_f32_16x16x32_bf16 v[196:199], v[52:55], a[208:211], v[196:199]
    ds_read_b64_tr_b16 v[38:39], v15 offset:50176
    v_and_b32_e64 v121, 3, v0
    v_mfma_f32_16x16x32_bf16 v[224:227], a[208:211], v[56:59], v[224:227]
    ds_read_b64_tr_b16 v[40:41], v14 offset:53248
    v_mov_b32 v120, 0x3f803f80
    v_mfma_f32_16x16x32_bf16 v[228:231], a[212:215], v[56:59], v[228:231]
    ds_read_b64_tr_b16 v[42:43], v14 offset:54272
    v_cmp_eq_u32_e64 vcc, 0, v121
    v_mfma_f32_16x16x32_bf16 v[232:235], a[216:219], v[56:59], v[232:235]
    ds_read_b64_tr_b16 v[44:45], v15 offset:53248
    v_cndmask_b32_e64 v88, 0, v120, vcc
    v_mfma_f32_16x16x32_bf16 v[236:239], a[220:223], v[56:59], v[236:239]
    ds_read_b64_tr_b16 v[46:47], v15 offset:54272
    v_cndmask_b32_e64 v89, 0, v120, vcc
    v_mfma_f32_16x16x32_bf16 v[252:255], a[220:223], v[60:63], v[252:255]
    v_cndmask_b32 v90, 0, v120, vcc
    v_cndmask_b32 v91, 0, v120, vcc
    v_mfma_f32_16x16x32_bf16 v[248:251], a[216:219], v[60:63], v[248:251]
    v_cmp_eq_u32_e64 vcc, 1, v121
    v_mfma_f32_16x16x32_bf16 v[244:247], a[212:215], v[60:63], v[244:247]
    v_mfma_f32_16x16x32_bf16 v[240:243], a[208:211], v[60:63], v[240:243]
    v_cndmask_b32 v92, 0, v120, vcc
    s_waitcnt lgkmcnt(3)
    v_mfma_f32_16x16x32_bf16 v[192:195], v[32:35], a[224:227], v[192:195]
    ds_read_b64_tr_b16 v[48:49], v14 offset:57344
    v_cndmask_b32_e64 v93, 0, v120, vcc
    v_mfma_f32_16x16x32_bf16 v[200:203], v[32:35], a[228:231], v[200:203]
    ds_read_b64_tr_b16 v[50:51], v14 offset:58368
    v_cndmask_b32_e64 v94, 0, v120, vcc
    v_mfma_f32_16x16x32_bf16 v[208:211], v[32:35], a[232:235], v[208:211]
    ds_read_b128 a[240:243], v11 offset:49152
    v_cndmask_b32_e64 v95, 0, v120, vcc
    v_mfma_f32_16x16x32_bf16 v[216:219], v[32:35], a[236:239], v[216:219]
    ds_read_b128 a[244:247], v11 offset:51200
    v_cmp_eq_u32_e64 vcc, 2, v121
    v_mfma_f32_16x16x32_bf16 v[220:223], v[36:39], a[236:239], v[220:223]
    ds_read_b128 a[248:251], v11 offset:53248
    v_cndmask_b32_e64 v96, 0, v120, vcc
    v_mfma_f32_16x16x32_bf16 v[212:215], v[36:39], a[232:235], v[212:215]
    ds_read_b128 a[252:255], v11 offset:55296
    v_cndmask_b32_e64 v97, 0, v120, vcc
    v_mfma_f32_16x16x32_bf16 v[204:207], v[36:39], a[228:231], v[204:207]
    ds_read_b64_tr_b16 v[52:53], v15 offset:57344
    v_cndmask_b32_e64 v98, 0, v120, vcc
    v_mfma_f32_16x16x32_bf16 v[196:199], v[36:39], a[224:227], v[196:199]
    ds_read_b64_tr_b16 v[54:55], v15 offset:58368
    s_waitcnt lgkmcnt(7)
    v_mfma_f32_16x16x32_bf16 v[224:227], a[224:227], v[40:43], v[224:227]
    ds_read_b64_tr_b16 v[56:57], v14 offset:61440
    v_cndmask_b32 v99, 0, v120, vcc
    v_mfma_f32_16x16x32_bf16 v[228:231], a[228:231], v[40:43], v[228:231]
    ds_read_b64_tr_b16 v[58:59], v14 offset:62464
    v_cmp_eq_u32_e64 vcc, 3, v121
    v_mfma_f32_16x16x32_bf16 v[232:235], a[232:235], v[40:43], v[232:235]
    ds_read_b64_tr_b16 v[60:61], v15 offset:61440
    v_cndmask_b32_e64 v100, 0, v120, vcc
    v_mfma_f32_16x16x32_bf16 v[236:239], a[236:239], v[40:43], v[236:239]
    ds_read_b64_tr_b16 v[62:63], v15 offset:62464
    v_cndmask_b32_e64 v101, 0, v120, vcc
    v_mfma_f32_16x16x32_bf16 v[252:255], a[236:239], v[44:47], v[252:255]
    v_cndmask_b32 v102, 0, v120, vcc
    v_cndmask_b32 v103, 0, v120, vcc
    v_mfma_f32_16x16x32_bf16 v[248:251], a[232:235], v[44:47], v[248:251]
    v_mfma_f32_16x16x32_bf16 v[244:247], a[228:231], v[44:47], v[244:247]
    s_waitcnt lgkmcnt(0)
    v_mfma_f32_16x16x32_bf16 v[240:243], a[224:227], v[44:47], v[240:243]
    s_barrier
    v_mfma_f32_16x16x32_bf16 v[192:195], v[48:51], a[240:243], v[192:195]
    s_add_u32 s84, s100, 0
    s_and_b32 s84, s84, 229376
    v_mfma_f32_16x16x32_bf16 v[200:203], v[48:51], a[244:247], v[200:203]
    s_add_u32 m0, s50, 131072
    v_mfma_f32_16x16x32_bf16 v[208:211], v[48:51], a[248:251], v[208:211]
    s_xor_b32 s84, s84, s4
    v_mfma_f32_16x16x32_bf16 v[216:219], v[48:51], a[252:255], v[216:219]
    buffer_load_dwordx4 v20, s[56:59], s84 offen offset:0 lds
    v_mfma_f32_16x16x32_bf16 v[220:223], v[52:55], a[252:255], v[220:223]
    v_mfma_f32_16x16x32_bf16 v[212:215], v[52:55], a[248:251], v[212:215]
    v_mfma_f32_16x16x32_bf16 v[204:207], v[52:55], a[244:247], v[204:207]
    v_mfma_f32_16x16x32_bf16 v[196:199], v[52:55], a[240:243], v[196:199]
    buffer_load_dwordx4 v21, s[56:59], s84 offen offset:1024 lds
    v_mfma_f32_16x16x32_bf16 v[224:227], a[240:243], v[56:59], v[224:227]
    v_mfma_f32_16x16x32_bf16 v[228:231], a[244:247], v[56:59], v[228:231]
    v_mfma_f32_16x16x32_bf16 v[232:235], a[248:251], v[56:59], v[232:235]
    v_mfma_f32_16x16x32_bf16 v[236:239], a[252:255], v[56:59], v[236:239]
    buffer_load_dwordx4 v22, s[56:59], s84 offen offset:2048 lds
    v_mfma_f32_16x16x32_bf16 v[252:255], a[252:255], v[60:63], v[252:255]
    v_mfma_f32_16x16x32_bf16 v[248:251], a[248:251], v[60:63], v[248:251]
    v_mfma_f32_16x16x32_bf16 v[244:247], a[244:247], v[60:63], v[244:247]
    v_mfma_f32_16x16x32_bf16 v[240:243], a[240:243], v[60:63], v[240:243]
    buffer_load_dwordx4 v23, s[56:59], s84 offen offset:3072 lds
.p2align 3
    v_cvt_pk_bf16_f32 v172, v192, v193
    v_cvt_pk_bf16_f32 v173, v194, v195
    v_cvt_pk_bf16_f32 v174, v196, v197
    v_cvt_pk_bf16_f32 v175, v198, v199
    s_nop 1
    v_mfma_f32_16x16x32_bf16 v[104:107], v[64:67], v[172:175], 0
    v_cvt_pk_bf16_f32 v224, v224, v225
    v_cvt_pk_bf16_f32 v225, v226, v227
    v_mfma_f32_16x16x32_bf16 v[108:111], v[68:71], v[172:175], 0
    v_cvt_pk_bf16_f32 v226, v228, v229
    v_cvt_pk_bf16_f32 v227, v230, v231
    v_mfma_f32_16x16x32_bf16 v[112:115], v[72:75], v[172:175], 0
    v_cvt_pk_bf16_f32 v232, v232, v233
    v_cvt_pk_bf16_f32 v233, v234, v235
    v_mfma_f32_16x16x32_bf16 v[116:119], v[76:79], v[172:175], 0
    v_cvt_pk_bf16_f32 v234, v236, v237
    v_cvt_pk_bf16_f32 v235, v238, v239
    v_cvt_pk_bf16_f32 v240, v240, v241
    v_cvt_pk_bf16_f32 v241, v242, v243
    v_cvt_pk_bf16_f32 v242, v244, v245
    v_cvt_pk_bf16_f32 v243, v246, v247
    v_cvt_pk_bf16_f32 v248, v248, v249
    v_cvt_pk_bf16_f32 v249, v250, v251
    v_cvt_pk_bf16_f32 v250, v252, v253
    v_cvt_pk_bf16_f32 v251, v254, v255
    v_cvt_pk_bf16_f32 v172, v200, v201
    v_cvt_pk_bf16_f32 v173, v202, v203
    v_cvt_pk_bf16_f32 v174, v204, v205
    v_cvt_pk_bf16_f32 v175, v206, v207
    v_max3_f32 v176, v104, v105, v106
    v_max3_f32 v176, v176, v107, v108
    v_max3_f32 v176, v176, v109, v110
    v_max3_f32 v176, v176, v111, v112
    v_max3_f32 v176, v176, v113, v114
    v_max3_f32 v176, v176, v115, v116
    v_max3_f32 v176, v176, v117, v118
    v_max_f32 v176, v176, v119
    v_mul_f32 v176, 0xbfb8aa3b, v176
    v_pk_fma_f32 v[104:105], v[104:105], s[88:89], v[176:177] op_sel_hi:[1,1,0]
    v_pk_fma_f32 v[106:107], v[106:107], s[88:89], v[176:177] op_sel_hi:[1,1,0]
    v_pk_fma_f32 v[108:109], v[108:109], s[88:89], v[176:177] op_sel_hi:[1,1,0]
    v_pk_fma_f32 v[110:111], v[110:111], s[88:89], v[176:177] op_sel_hi:[1,1,0]
    v_pk_fma_f32 v[112:113], v[112:113], s[88:89], v[176:177] op_sel_hi:[1,1,0]
    v_pk_fma_f32 v[114:115], v[114:115], s[88:89], v[176:177] op_sel_hi:[1,1,0]
    v_pk_fma_f32 v[116:117], v[116:117], s[88:89], v[176:177] op_sel_hi:[1,1,0]
    v_pk_fma_f32 v[118:119], v[118:119], s[88:89], v[176:177] op_sel_hi:[1,1,0]
    v_mfma_f32_16x16x32_bf16 v[120:123], v[64:67], v[172:175], 0
    v_exp_f32 v104, v104
    v_exp_f32 v105, v105
    v_exp_f32 v106, v106
    v_exp_f32 v107, v107
    v_mfma_f32_16x16x32_bf16 v[124:127], v[68:71], v[172:175], 0
    v_exp_f32 v108, v108
    v_exp_f32 v109, v109
    v_exp_f32_e64 v110, v110
    v_mfma_f32_16x16x32_bf16 v[128:131], v[72:75], v[172:175], 0
    v_exp_f32 v111, v111
    v_exp_f32 v112, v112
    v_exp_f32_e64 v113, v113
    v_mfma_f32_16x16x32_bf16 v[132:135], v[76:79], v[172:175], 0
    v_exp_f32 v114, v114
    v_exp_f32 v115, v115
    v_exp_f32 v116, v116
    v_exp_f32 v117, v117
    v_exp_f32 v118, v118
    v_exp_f32 v119, v119
    v_pk_add_f32 v[176:177], v[104:105], v[106:107]
    v_pk_add_f32 v[178:179], v[108:109], v[110:111]
    v_pk_add_f32 v[176:177], v[176:177], v[112:113]
    v_pk_add_f32 v[178:179], v[178:179], v[114:115]
    v_pk_add_f32 v[176:177], v[176:177], v[116:117]
    v_pk_add_f32 v[178:179], v[178:179], v[118:119]
    v_pk_add_f32 v[176:177], v[176:177], v[178:179]
    v_add_f32 v176, v176, v177
    v_rcp_f32 v176, v176
    s_add_u32 s84, s100, 32768
    s_and_b32 s84, s84, 229376
    s_add_u32 m0, s50, 147456
    s_xor_b32 s84, s84, s4
    buffer_load_dwordx4 v20, s[56:59], s84 offen offset:0 lds
    v_pk_mul_f32 v[104:105], v[104:105], v[176:177] op_sel_hi:[1,0]
    v_pk_mul_f32 v[106:107], v[106:107], v[176:177] op_sel_hi:[1,0]
    v_pk_mul_f32 v[108:109], v[108:109], v[176:177] op_sel_hi:[1,0]
    v_pk_mul_f32 v[110:111], v[110:111], v[176:177] op_sel_hi:[1,0]
    v_pk_mul_f32 v[112:113], v[112:113], v[176:177] op_sel_hi:[1,0]
    v_pk_mul_f32 v[114:115], v[114:115], v[176:177] op_sel_hi:[1,0]
    v_pk_mul_f32 v[116:117], v[116:117], v[176:177] op_sel_hi:[1,0]
    v_pk_mul_f32 v[118:119], v[118:119], v[176:177] op_sel_hi:[1,0]
    v_cvt_pk_bf16_f32 v192, v104, v105
    v_cvt_pk_bf16_f32 v193, v106, v107
    buffer_load_dwordx4 v21, s[56:59], s84 offen offset:1024 lds
    v_cvt_pk_bf16_f32 v194, v108, v109
    v_cvt_pk_bf16_f32 v195, v110, v111
    v_cvt_pk_bf16_f32 v196, v112, v113
    v_cvt_pk_bf16_f32 v197, v114, v115
    v_cvt_pk_bf16_f32 v198, v116, v117
    v_cvt_pk_bf16_f32 v199, v118, v119
    v_mfma_f32_16x16x32_bf16 v[104:107], v[192:195], v[80:83], 0
    buffer_load_dwordx4 v22, s[56:59], s84 offen offset:2048 lds
    v_cvt_pk_bf16_f32 v172, v208, v209
    v_cvt_pk_bf16_f32 v173, v210, v211
    v_mfma_f32_16x16x32_bf16 v[112:115], v[192:195], v[84:87], 0
    v_cvt_pk_bf16_f32 v174, v212, v213
    v_cvt_pk_bf16_f32 v175, v214, v215
    v_mfma_f32_16x16x32_bf16 v[108:111], v[196:199], v[80:83], 0
    v_max3_f32 v176, v120, v121, v122
    v_max3_f32 v176, v176, v123, v124
    v_mfma_f32_16x16x32_bf16 v[116:119], v[196:199], v[84:87], 0
    v_max3_f32 v176, v176, v125, v126
    v_max3_f32 v176, v176, v127, v128
    v_max3_f32 v176, v176, v129, v130
    v_max3_f32 v176, v176, v131, v132
    v_max3_f32 v176, v176, v133, v134
    v_max_f32 v176, v176, v135
    v_mul_f32 v176, 0xbfb8aa3b, v176
    v_pk_fma_f32 v[120:121], v[120:121], s[88:89], v[176:177] op_sel_hi:[1,1,0]
    v_pk_fma_f32 v[122:123], v[122:123], s[88:89], v[176:177] op_sel_hi:[1,1,0]
    v_pk_fma_f32 v[124:125], v[124:125], s[88:89], v[176:177] op_sel_hi:[1,1,0]
    v_pk_fma_f32 v[126:127], v[126:127], s[88:89], v[176:177] op_sel_hi:[1,1,0]
    v_pk_fma_f32 v[128:129], v[128:129], s[88:89], v[176:177] op_sel_hi:[1,1,0]
    v_pk_fma_f32 v[130:131], v[130:131], s[88:89], v[176:177] op_sel_hi:[1,1,0]
    v_pk_fma_f32 v[132:133], v[132:133], s[88:89], v[176:177] op_sel_hi:[1,1,0]
    v_pk_fma_f32 v[134:135], v[134:135], s[88:89], v[176:177] op_sel_hi:[1,1,0]
    buffer_load_dwordx4 v23, s[56:59], s84 offen offset:3072 lds
    v_cvt_pk_bf16_f32 v136, v104, v105
    v_cvt_pk_bf16_f32 v137, v106, v107
    v_cvt_pk_bf16_f32 v140, v108, v109
    v_cvt_pk_bf16_f32 v141, v110, v111
    v_cvt_pk_bf16_f32 v144, v112, v113
    v_cvt_pk_bf16_f32 v145, v114, v115
    v_cvt_pk_bf16_f32 v148, v116, v117
    v_cvt_pk_bf16_f32 v149, v118, v119
    v_mfma_f32_16x16x32_bf16 v[104:107], v[64:67], v[172:175], 0
    buffer_load_dword v19, v1, s[72:75], 0 offen offset:0 sc1
    v_exp_f32 v120, v120
    v_exp_f32 v121, v121
    v_exp_f32 v122, v122
    v_exp_f32 v123, v123
    v_mfma_f32_16x16x32_bf16 v[108:111], v[68:71], v[172:175], 0
    v_exp_f32 v124, v124
    v_exp_f32 v125, v125
    v_exp_f32_e64 v126, v126
    v_mfma_f32_16x16x32_bf16 v[112:115], v[72:75], v[172:175], 0
    v_exp_f32_e64 v127, v127
    s_add_u32 s98, s98, 2
    s_and_b32 s98, s98, 15
    s_add_u32 m0, s50, 16384
    s_mul_i32 s52, s98, 114688
    buffer_load_dwordx4 v6, s[32:35], s52 offen offset:0 lds
    v_exp_f32 v128, v128
    v_exp_f32 v129, v129
    v_mfma_f32_16x16x32_bf16 v[116:119], v[76:79], v[172:175], 0
    v_exp_f32 v130, v130
    v_exp_f32 v131, v131
    v_exp_f32 v132, v132
    v_exp_f32 v133, v133
    v_exp_f32 v134, v134
    v_exp_f32 v135, v135
    buffer_load_dwordx4 v7, s[32:35], s52 offen offset:1024 lds
    v_pk_add_f32 v[176:177], v[120:121], v[122:123]
    v_pk_add_f32 v[178:179], v[124:125], v[126:127]
    v_pk_add_f32 v[176:177], v[176:177], v[128:129]
    v_pk_add_f32 v[178:179], v[178:179], v[130:131]
    v_pk_add_f32 v[176:177], v[176:177], v[132:133]
    v_pk_add_f32 v[178:179], v[178:179], v[134:135]
    v_pk_add_f32 v[176:177], v[176:177], v[178:179]
    v_add_f32 v176, v176, v177
    v_rcp_f32 v176, v176
    buffer_load_dwordx4 v8, s[32:35], s52 offen offset:2048 lds
    v_pk_mul_f32 v[120:121], v[120:121], v[176:177] op_sel_hi:[1,0]
    v_pk_mul_f32 v[122:123], v[122:123], v[176:177] op_sel_hi:[1,0]
    v_pk_mul_f32 v[124:125], v[124:125], v[176:177] op_sel_hi:[1,0]
    v_pk_mul_f32 v[126:127], v[126:127], v[176:177] op_sel_hi:[1,0]
    v_pk_mul_f32 v[128:129], v[128:129], v[176:177] op_sel_hi:[1,0]
    v_pk_mul_f32 v[130:131], v[130:131], v[176:177] op_sel_hi:[1,0]
    v_pk_mul_f32 v[132:133], v[132:133], v[176:177] op_sel_hi:[1,0]
    v_pk_mul_f32 v[134:135], v[134:135], v[176:177] op_sel_hi:[1,0]
    v_cvt_pk_bf16_f32 v200, v120, v121
    v_cvt_pk_bf16_f32 v201, v122, v123
    buffer_load_dwordx4 v9, s[32:35], s52 offen offset:3072 lds
    v_cvt_pk_bf16_f32 v202, v124, v125
    v_cvt_pk_bf16_f32 v203, v126, v127
    v_cvt_pk_bf16_f32 v204, v128, v129
    v_cvt_pk_bf16_f32 v205, v130, v131
    v_cvt_pk_bf16_f32 v206, v132, v133
    v_cvt_pk_bf16_f32 v207, v134, v135
    s_add_u32 s84, s100, 65536
    s_and_b32 s84, s84, 229376
    s_add_u32 m0, s50, 65536
    s_xor_b32 s84, s84, s4
    v_mfma_f32_16x16x32_bf16 v[120:123], v[200:203], v[80:83], 0
    buffer_load_dwordx4 v20, s[56:59], s84 offen offset:0 lds
    v_cvt_pk_bf16_f32 v172, v216, v217
    v_cvt_pk_bf16_f32 v173, v218, v219
    v_mfma_f32_16x16x32_bf16 v[128:131], v[200:203], v[84:87], 0
    v_cvt_pk_bf16_f32 v174, v220, v221
    v_cvt_pk_bf16_f32 v175, v222, v223
    v_mfma_f32_16x16x32_bf16 v[124:127], v[204:207], v[80:83], 0
    v_max3_f32 v176, v104, v105, v106
    v_max3_f32 v176, v176, v107, v108
    v_mfma_f32_16x16x32_bf16 v[132:135], v[204:207], v[84:87], 0
    v_max3_f32 v176, v176, v109, v110
    v_max3_f32 v176, v176, v111, v112
    v_max3_f32 v176, v176, v113, v114
    v_max3_f32 v176, v176, v115, v116
    v_max3_f32 v176, v176, v117, v118
    v_max_f32 v176, v176, v119
    v_mul_f32 v176, 0xbfb8aa3b, v176
    v_pk_fma_f32 v[104:105], v[104:105], s[88:89], v[176:177] op_sel_hi:[1,1,0]
    v_pk_fma_f32 v[106:107], v[106:107], s[88:89], v[176:177] op_sel_hi:[1,1,0]
    v_pk_fma_f32 v[108:109], v[108:109], s[88:89], v[176:177] op_sel_hi:[1,1,0]
    v_pk_fma_f32 v[110:111], v[110:111], s[88:89], v[176:177] op_sel_hi:[1,1,0]
    v_pk_fma_f32 v[112:113], v[112:113], s[88:89], v[176:177] op_sel_hi:[1,1,0]
    v_pk_fma_f32 v[114:115], v[114:115], s[88:89], v[176:177] op_sel_hi:[1,1,0]
    v_pk_fma_f32 v[116:117], v[116:117], s[88:89], v[176:177] op_sel_hi:[1,1,0]
    v_pk_fma_f32 v[118:119], v[118:119], s[88:89], v[176:177] op_sel_hi:[1,1,0]
    buffer_load_dwordx4 v21, s[56:59], s84 offen offset:1024 lds
    v_cvt_pk_bf16_f32 v138, v120, v121
    v_cvt_pk_bf16_f32 v139, v122, v123
    v_cvt_pk_bf16_f32 v142, v124, v125
    v_cvt_pk_bf16_f32 v143, v126, v127
    v_cvt_pk_bf16_f32 v146, v128, v129
    v_cvt_pk_bf16_f32 v147, v130, v131
    v_cvt_pk_bf16_f32 v150, v132, v133
    v_cvt_pk_bf16_f32 v151, v134, v135
    v_mfma_f32_16x16x32_bf16 v[120:123], v[64:67], v[172:175], 0
    buffer_load_dwordx4 v22, s[56:59], s84 offen offset:2048 lds
    v_exp_f32 v104, v104
    v_exp_f32 v105, v105
    v_mfma_f32_16x16x32_bf16 v[124:127], v[68:71], v[172:175], 0
    v_exp_f32_e64 v106, v106
    v_mfma_f32_16x16x32_bf16 v[128:131], v[72:75], v[172:175], 0
    v_exp_f32_e64 v107, v107
    v_mfma_f32_16x16x32_bf16 v[132:135], v[76:79], v[172:175], 0
    v_exp_f32_e64 v108, v108
    v_mfma_f32_16x16x32_bf16 v[152:155], v[224:227], v[136:139], 0
    v_exp_f32_e64 v109, v109
    v_mfma_f32_16x16x32_bf16 v[156:159], v[224:227], v[140:143], 0
    v_exp_f32_e64 v110, v110
    v_mfma_f32_16x16x32_bf16 v[160:163], v[240:243], v[144:147], 0
    v_exp_f32_e64 v111, v111
    buffer_load_dwordx4 v23, s[56:59], s84 offen offset:3072 lds
    v_mfma_f32_16x16x32_bf16 v[164:167], v[240:243], v[148:151], 0
    v_exp_f32_e64 v112, v112
    v_mfma_f32_16x16x32_bf16 v[168:171], v[88:91], v[136:139], 0
    v_exp_f32_e64 v113, v113
    v_mfma_f32_16x16x32_bf16 v[168:171], v[92:95], v[140:143], v[168:171]
    v_exp_f32_e64 v114, v114
    v_mfma_f32_16x16x32_bf16 v[168:171], v[96:99], v[144:147], v[168:171]
    v_exp_f32_e64 v115, v115
    v_mfma_f32_16x16x32_bf16 v[168:171], v[100:103], v[148:151], v[168:171]
    v_exp_f32 v116, v116
    v_exp_f32 v117, v117
    v_exp_f32 v118, v118
    v_exp_f32 v119, v119
    s_add_u32 s98, s98, 2
    s_and_b32 s98, s98, 15
    s_add_u32 m0, s50, 32768
    s_mul_i32 s52, s98, 114688
    buffer_load_dwordx4 v6, s[32:35], s52 offen offset:0 lds
    v_pk_add_f32 v[176:177], v[104:105], v[106:107]
    v_pk_add_f32 v[178:179], v[108:109], v[110:111]
    v_pk_add_f32 v[176:177], v[176:177], v[112:113]
    v_pk_add_f32 v[178:179], v[178:179], v[114:115]
    v_pk_add_f32 v[176:177], v[176:177], v[116:117]
    v_pk_add_f32 v[178:179], v[178:179], v[118:119]
    v_pk_add_f32 v[176:177], v[176:177], v[178:179]
    v_add_f32 v176, v176, v177
    v_rcp_f32 v176, v176
    buffer_load_dwordx4 v7, s[32:35], s52 offen offset:1024 lds
    v_pk_mul_f32 v[104:105], v[104:105], v[176:177] op_sel_hi:[1,0]
    v_pk_mul_f32 v[106:107], v[106:107], v[176:177] op_sel_hi:[1,0]
    v_pk_mul_f32 v[108:109], v[108:109], v[176:177] op_sel_hi:[1,0]
    v_pk_mul_f32 v[110:111], v[110:111], v[176:177] op_sel_hi:[1,0]
    v_pk_mul_f32 v[112:113], v[112:113], v[176:177] op_sel_hi:[1,0]
    v_pk_mul_f32 v[114:115], v[114:115], v[176:177] op_sel_hi:[1,0]
    v_pk_mul_f32 v[116:117], v[116:117], v[176:177] op_sel_hi:[1,0]
    v_pk_mul_f32 v[118:119], v[118:119], v[176:177] op_sel_hi:[1,0]
    v_cvt_pk_bf16_f32 v208, v104, v105
    v_cvt_pk_bf16_f32 v209, v106, v107
    buffer_load_dwordx4 v8, s[32:35], s52 offen offset:2048 lds
    v_cvt_pk_bf16_f32 v210, v108, v109
    v_cvt_pk_bf16_f32 v211, v110, v111
    v_cvt_pk_bf16_f32 v212, v112, v113
    v_cvt_pk_bf16_f32 v213, v114, v115
    v_cvt_pk_bf16_f32 v214, v116, v117
    v_cvt_pk_bf16_f32 v215, v118, v119
    v_mfma_f32_16x16x32_bf16 v[104:107], v[208:211], v[80:83], 0
    buffer_load_dwordx4 v9, s[32:35], s52 offen offset:3072 lds
    v_max3_f32 v176, v120, v121, v122
    v_max3_f32 v176, v176, v123, v124
    v_mfma_f32_16x16x32_bf16 v[112:115], v[208:211], v[84:87], 0
    v_max3_f32 v176, v176, v125, v126
    v_max3_f32 v176, v176, v127, v128
    v_mfma_f32_16x16x32_bf16 v[108:111], v[212:215], v[80:83], 0
    v_max3_f32 v176, v176, v129, v130
    v_max3_f32 v176, v176, v131, v132
    v_mfma_f32_16x16x32_bf16 v[116:119], v[212:215], v[84:87], 0
    v_max3_f32 v176, v176, v133, v134
    v_max_f32_e64 v176, v176, v135
    v_mul_f32 v176, 0xbfb8aa3b, v176
    v_pk_fma_f32 v[120:121], v[120:121], s[88:89], v[176:177] op_sel_hi:[1,1,0]
    v_pk_fma_f32 v[122:123], v[122:123], s[88:89], v[176:177] op_sel_hi:[1,1,0]
    v_pk_fma_f32 v[124:125], v[124:125], s[88:89], v[176:177] op_sel_hi:[1,1,0]
    v_pk_fma_f32 v[126:127], v[126:127], s[88:89], v[176:177] op_sel_hi:[1,1,0]
    v_pk_fma_f32 v[128:129], v[128:129], s[88:89], v[176:177] op_sel_hi:[1,1,0]
    v_pk_fma_f32 v[130:131], v[130:131], s[88:89], v[176:177] op_sel_hi:[1,1,0]
    v_pk_fma_f32 v[132:133], v[132:133], s[88:89], v[176:177] op_sel_hi:[1,1,0]
    v_pk_fma_f32 v[134:135], v[134:135], s[88:89], v[176:177] op_sel_hi:[1,1,0]
    s_add_u32 s84, s100, 98304
    s_and_b32 s84, s84, 229376
    s_add_u32 m0, s50, 81920
    s_xor_b32 s84, s84, s4
    buffer_load_dwordx4 v20, s[56:59], s84 offen offset:0 lds
    v_cvt_pk_bf16_f32 v136, v104, v105
    v_cvt_pk_bf16_f32 v137, v106, v107
    v_cvt_pk_bf16_f32 v140, v108, v109
    v_cvt_pk_bf16_f32 v141, v110, v111
    v_cvt_pk_bf16_f32 v144, v112, v113
    v_cvt_pk_bf16_f32 v145, v114, v115
    v_cvt_pk_bf16_f32 v148, v116, v117
    v_cvt_pk_bf16_f32 v149, v118, v119
    v_exp_f32 v120, v120
    buffer_load_dwordx4 v21, s[56:59], s84 offen offset:1024 lds
    v_exp_f32 v121, v121
    v_exp_f32 v122, v122
    v_exp_f32 v123, v123
    v_exp_f32 v124, v124
    v_exp_f32 v125, v125
    v_exp_f32 v126, v126
    v_exp_f32 v127, v127
    v_exp_f32 v128, v128
    buffer_load_dwordx4 v22, s[56:59], s84 offen offset:2048 lds
    v_exp_f32 v129, v129
    v_exp_f32 v130, v130
    v_exp_f32 v131, v131
    v_exp_f32 v132, v132
    v_exp_f32 v133, v133
    v_exp_f32 v134, v134
    v_exp_f32_e64 v135, v135
    buffer_load_dwordx4 v23, s[56:59], s84 offen offset:3072 lds
L_kvmain_s2:
    s_cbranch_execz L_kvmain_ret
    v_pk_add_f32 v[176:177], v[120:121], v[122:123]
    v_pk_add_f32 v[178:179], v[124:125], v[126:127]
    v_pk_add_f32 v[176:177], v[176:177], v[128:129]
    v_pk_add_f32 v[178:179], v[178:179], v[130:131]
    v_pk_add_f32 v[176:177], v[176:177], v[132:133]
    v_pk_add_f32 v[178:179], v[178:179], v[134:135]
    v_pk_add_f32 v[176:177], v[176:177], v[178:179]
    v_add_f32 v176, v176, v177
    v_rcp_f32_e64 v176, v176
    s_add_u32 s98, s98, 2
    s_and_b32 s98, s98, 15
    s_add_u32 m0, s50, 49152
    s_mul_i32 s52, s98, 114688
    buffer_load_dwordx4 v6, s[32:35], s52 offen offset:0 lds
    v_pk_mul_f32 v[120:121], v[120:121], v[176:177] op_sel_hi:[1,0]
    v_pk_mul_f32 v[122:123], v[122:123], v[176:177] op_sel_hi:[1,0]
    v_pk_mul_f32 v[124:125], v[124:125], v[176:177] op_sel_hi:[1,0]
    v_pk_mul_f32 v[126:127], v[126:127], v[176:177] op_sel_hi:[1,0]
    v_pk_mul_f32 v[128:129], v[128:129], v[176:177] op_sel_hi:[1,0]
    v_pk_mul_f32 v[130:131], v[130:131], v[176:177] op_sel_hi:[1,0]
    v_pk_mul_f32 v[132:133], v[132:133], v[176:177] op_sel_hi:[1,0]
    v_pk_mul_f32 v[134:135], v[134:135], v[176:177] op_sel_hi:[1,0]
    v_cvt_pk_bf16_f32 v216, v120, v121
    v_cvt_pk_bf16_f32 v217, v122, v123
    v_cvt_pk_bf16_f32 v218, v124, v125
    v_cvt_pk_bf16_f32 v219, v126, v127
    v_cvt_pk_bf16_f32 v220, v128, v129
    v_cvt_pk_bf16_f32 v221, v130, v131
    v_cvt_pk_bf16_f32 v222, v132, v133
    v_cvt_pk_bf16_f32 v223, v134, v135
    v_mfma_f32_16x16x32_bf16 v[120:123], v[216:219], v[80:83], 0
    v_lshrrev_b32 v180, 3, v0
    v_and_b32 v181, 7, v0
    v_mfma_f32_16x16x32_bf16 v[128:131], v[216:219], v[84:87], 0
    v_lshlrev_b32_e64 v180, 12, v180
    v_lshl_add_u32 v180, v181, 4, v180
    v_mfma_f32_16x16x32_bf16 v[124:127], v[220:223], v[80:83], 0
    v_cmp_gt_u32_e64 vcc, 16, v0
    v_mov_b32 v181, 0x7ffffff0
    v_mfma_f32_16x16x32_bf16 v[132:135], v[220:223], v[84:87], 0
    s_mul_i32 s12, s85, 0x22000
    v_cndmask_b32 v181, v181, v180, vcc
    s_lshl_b32 s48, s55, 7
    s_add_u32 s12, s12, 0xa00000
    s_add_u32 s13, s12, s48
    v_cvt_pk_bf16_f32 v138, v120, v121
    v_cvt_pk_bf16_f32 v139, v122, v123
    v_cvt_pk_bf16_f32 v142, v124, v125
    v_cvt_pk_bf16_f32 v143, v126, v127
    v_cvt_pk_bf16_f32 v146, v128, v129
    v_cvt_pk_bf16_f32 v147, v130, v131
    v_cvt_pk_bf16_f32 v150, v132, v133
    v_cvt_pk_bf16_f32 v151, v134, v135
    s_waitcnt vmcnt(30)
    s_barrier
    v_mfma_f32_16x16x32_bf16 v[152:155], v[232:235], v[136:139], v[152:155]
    ds_read_b64_tr_b16 v[32:33], v14 offset:0
    v_mfma_f32_16x16x32_bf16 v[156:159], v[232:235], v[140:143], v[156:159]
    ds_read_b64_tr_b16 v[34:35], v14 offset:1024
    v_mfma_f32_16x16x32_bf16 v[160:163], v[248:251], v[144:147], v[160:163]
    ds_read_b64_tr_b16 v[36:37], v15 offset:0
    v_mfma_f32_16x16x32_bf16 v[164:167], v[248:251], v[148:151], v[164:167]
    ds_read_b64_tr_b16 v[38:39], v15 offset:1024
    v_mfma_f32_16x16x32_bf16 v[168:171], v[88:91], v[136:139], v[168:171]
    ds_read_b64_tr_b16 v[40:41], v14 offset:4096
    v_mfma_f32_16x16x32_bf16 v[168:171], v[92:95], v[140:143], v[168:171]
    ds_read_b64_tr_b16 v[42:43], v14 offset:5120
    v_mfma_f32_16x16x32_bf16 v[168:171], v[96:99], v[144:147], v[168:171]
    ds_read_b64_tr_b16 v[44:45], v15 offset:4096
    v_mfma_f32_16x16x32_bf16 v[168:171], v[100:103], v[148:151], v[168:171]
    ds_read_b64_tr_b16 v[46:47], v15 offset:5120
    s_waitcnt lgkmcnt(6)
    v_mfma_f32_16x16x32_bf16 v[192:195], v[32:35], a[0:3], 0
    ds_read_b64_tr_b16 v[48:49], v14 offset:8192
    s_lshl1_add_u32 s48, s44, s47
    v_mfma_f32_16x16x32_bf16 v[208:211], v[32:35], a[4:7], 0
    ds_read_b64_tr_b16 v[50:51], v14 offset:9216
    s_addk_i32 s48, 32
    v_mfma_f32_16x16x32_bf16 v[224:227], v[32:35], a[8:11], 0
    buffer_store_dwordx4 v[152:155], v180, s[36:39], s13 offen sc1
    ds_read_b64_tr_b16 v[52:53], v15 offset:8192
    v_mfma_f32_16x16x32_bf16 v[240:243], v[32:35], a[12:15], 0
    ds_read_b64_tr_b16 v[54:55], v15 offset:9216
    s_waitcnt lgkmcnt(7)
    v_mfma_f32_16x16x32_bf16 v[244:247], v[36:39], a[12:15], 0
    ds_read_b64_tr_b16 v[56:57], v14 offset:12288
    s_add_u32 s13, s13, 0x8000
    v_mfma_f32_16x16x32_bf16 v[228:231], v[36:39], a[8:11], 0
    buffer_store_dwordx4 v[156:159], v180, s[36:39], s13 offen sc1
    v_mfma_f32_16x16x32_bf16 v[212:215], v[36:39], a[4:7], 0
    ds_read_b64_tr_b16 v[58:59], v14 offset:13312
    s_lshl_b32 s48, s48, 12
    v_mfma_f32_16x16x32_bf16 v[196:199], v[36:39], a[0:3], 0
    ds_read_b64_tr_b16 v[60:61], v15 offset:12288
    s_add_u32 s13, s13, 0x8000
    s_waitcnt lgkmcnt(6)
    v_mfma_f32_16x16x32_bf16 v[200:203], v[40:43], a[0:3], 0
    buffer_store_dwordx4 v[160:163], v180, s[36:39], s13 offen sc1
    v_mfma_f32_16x16x32_bf16 v[216:219], v[40:43], a[4:7], 0
    ds_read_b64_tr_b16 v[62:63], v15 offset:13312
    s_add_u32 s54, s54, s48
    v_mfma_f32_16x16x32_bf16 v[232:235], v[40:43], a[8:11], 0
    s_add_u32 s13, s13, 0x8000
    v_lshrrev_b32_e64 v10, 2, v0
    v_mfma_f32_16x16x32_bf16 v[248:251], v[40:43], a[12:15], 0
    buffer_store_dwordx4 v[164:167], v180, s[36:39], s13 offen sc1
    v_mfma_f32_16x16x32_bf16 v[252:255], v[44:47], a[12:15], 0
    v_mul_u32_u24 v10, 3584, v10
    v_lshrrev_b32_e64 v11, 5, v0
    v_mfma_f32_16x16x32_bf16 v[236:239], v[44:47], a[8:11], 0
    s_add_u32 s13, s13, 0x8000
    v_lshlrev_b32_e64 v11, 1, v11
    v_mfma_f32_16x16x32_bf16 v[220:223], v[44:47], a[4:7], 0
    buffer_store_dwordx4 v[168:171], v181, s[36:39], s13 offen sc1
    s_waitcnt vmcnt(18) lgkmcnt(0)
    v_mfma_f32_16x16x32_bf16 v[204:207], v[44:47], a[0:3], 0
    s_barrier
    v_mfma_f32_16x16x32_bf16 v[192:195], v[48:51], a[16:19], v[192:195]
    ds_read_b64_tr_b16 v[32:33], v14 offset:16384
    v_and_b32_e64 v12, 3, v0
    v_mfma_f32_16x16x32_bf16 v[208:211], v[48:51], a[20:23], v[208:211]
    ds_read_b64_tr_b16 v[34:35], v14 offset:17408
    v_xor_b32_e64 v11, v11, v12
    v_mfma_f32_16x16x32_bf16 v[224:227], v[48:51], a[24:27], v[224:227]
    ds_read_b64_tr_b16 v[36:37], v15 offset:16384
    v_cmp_ne_u32 s[92:93], 0, v19
    s_nop 0
    s_cmp_eq_u64 s[92:93], -1
    s_cbranch_scc0 L_sp7
L_ok7:
    v_lshrrev_b32 v1, 5, v0
    v_lshlrev_b32_e64 v1, 7, v1
    v_mfma_f32_16x16x32_bf16 v[240:243], v[48:51], a[28:31], v[240:243]
    buffer_load_dwordx4 v7, s[32:35], s52 offen offset:1024 lds
    v_mfma_f32_16x16x32_bf16 v[244:247], v[52:55], a[28:31], v[244:247]
    ds_read_b64_tr_b16 v[38:39], v15 offset:17408
    s_lshl_b32 s48, s44, 6
    v_mfma_f32_16x16x32_bf16 v[228:231], v[52:55], a[24:27], v[228:231]
    ds_read_b64_tr_b16 v[40:41], v14 offset:20480
    s_addk_i32 s48, 3072
    v_mfma_f32_16x16x32_bf16 v[212:215], v[52:55], a[20:23], v[212:215]
    ds_read_b64_tr_b16 v[42:43], v14 offset:21504
    v_lshl_add_u32 v10, v11, 4, v10
    v_mfma_f32_16x16x32_bf16 v[196:199], v[52:55], a[16:19], v[196:199]
    buffer_load_dwordx4 v8, s[32:35], s52 offen offset:2048 lds
    v_mfma_f32_16x16x32_bf16 v[200:203], v[56:59], a[16:19], v[200:203]
    ds_read_b64_tr_b16 v[44:45], v15 offset:20480
    v_add_u32_e64 v29, s48, v10
    v_mfma_f32_16x16x32_bf16 v[216:219], v[56:59], a[20:23], v[216:219]
    ds_read_b64_tr_b16 v[46:47], v15 offset:21504
    v_bfe_u32 v10, v0, 4, 1
    v_mfma_f32_16x16x32_bf16 v[232:235], v[56:59], a[24:27], v[232:235]
    v_xor_b32 v10, s47, v10
    v_lshlrev_b32 v10, 5, v10
    v_mfma_f32_16x16x32_bf16 v[248:251], v[56:59], a[28:31], v[248:251]
    buffer_load_dwordx4 v9, s[32:35], s52 offen offset:3072 lds
    v_mfma_f32_16x16x32_bf16 v[252:255], v[60:63], a[28:31], v[252:255]
    s_add_u32 s98, s98, 2
    s_and_b32 s98, s98, 15
    v_mfma_f32_16x16x32_bf16 v[236:239], v[60:63], a[24:27], v[236:239]
    s_add_u32 m0, s50, 0
    v_lshrrev_b32 v11, 4, v0
    v_mfma_f32_16x16x32_bf16 v[220:223], v[60:63], a[20:23], v[220:223]
    s_mul_i32 s52, s98, 114688
    v_lshl_add_u32 v10, v11, 9, v10
    v_mfma_f32_16x16x32_bf16 v[204:207], v[60:63], a[16:19], v[204:207]
    buffer_load_dwordx4 v6, s[32:35], s52 offen offset:0 lds
    s_waitcnt lgkmcnt(1)
    v_mfma_f32_16x16x32_bf16 v[192:195], v[32:35], a[32:35], v[192:195]
    ds_read_b64_tr_b16 v[48:49], v14 offset:24576
    v_bfe_u32 v11, v0, 2, 2
    v_mfma_f32_16x16x32_bf16 v[208:211], v[32:35], a[36:39], v[208:211]
    ds_read_b64_tr_b16 v[50:51], v14 offset:25600
    v_lshl_add_u32 v10, v11, 6, v10
    v_mfma_f32_16x16x32_bf16 v[224:227], v[32:35], a[40:43], v[224:227]
    ds_read_b64_tr_b16 v[52:53], v15 offset:24576
    v_lshl_add_u32 v12, v12, 3, v10
    v_mfma_f32_16x16x32_bf16 v[240:243], v[32:35], a[44:47], v[240:243]
    ds_read_b64_tr_b16 v[54:55], v15 offset:25600
    v_and_b32 v10, 15, v0
    v_mfma_f32_16x16x32_bf16 v[244:247], v[36:39], a[44:47], v[244:247]
    buffer_load_dwordx4 v7, s[32:35], s52 offen offset:1024 lds
    v_mfma_f32_16x16x32_bf16 v[228:231], v[36:39], a[40:43], v[228:231]
    ds_read_b64_tr_b16 v[56:57], v14 offset:28672
    v_lshlrev_b32_e64 v10, 4, v10
    v_mfma_f32_16x16x32_bf16 v[212:215], v[36:39], a[36:39], v[212:215]
    ds_read_b64_tr_b16 v[58:59], v14 offset:29696
    v_bfe_u32 v11, v0, 4, 1
    v_mfma_f32_16x16x32_bf16 v[196:199], v[36:39], a[32:35], v[196:199]
    ds_read_b64_tr_b16 v[60:61], v15 offset:28672
    v_lshl_add_u32 v10, v11, 10, v10
    v_mfma_f32_16x16x32_bf16 v[200:203], v[40:43], a[32:35], v[200:203]
    ds_read_b64_tr_b16 v[62:63], v15 offset:29696
    v_lshrrev_b32_e64 v11, 5, v0
    v_mfma_f32_16x16x32_bf16 v[216:219], v[40:43], a[36:39], v[216:219]
    buffer_load_dwordx4 v8, s[32:35], s52 offen offset:2048 lds
    v_mfma_f32_16x16x32_bf16 v[232:235], v[40:43], a[40:43], v[232:235]
    ds_read_b64_tr_b16 v[64:65], v24 offset:0
    v_lshl_add_u32 v10, v11, 8, v10
    v_mfma_f32_16x16x32_bf16 v[248:251], v[40:43], a[44:47], v[248:251]
    ds_read_b64_tr_b16 v[66:67], v24 offset:1024
    s_waitcnt lgkmcnt(6)
    v_mfma_f32_16x16x32_bf16 v[252:255], v[44:47], a[44:47], v[252:255]
    ds_read_b64_tr_b16 v[68:69], v25 offset:0
    s_lshl_b32 s48, s47, 9
    v_mfma_f32_16x16x32_bf16 v[236:239], v[44:47], a[40:43], v[236:239]
    ds_read_b64_tr_b16 v[70:71], v25 offset:1024
    v_add_u32_e64 v10, s48, v10
    v_mfma_f32_16x16x32_bf16 v[220:223], v[44:47], a[36:39], v[220:223]
    buffer_load_dwordx4 v9, s[32:35], s52 offen offset:3072 lds
    s_waitcnt vmcnt(7) lgkmcnt(4)
    v_mfma_f32_16x16x32_bf16 v[204:207], v[44:47], a[32:35], v[204:207]
    s_barrier
    v_mfma_f32_16x16x32_bf16 v[192:195], v[48:51], a[48:51], v[192:195]
    ds_read_b64_tr_b16 v[32:33], v14 offset:32768
    v_mfma_f32_16x16x32_bf16 v[208:211], v[48:51], a[52:55], v[208:211]
    ds_read_b64_tr_b16 v[34:35], v14 offset:33792
    v_mfma_f32_16x16x32_bf16 v[224:227], v[48:51], a[56:59], v[224:227]
    ds_read_b64_tr_b16 v[36:37], v15 offset:32768
    v_mfma_f32_16x16x32_bf16 v[240:243], v[48:51], a[60:63], v[240:243]
    buffer_store_dword v24, v18, s[36:39], s16 offen sc1
    v_mfma_f32_16x16x32_bf16 v[244:247], v[52:55], a[60:63], v[244:247]
    ds_read_b64_tr_b16 v[38:39], v15 offset:33792
    s_add_u32 s98, s98, 2
    s_and_b32 s98, s98, 15
    v_mfma_f32_16x16x32_bf16 v[228:231], v[52:55], a[56:59], v[228:231]
    ds_read_b64_tr_b16 v[40:41], v14 offset:36864
    s_add_u32 m0, s50, 16384
    v_mfma_f32_16x16x32_bf16 v[212:215], v[52:55], a[52:55], v[212:215]
    ds_read_b64_tr_b16 v[42:43], v14 offset:37888
    s_mul_i32 s52, s98, 114688
    v_mfma_f32_16x16x32_bf16 v[196:199], v[52:55], a[48:51], v[196:199]
    buffer_load_dwordx4 v6, s[32:35], s52 offen offset:0 lds
    v_mfma_f32_16x16x32_bf16 v[200:203], v[56:59], a[48:51], v[200:203]
    ds_read_b64_tr_b16 v[44:45], v15 offset:36864
    v_mfma_f32_16x16x32_bf16 v[216:219], v[56:59], a[52:55], v[216:219]
    ds_read_b64_tr_b16 v[46:47], v15 offset:37888
    v_mfma_f32_16x16x32_bf16 v[232:235], v[56:59], a[56:59], v[232:235]
    ds_read_b64_tr_b16 v[72:73], v26 offset:0
    v_mfma_f32_16x16x32_bf16 v[248:251], v[56:59], a[60:63], v[248:251]
    buffer_load_dwordx4 v7, s[32:35], s52 offen offset:1024 lds
    v_mfma_f32_16x16x32_bf16 v[252:255], v[60:63], a[60:63], v[252:255]
    ds_read_b64_tr_b16 v[74:75], v26 offset:1024
    v_mfma_f32_16x16x32_bf16 v[236:239], v[60:63], a[56:59], v[236:239]
    ds_read_b64_tr_b16 v[76:77], v27 offset:0
    v_mfma_f32_16x16x32_bf16 v[220:223], v[60:63], a[52:55], v[220:223]
    ds_read_b64_tr_b16 v[78:79], v27 offset:1024
    v_mfma_f32_16x16x32_bf16 v[204:207], v[60:63], a[48:51], v[204:207]
    buffer_load_dwordx4 v8, s[32:35], s52 offen offset:2048 lds
    s_waitcnt lgkmcnt(5)
    v_mfma_f32_16x16x32_bf16 v[192:195], v[32:35], a[64:67], v[192:195]
    ds_read_b64_tr_b16 v[48:49], v14 offset:40960
    v_mfma_f32_16x16x32_bf16 v[208:211], v[32:35], a[68:71], v[208:211]
    ds_read_b64_tr_b16 v[50:51], v14 offset:41984
    v_mfma_f32_16x16x32_bf16 v[224:227], v[32:35], a[72:75], v[224:227]
    ds_read_b64_tr_b16 v[52:53], v15 offset:40960
    v_mfma_f32_16x16x32_bf16 v[240:243], v[32:35], a[76:79], v[240:243]
    buffer_load_dwordx4 v9, s[32:35], s52 offen offset:3072 lds
    ds_read_b64_tr_b16 v[54:55], v15 offset:41984
    v_mfma_f32_16x16x32_bf16 v[244:247], v[36:39], a[76:79], v[244:247]
    ds_read_b64_tr_b16 v[56:57], v14 offset:45056
    s_add_u32 s84, s100, 131072
    s_and_b32 s84, s84, 229376
    v_mfma_f32_16x16x32_bf16 v[228:231], v[36:39], a[72:75], v[228:231]
    ds_read_b64_tr_b16 v[58:59], v14 offset:46080
    s_add_u32 m0, s50, 98304
    v_mfma_f32_16x16x32_bf16 v[212:215], v[36:39], a[68:71], v[212:215]
    ds_read_b64_tr_b16 v[60:61], v15 offset:45056
    s_xor_b32 s84, s84, s4
    v_mfma_f32_16x16x32_bf16 v[196:199], v[36:39], a[64:67], v[196:199]
    buffer_load_dwordx4 v20, s[56:59], s84 offen offset:0 lds
    v_mfma_f32_16x16x32_bf16 v[200:203], v[40:43], a[64:67], v[200:203]
    ds_read_b64_tr_b16 v[62:63], v15 offset:46080
    v_mfma_f32_16x16x32_bf16 v[216:219], v[40:43], a[68:71], v[216:219]
    ds_read_b64_tr_b16 v[80:81], v24 offset:16384
    v_mfma_f32_16x16x32_bf16 v[232:235], v[40:43], a[72:75], v[232:235]
    ds_read_b64_tr_b16 v[82:83], v24 offset:17408
    v_mfma_f32_16x16x32_bf16 v[248:251], v[40:43], a[76:79], v[248:251]
    buffer_load_dwordx4 v21, s[56:59], s84 offen offset:1024 lds
    s_waitcnt lgkmcnt(5)
    v_mfma_f32_16x16x32_bf16 v[252:255], v[44:47], a[76:79], v[252:255]
    ds_read_b64_tr_b16 v[84:85], v25 offset:16384
    v_mfma_f32_16x16x32_bf16 v[236:239], v[44:47], a[72:75], v[236:239]
    ds_read_b64_tr_b16 v[86:87], v25 offset:17408
    v_mfma_f32_16x16x32_bf16 v[220:223], v[44:47], a[68:71], v[220:223]
    buffer_load_dwordx4 v22, s[56:59], s84 offen offset:2048 lds
    s_waitcnt vmcnt(12) lgkmcnt(4)
    v_mfma_f32_16x16x32_bf16 v[204:207], v[44:47], a[64:67], v[204:207]
    s_barrier
    v_mfma_f32_16x16x32_bf16 v[192:195], v[48:51], a[80:83], v[192:195]
    ds_read_b64_tr_b16 v[32:33], v14 offset:49152
    v_mfma_f32_16x16x32_bf16 v[208:211], v[48:51], a[84:87], v[208:211]
    ds_read_b64_tr_b16 v[34:35], v14 offset:50176
    v_mfma_f32_16x16x32_bf16 v[224:227], v[48:51], a[88:91], v[224:227]
    ds_read_b64_tr_b16 v[36:37], v15 offset:49152
    v_mfma_f32_16x16x32_bf16 v[240:243], v[48:51], a[92:95], v[240:243]
    buffer_load_dwordx4 v23, s[56:59], s84 offen offset:3072 lds
    v_mfma_f32_16x16x32_bf16 v[244:247], v[52:55], a[92:95], v[244:247]
    ds_read_b64_tr_b16 v[38:39], v15 offset:50176
    s_add_u32 s98, s98, 2
    s_and_b32 s98, s98, 15
    v_mfma_f32_16x16x32_bf16 v[228:231], v[52:55], a[88:91], v[228:231]
    ds_read_b64_tr_b16 v[40:41], v14 offset:53248
    s_add_u32 m0, s50, 32768
    v_mfma_f32_16x16x32_bf16 v[212:215], v[52:55], a[84:87], v[212:215]
    ds_read_b64_tr_b16 v[42:43], v14 offset:54272
    s_mul_i32 s52, s98, 114688
    v_mfma_f32_16x16x32_bf16 v[196:199], v[52:55], a[80:83], v[196:199]
    buffer_load_dwordx4 v6, s[32:35], s52 offen offset:0 lds
    v_mfma_f32_16x16x32_bf16 v[200:203], v[56:59], a[80:83], v[200:203]
    ds_read_b64_tr_b16 v[44:45], v15 offset:53248
    v_mfma_f32_16x16x32_bf16 v[216:219], v[56:59], a[84:87], v[216:219]
    ds_read_b64_tr_b16 v[46:47], v15 offset:54272
    v_mfma_f32_16x16x32_bf16 v[232:235], v[56:59], a[88:91], v[232:235]
    ds_read_b64_tr_b16 v[88:89], v26 offset:16384
    v_mfma_f32_16x16x32_bf16 v[248:251], v[56:59], a[92:95], v[248:251]
    buffer_load_dwordx4 v7, s[32:35], s52 offen offset:1024 lds
    v_mfma_f32_16x16x32_bf16 v[252:255], v[60:63], a[92:95], v[252:255]
    ds_read_b64_tr_b16 v[90:91], v26 offset:17408
    v_mfma_f32_16x16x32_bf16 v[236:239], v[60:63], a[88:91], v[236:239]
    ds_read_b64_tr_b16 v[92:93], v27 offset:16384
    v_mfma_f32_16x16x32_bf16 v[220:223], v[60:63], a[84:87], v[220:223]
    ds_read_b64_tr_b16 v[94:95], v27 offset:17408
    v_mfma_f32_16x16x32_bf16 v[204:207], v[60:63], a[80:83], v[204:207]
    buffer_load_dwordx4 v8, s[32:35], s52 offen offset:2048 lds
    s_waitcnt lgkmcnt(5)
    v_mfma_f32_16x16x32_bf16 v[192:195], v[32:35], a[96:99], v[192:195]
    ds_read_b64_tr_b16 v[48:49], v14 offset:57344
    v_mfma_f32_16x16x32_bf16 v[208:211], v[32:35], a[100:103], v[208:211]
    ds_read_b64_tr_b16 v[50:51], v14 offset:58368
    v_mfma_f32_16x16x32_bf16 v[224:227], v[32:35], a[104:107], v[224:227]
    ds_read_b64_tr_b16 v[52:53], v15 offset:57344
    v_mfma_f32_16x16x32_bf16 v[240:243], v[32:35], a[108:111], v[240:243]
    buffer_load_dwordx4 v9, s[32:35], s52 offen offset:3072 lds
    ds_read_b64_tr_b16 v[54:55], v15 offset:58368
    v_mfma_f32_16x16x32_bf16 v[244:247], v[36:39], a[108:111], v[244:247]
    ds_read_b64_tr_b16 v[56:57], v14 offset:61440
    s_add_u32 s84, s100, 32768
    s_and_b32 s84, s84, 98304
    v_mfma_f32_16x16x32_bf16 v[228:231], v[36:39], a[104:107], v[228:231]
    ds_read_b64_tr_b16 v[58:59], v14 offset:62464
    s_add_u32 m0, s50, 114688
    v_mfma_f32_16x16x32_bf16 v[212:215], v[36:39], a[100:103], v[212:215]
    ds_read_b64_tr_b16 v[60:61], v15 offset:61440
    s_xor_b32 s84, s84, s7
    v_mfma_f32_16x16x32_bf16 v[196:199], v[36:39], a[96:99], v[196:199]
    buffer_load_dwordx4 v20, s[60:63], s84 offen offset:0 lds
    v_mfma_f32_16x16x32_bf16 v[200:203], v[40:43], a[96:99], v[200:203]
    ds_read_b64_tr_b16 v[62:63], v15 offset:62464
    v_mfma_f32_16x16x32_bf16 v[216:219], v[40:43], a[100:103], v[216:219]
    v_add_u32 v24, 0xffff0000, v24
    ds_read_b64_tr_b16 v[96:97], v24 offset:0
    v_mfma_f32_16x16x32_bf16 v[232:235], v[40:43], a[104:107], v[232:235]
    ds_read_b64_tr_b16 v[98:99], v24 offset:1024
    v_mfma_f32_16x16x32_bf16 v[248:251], v[40:43], a[108:111], v[248:251]
    buffer_load_dwordx4 v21, s[60:63], s84 offen offset:1024 lds
    s_waitcnt lgkmcnt(5)
    v_mfma_f32_16x16x32_bf16 v[252:255], v[44:47], a[108:111], v[252:255]
    v_add_u32 v25, 0xffff0000, v25
    ds_read_b64_tr_b16 v[100:101], v25 offset:0
    v_mfma_f32_16x16x32_bf16 v[236:239], v[44:47], a[104:107], v[236:239]
    ds_read_b64_tr_b16 v[102:103], v25 offset:1024
    v_mfma_f32_16x16x32_bf16 v[220:223], v[44:47], a[100:103], v[220:223]
    buffer_load_dwordx4 v22, s[60:63], s84 offen offset:2048 lds
    s_waitcnt vmcnt(16) lgkmcnt(4)
    v_mfma_f32_16x16x32_bf16 v[204:207], v[44:47], a[96:99], v[204:207]
    s_barrier
    v_mfma_f32_16x16x32_bf16 v[192:195], v[48:51], a[112:115], v[192:195]
    ds_read_b64_tr_b16 v[32:33], v14 offset:0
    v_mfma_f32_16x16x32_bf16 v[208:211], v[48:51], a[116:119], v[208:211]
    ds_read_b64_tr_b16 v[34:35], v14 offset:1024
    v_mfma_f32_16x16x32_bf16 v[224:227], v[48:51], a[120:123], v[224:227]
    ds_read_b64_tr_b16 v[36:37], v15 offset:0
    v_mfma_f32_16x16x32_bf16 v[240:243], v[48:51], a[124:127], v[240:243]
    buffer_load_dwordx4 v23, s[60:63], s84 offen offset:3072 lds
    v_mfma_f32_16x16x32_bf16 v[244:247], v[52:55], a[124:127], v[244:247]
    ds_read_b64_tr_b16 v[38:39], v15 offset:1024
    v_lshlrev_b32_e64 v165, 2, v0
    v_mfma_f32_16x16x32_bf16 v[228:231], v[52:55], a[120:123], v[228:231]
    ds_read_b64_tr_b16 v[40:41], v14 offset:4096
    s_lshl_b32 s45, s55, 8
    v_mfma_f32_16x16x32_bf16 v[212:215], v[52:55], a[116:119], v[212:215]
    ds_read_b64_tr_b16 v[42:43], v14 offset:5120
    s_add_u32 s45, s45, 0x54000
    v_mfma_f32_16x16x32_bf16 v[196:199], v[52:55], a[112:115], v[196:199]
    buffer_load_dword v164, v165, s[36:39], s45 offen sc1
    v_mfma_f32_16x16x32_bf16 v[200:203], v[56:59], a[112:115], v[200:203]
    ds_read_b64_tr_b16 v[44:45], v15 offset:4096
    s_add_u32 s98, s98, 2
    s_and_b32 s98, s98, 15
    v_mfma_f32_16x16x32_bf16 v[216:219], v[56:59], a[116:119], v[216:219]
    ds_read_b64_tr_b16 v[46:47], v15 offset:5120
    s_add_u32 m0, s50, 49152
    v_mfma_f32_16x16x32_bf16 v[232:235], v[56:59], a[120:123], v[232:235]
    v_add_u32 v26, 0xffff0000, v26
    ds_read_b64_tr_b16 v[104:105], v26 offset:0
    s_mul_i32 s52, s98, 114688
    v_mfma_f32_16x16x32_bf16 v[248:251], v[56:59], a[124:127], v[248:251]
    buffer_load_dwordx4 v6, s[32:35], s52 offen offset:0 lds
    v_mfma_f32_16x16x32_bf16 v[252:255], v[60:63], a[124:127], v[252:255]
    ds_read_b64_tr_b16 v[106:107], v26 offset:1024
    v_mfma_f32_16x16x32_bf16 v[236:239], v[60:63], a[120:123], v[236:239]
    v_add_u32 v27, 0xffff0000, v27
    ds_read_b64_tr_b16 v[108:109], v27 offset:0
    v_mfma_f32_16x16x32_bf16 v[220:223], v[60:63], a[116:119], v[220:223]
    ds_read_b64_tr_b16 v[110:111], v27 offset:1024
    v_mfma_f32_16x16x32_bf16 v[204:207], v[60:63], a[112:115], v[204:207]
    buffer_load_dwordx4 v7, s[32:35], s52 offen offset:1024 lds
    s_waitcnt lgkmcnt(5)
    v_mfma_f32_16x16x32_bf16 v[192:195], v[32:35], a[128:131], v[192:195]
    ds_read_b64_tr_b16 v[48:49], v14 offset:8192
    v_mfma_f32_16x16x32_bf16 v[208:211], v[32:35], a[132:135], v[208:211]
    ds_read_b64_tr_b16 v[50:51], v14 offset:9216
    v_mfma_f32_16x16x32_bf16 v[224:227], v[32:35], a[136:139], v[224:227]
    ds_read_b64_tr_b16 v[52:53], v15 offset:8192
    v_mfma_f32_16x16x32_bf16 v[240:243], v[32:35], a[140:143], v[240:243]
    buffer_load_dwordx4 v8, s[32:35], s52 offen offset:2048 lds
    v_mfma_f32_16x16x32_bf16 v[244:247], v[36:39], a[140:143], v[244:247]
    ds_read_b64_tr_b16 v[54:55], v15 offset:9216
    v_mfma_f32_16x16x32_bf16 v[228:231], v[36:39], a[136:139], v[228:231]
    ds_read_b64_tr_b16 v[56:57], v14 offset:12288
    v_mfma_f32_16x16x32_bf16 v[212:215], v[36:39], a[132:135], v[212:215]
    ds_read_b64_tr_b16 v[58:59], v14 offset:13312
    v_mfma_f32_16x16x32_bf16 v[196:199], v[36:39], a[128:131], v[196:199]
    buffer_load_dwordx4 v9, s[32:35], s52 offen offset:3072 lds
    v_mfma_f32_16x16x32_bf16 v[200:203], v[40:43], a[128:131], v[200:203]
    ds_read_b64_tr_b16 v[60:61], v15 offset:12288
    s_add_u32 s84, s100, 65536
    v_mfma_f32_16x16x32_bf16 v[216:219], v[40:43], a[132:135], v[216:219]
    ds_read_b64_tr_b16 v[62:63], v15 offset:13312
    s_and_b32 s84, s84, 98304
    s_add_u32 m0, s50, 131072
    v_mfma_f32_16x16x32_bf16 v[232:235], v[40:43], a[136:139], v[232:235]
    s_xor_b32 s84, s84, s7
    v_mfma_f32_16x16x32_bf16 v[248:251], v[40:43], a[140:143], v[248:251]
    buffer_load_dwordx4 v20, s[60:63], s84 offen offset:0 lds
    s_waitcnt lgkmcnt(4)
    v_mfma_f32_16x16x32_bf16 v[252:255], v[44:47], a[140:143], v[252:255]
    v_mfma_f32_16x16x32_bf16 v[236:239], v[44:47], a[136:139], v[236:239]
    v_mfma_f32_16x16x32_bf16 v[220:223], v[44:47], a[132:135], v[220:223]
    buffer_load_dwordx4 v21, s[60:63], s84 offen offset:1024 lds
    s_waitcnt vmcnt(19) lgkmcnt(0)
    v_mfma_f32_16x16x32_bf16 v[204:207], v[44:47], a[128:131], v[204:207]
    s_barrier
    v_mfma_f32_16x16x32_bf16 v[192:195], v[48:51], a[144:147], v[192:195]
    ds_read_b64_tr_b16 v[32:33], v14 offset:16384
    v_mfma_f32_16x16x32_bf16 v[208:211], v[48:51], a[148:151], v[208:211]
    ds_read_b64_tr_b16 v[34:35], v14 offset:17408
    v_mfma_f32_16x16x32_bf16 v[224:227], v[48:51], a[152:155], v[224:227]
    ds_read_b64_tr_b16 v[36:37], v15 offset:16384
    v_mfma_f32_16x16x32_bf16 v[240:243], v[48:51], a[156:159], v[240:243]
    ds_read_b64_tr_b16 v[38:39], v15 offset:17408
    v_mfma_f32_16x16x32_bf16 v[244:247], v[52:55], a[156:159], v[244:247]
    buffer_load_dwordx4 v22, s[60:63], s84 offen offset:2048 lds
    v_mfma_f32_16x16x32_bf16 v[228:231], v[52:55], a[152:155], v[228:231]
    ds_read_b64_tr_b16 v[40:41], v14 offset:20480
    v_mfma_f32_16x16x32_bf16 v[212:215], v[52:55], a[148:151], v[212:215]
    ds_read_b64_tr_b16 v[42:43], v14 offset:21504
    v_mfma_f32_16x16x32_bf16 v[196:199], v[52:55], a[144:147], v[196:199]
    ds_read_b64_tr_b16 v[44:45], v15 offset:20480
    v_mfma_f32_16x16x32_bf16 v[200:203], v[56:59], a[144:147], v[200:203]
    ds_read_b64_tr_b16 v[46:47], v15 offset:21504
    v_mfma_f32_16x16x32_bf16 v[216:219], v[56:59], a[148:151], v[216:219]
    buffer_load_dwordx4 v23, s[60:63], s84 offen offset:3072 lds
    v_mfma_f32_16x16x32_bf16 v[232:235], v[56:59], a[152:155], v[232:235]
    v_add_u32 v9, 168960, v29
    v_add_u32 v8, 112640, v29
    v_mfma_f32_16x16x32_bf16 v[248:251], v[56:59], a[156:159], v[248:251]
    v_add_u32 v7, 56320, v29
    v_add_u32_e64 v6, 0, v29
    v_mfma_f32_16x16x32_bf16 v[252:255], v[60:63], a[156:159], v[252:255]
    s_lshl1_add_u32 s98, s47, s99
    s_and_b32 s98, s98, 15
    v_mfma_f32_16x16x32_bf16 v[236:239], v[60:63], a[152:155], v[236:239]
    s_add_u32 m0, s50, 0
    s_mul_i32 s52, s98, 114688
    v_mfma_f32_16x16x32_bf16 v[220:223], v[60:63], a[148:151], v[220:223]
    buffer_load_dwordx4 v6, s[32:35], s52 offen offset:0 lds
    v_mfma_f32_16x16x32_bf16 v[204:207], v[60:63], a[144:147], v[204:207]
    s_waitcnt lgkmcnt(0)
    v_mfma_f32_16x16x32_bf16 v[192:195], v[32:35], a[160:163], v[192:195]
    ds_read_b64_tr_b16 v[48:49], v14 offset:24576
    v_mfma_f32_16x16x32_bf16 v[208:211], v[32:35], a[164:167], v[208:211]
    ds_read_b64_tr_b16 v[50:51], v14 offset:25600
    v_mfma_f32_16x16x32_bf16 v[224:227], v[32:35], a[168:171], v[224:227]
    ds_read_b64_tr_b16 v[52:53], v15 offset:24576
    v_mfma_f32_16x16x32_bf16 v[240:243], v[32:35], a[172:175], v[240:243]
    ds_read_b64_tr_b16 v[54:55], v15 offset:25600
    v_mfma_f32_16x16x32_bf16 v[244:247], v[36:39], a[172:175], v[244:247]
    buffer_load_dwordx4 v7, s[32:35], s52 offen offset:1024 lds
    v_mfma_f32_16x16x32_bf16 v[228:231], v[36:39], a[168:171], v[228:231]
    ds_read_b64_tr_b16 v[56:57], v14 offset:28672
    v_mfma_f32_16x16x32_bf16 v[212:215], v[36:39], a[164:167], v[212:215]
    ds_read_b64_tr_b16 v[58:59], v14 offset:29696
    v_mfma_f32_16x16x32_bf16 v[196:199], v[36:39], a[160:163], v[196:199]
    ds_read_b64_tr_b16 v[60:61], v15 offset:28672
    v_mfma_f32_16x16x32_bf16 v[200:203], v[40:43], a[160:163], v[200:203]
    ds_read_b64_tr_b16 v[62:63], v15 offset:29696
    v_mfma_f32_16x16x32_bf16 v[216:219], v[40:43], a[164:167], v[216:219]
    buffer_load_dwordx4 v8, s[32:35], s52 offen offset:2048 lds
    v_mfma_f32_16x16x32_bf16 v[232:235], v[40:43], a[168:171], v[232:235]
    s_waitcnt vmcnt(12)
    ds_read_b64_tr_b16 v[112:113], v24 offset:49152
    v_mfma_f32_16x16x32_bf16 v[248:251], v[40:43], a[172:175], v[248:251]
    ds_read_b64_tr_b16 v[114:115], v24 offset:50176
    v_mfma_f32_16x16x32_bf16 v[252:255], v[44:47], a[172:175], v[252:255]
    ds_read_b64_tr_b16 v[116:117], v25 offset:49152
    v_mfma_f32_16x16x32_bf16 v[236:239], v[44:47], a[168:171], v[236:239]
    ds_read_b64_tr_b16 v[118:119], v25 offset:50176
    v_mfma_f32_16x16x32_bf16 v[220:223], v[44:47], a[164:167], v[220:223]
    buffer_load_dwordx4 v9, s[32:35], s52 offen offset:3072 lds
    s_waitcnt lgkmcnt(4)
    v_mfma_f32_16x16x32_bf16 v[204:207], v[44:47], a[160:163], v[204:207]
    s_barrier
    v_mfma_f32_16x16x32_bf16 v[192:195], v[48:51], a[176:179], v[192:195]
    ds_read_b64_tr_b16 v[32:33], v14 offset:32768
    s_add_u32 s84, s100, 98304
    v_mfma_f32_16x16x32_bf16 v[208:211], v[48:51], a[180:183], v[208:211]
    ds_read_b64_tr_b16 v[34:35], v14 offset:33792
    s_and_b32 s84, s84, 98304
    v_mfma_f32_16x16x32_bf16 v[224:227], v[48:51], a[184:187], v[224:227]
    ds_read_b64_tr_b16 v[36:37], v15 offset:32768
    s_add_u32 m0, s50, 147456
    v_mfma_f32_16x16x32_bf16 v[240:243], v[48:51], a[188:191], v[240:243]
    ds_read_b64_tr_b16 v[38:39], v15 offset:33792
    s_xor_b32 s84, s84, s7
    v_mfma_f32_16x16x32_bf16 v[244:247], v[52:55], a[188:191], v[244:247]
    buffer_load_dwordx4 v20, s[60:63], s84 offen offset:0 lds
    v_mfma_f32_16x16x32_bf16 v[228:231], v[52:55], a[184:187], v[228:231]
    ds_read_b64_tr_b16 v[40:41], v14 offset:36864
    v_mfma_f32_16x16x32_bf16 v[212:215], v[52:55], a[180:183], v[212:215]
    ds_read_b64_tr_b16 v[42:43], v14 offset:37888
    v_mfma_f32_16x16x32_bf16 v[196:199], v[52:55], a[176:179], v[196:199]
    ds_read_b64_tr_b16 v[44:45], v15 offset:36864
    v_mfma_f32_16x16x32_bf16 v[200:203], v[56:59], a[176:179], v[200:203]
    ds_read_b64_tr_b16 v[46:47], v15 offset:37888
    v_mfma_f32_16x16x32_bf16 v[216:219], v[56:59], a[180:183], v[216:219]
    buffer_load_dwordx4 v21, s[60:63], s84 offen offset:1024 lds
    v_mfma_f32_16x16x32_bf16 v[232:235], v[56:59], a[184:187], v[232:235]
    ds_read_b64_tr_b16 v[120:121], v26 offset:49152
    v_mfma_f32_16x16x32_bf16 v[248:251], v[56:59], a[188:191], v[248:251]
    ds_read_b64_tr_b16 v[122:123], v26 offset:50176
    v_mfma_f32_16x16x32_bf16 v[252:255], v[60:63], a[188:191], v[252:255]
    ds_read_b64_tr_b16 v[124:125], v27 offset:49152
    v_mfma_f32_16x16x32_bf16 v[236:239], v[60:63], a[184:187], v[236:239]
    ds_read_b64_tr_b16 v[126:127], v27 offset:50176
L_kvmain_s3:
    s_cbranch_execz L_kvmain_ret
    v_mfma_f32_16x16x32_bf16 v[220:223], v[60:63], a[180:183], v[220:223]
    buffer_load_dwordx4 v22, s[60:63], s84 offen offset:2048 lds
    v_mfma_f32_16x16x32_bf16 v[204:207], v[60:63], a[176:179], v[204:207]
    s_waitcnt lgkmcnt(4)
    v_mfma_f32_16x16x32_bf16 v[192:195], v[32:35], a[192:195], v[192:195]
    ds_read_b64_tr_b16 v[48:49], v14 offset:40960
    v_mfma_f32_16x16x32_bf16 v[208:211], v[32:35], a[196:199], v[208:211]
    ds_read_b64_tr_b16 v[50:51], v14 offset:41984
    v_mfma_f32_16x16x32_bf16 v[224:227], v[32:35], a[200:203], v[224:227]
    ds_read_b64_tr_b16 v[52:53], v15 offset:40960
    v_mfma_f32_16x16x32_bf16 v[240:243], v[32:35], a[204:207], v[240:243]
    ds_read_b64_tr_b16 v[54:55], v15 offset:41984
    v_mfma_f32_16x16x32_bf16 v[244:247], v[36:39], a[204:207], v[244:247]
    buffer_load_dwordx4 v23, s[60:63], s84 offen offset:3072 lds
    v_mfma_f32_16x16x32_bf16 v[228:231], v[36:39], a[200:203], v[228:231]
    ds_read_b64_tr_b16 v[56:57], v14 offset:45056
    s_add_u32 s98, s98, 4
    v_mfma_f32_16x16x32_bf16 v[212:215], v[36:39], a[196:199], v[212:215]
    ds_read_b64_tr_b16 v[58:59], v14 offset:46080
    s_and_b32 s98, s98, 15
    v_mfma_f32_16x16x32_bf16 v[196:199], v[36:39], a[192:195], v[196:199]
    ds_read_b64_tr_b16 v[60:61], v15 offset:45056
    s_add_u32 m0, s50, 16384
    v_mfma_f32_16x16x32_bf16 v[200:203], v[40:43], a[192:195], v[200:203]
    ds_read_b64_tr_b16 v[62:63], v15 offset:46080
    s_mul_i32 s52, s98, 114688
    v_mfma_f32_16x16x32_bf16 v[216:219], v[40:43], a[196:199], v[216:219]
    buffer_load_dwordx4 v6, s[32:35], s52 offen offset:0 lds
    v_mfma_f32_16x16x32_bf16 v[232:235], v[40:43], a[200:203], v[232:235]
    s_waitcnt vmcnt(9)
    v_add_u32 v24, 0x10000, v24
    ds_read_b64_tr_b16 v[128:129], v24 offset:0
    v_mfma_f32_16x16x32_bf16 v[248:251], v[40:43], a[204:207], v[248:251]
    ds_read_b64_tr_b16 v[130:131], v24 offset:1024
    v_mfma_f32_16x16x32_bf16 v[252:255], v[44:47], a[204:207], v[252:255]
    v_add_u32 v25, 0x10000, v25
    ds_read_b64_tr_b16 v[132:133], v25 offset:0
    v_mfma_f32_16x16x32_bf16 v[236:239], v[44:47], a[200:203], v[236:239]
    ds_read_b64_tr_b16 v[134:135], v25 offset:1024
    v_mfma_f32_16x16x32_bf16 v[220:223], v[44:47], a[196:199], v[220:223]
    buffer_load_dwordx4 v7, s[32:35], s52 offen offset:1024 lds
    s_waitcnt lgkmcnt(4)
    v_mfma_f32_16x16x32_bf16 v[204:207], v[44:47], a[192:195], v[204:207]
    s_barrier
    v_cmp_ne_u32 s[92:93], v164, 0
    s_nop 0
    s_cmp_eq_u64 s[92:93], -1
    s_cbranch_scc0 L_spgKV
L_okgKV:
    v_mfma_f32_16x16x32_bf16 v[192:195], v[48:51], a[208:211], v[192:195]
    ds_read_b64_tr_b16 v[32:33], v14 offset:49152
    v_mfma_f32_16x16x32_bf16 v[208:211], v[48:51], a[212:215], v[208:211]
    ds_read_b64_tr_b16 v[34:35], v14 offset:50176
    v_mfma_f32_16x16x32_bf16 v[224:227], v[48:51], a[216:219], v[224:227]
    ds_read_b64_tr_b16 v[36:37], v15 offset:49152
    v_mfma_f32_16x16x32_bf16 v[240:243], v[48:51], a[220:223], v[240:243]
    ds_read_b64_tr_b16 v[38:39], v15 offset:50176
    v_mfma_f32_16x16x32_bf16 v[244:247], v[52:55], a[220:223], v[244:247]
    buffer_load_dwordx4 v8, s[32:35], s52 offen offset:2048 lds
    v_mfma_f32_16x16x32_bf16 v[228:231], v[52:55], a[216:219], v[228:231]
    ds_read_b64_tr_b16 v[40:41], v14 offset:53248
    v_mfma_f32_16x16x32_bf16 v[212:215], v[52:55], a[212:215], v[212:215]
    ds_read_b64_tr_b16 v[42:43], v14 offset:54272
    v_mfma_f32_16x16x32_bf16 v[196:199], v[52:55], a[208:211], v[196:199]
    ds_read_b64_tr_b16 v[44:45], v15 offset:53248
    v_mfma_f32_16x16x32_bf16 v[200:203], v[56:59], a[208:211], v[200:203]
    ds_read_b64_tr_b16 v[46:47], v15 offset:54272
    v_mfma_f32_16x16x32_bf16 v[216:219], v[56:59], a[212:215], v[216:219]
    buffer_load_dwordx4 v9, s[32:35], s52 offen offset:3072 lds
    v_mfma_f32_16x16x32_bf16 v[232:235], v[56:59], a[216:219], v[232:235]
    v_add_u32 v26, 0x10000, v26
    ds_read_b64_tr_b16 v[136:137], v26 offset:0
    s_add_u32 s98, s98, 4
    v_mfma_f32_16x16x32_bf16 v[248:251], v[56:59], a[220:223], v[248:251]
    ds_read_b64_tr_b16 v[138:139], v26 offset:1024
    s_and_b32 s98, s98, 15
    v_mfma_f32_16x16x32_bf16 v[252:255], v[60:63], a[220:223], v[252:255]
    v_add_u32 v27, 0x10000, v27
    ds_read_b64_tr_b16 v[140:141], v27 offset:0
    s_add_u32 m0, s50, 32768
    v_mfma_f32_16x16x32_bf16 v[236:239], v[60:63], a[216:219], v[236:239]
    ds_read_b64_tr_b16 v[142:143], v27 offset:1024
    s_mul_i32 s52, s98, 114688
    v_mfma_f32_16x16x32_bf16 v[220:223], v[60:63], a[212:215], v[220:223]
    buffer_load_dwordx4 v6, s[32:35], s52 offen offset:0 lds
    v_mfma_f32_16x16x32_bf16 v[204:207], v[60:63], a[208:211], v[204:207]
    s_waitcnt lgkmcnt(4)
    v_mfma_f32_16x16x32_bf16 v[192:195], v[32:35], a[224:227], v[192:195]
    ds_read_b64_tr_b16 v[48:49], v14 offset:57344
    v_mfma_f32_16x16x32_bf16 v[208:211], v[32:35], a[228:231], v[208:211]
    ds_read_b64_tr_b16 v[50:51], v14 offset:58368
    v_mfma_f32_16x16x32_bf16 v[224:227], v[32:35], a[232:235], v[224:227]
    ds_read_b64_tr_b16 v[52:53], v15 offset:57344
    v_mfma_f32_16x16x32_bf16 v[240:243], v[32:35], a[236:239], v[240:243]
    ds_read_b64_tr_b16 v[54:55], v15 offset:58368
    v_mfma_f32_16x16x32_bf16 v[244:247], v[36:39], a[236:239], v[244:247]
    buffer_load_dwordx4 v7, s[32:35], s52 offen offset:1024 lds
    v_mfma_f32_16x16x32_bf16 v[228:231], v[36:39], a[232:235], v[228:231]
    ds_read_b64_tr_b16 v[56:57], v14 offset:61440
    v_mfma_f32_16x16x32_bf16 v[212:215], v[36:39], a[228:231], v[212:215]
    ds_read_b64_tr_b16 v[58:59], v14 offset:62464
    v_mfma_f32_16x16x32_bf16 v[196:199], v[36:39], a[224:227], v[196:199]
    ds_read_b64_tr_b16 v[60:61], v15 offset:61440
    v_mfma_f32_16x16x32_bf16 v[200:203], v[40:43], a[224:227], v[200:203]
    ds_read_b64_tr_b16 v[62:63], v15 offset:62464
    v_mfma_f32_16x16x32_bf16 v[216:219], v[40:43], a[228:231], v[216:219]
    buffer_load_dwordx4 v8, s[32:35], s52 offen offset:2048 lds
    v_mfma_f32_16x16x32_bf16 v[232:235], v[40:43], a[232:235], v[232:235]
    s_waitcnt vmcnt(7)
    ds_read_b64_tr_b16 v[144:145], v24 offset:16384
    v_mfma_f32_16x16x32_bf16 v[248:251], v[40:43], a[236:239], v[248:251]
    ds_read_b64_tr_b16 v[146:147], v24 offset:17408
    v_mfma_f32_16x16x32_bf16 v[252:255], v[44:47], a[236:239], v[252:255]
    ds_read_b64_tr_b16 v[148:149], v25 offset:16384
    v_mfma_f32_16x16x32_bf16 v[236:239], v[44:47], a[232:235], v[236:239]
    ds_read_b64_tr_b16 v[150:151], v25 offset:17408
    v_mfma_f32_16x16x32_bf16 v[220:223], v[44:47], a[228:231], v[220:223]
    buffer_load_dwordx4 v9, s[32:35], s52 offen offset:3072 lds
    s_waitcnt lgkmcnt(4)
    v_mfma_f32_16x16x32_bf16 v[204:207], v[44:47], a[224:227], v[204:207]
    s_barrier
    v_mfma_f32_16x16x32_bf16 v[192:195], v[48:51], a[240:243], v[192:195]
    ds_read_b64_tr_b16 v[32:33], v12 offset:0
    s_add_u32 s98, s98, 4
    v_mfma_f32_16x16x32_bf16 v[208:211], v[48:51], a[244:247], v[208:211]
    ds_read_b64_tr_b16 v[34:35], v12 offset:256
    s_and_b32 s98, s98, 15
    v_mfma_f32_16x16x32_bf16 v[224:227], v[48:51], a[248:251], v[224:227]
    ds_read_b64_tr_b16 v[36:37], v12 offset:4096
    s_add_u32 m0, s50, 49152
    v_mfma_f32_16x16x32_bf16 v[240:243], v[48:51], a[252:255], v[240:243]
    ds_read_b64_tr_b16 v[38:39], v12 offset:4352
    s_mul_i32 s52, s98, 114688
    v_mfma_f32_16x16x32_bf16 v[244:247], v[52:55], a[252:255], v[244:247]
    buffer_load_dwordx4 v6, s[32:35], s52 offen offset:0 lds
    v_mfma_f32_16x16x32_bf16 v[228:231], v[52:55], a[248:251], v[228:231]
    ds_read_b64_tr_b16 v[40:41], v12 offset:2048
    v_mfma_f32_16x16x32_bf16 v[212:215], v[52:55], a[244:247], v[212:215]
    ds_read_b64_tr_b16 v[42:43], v12 offset:2304
    v_mfma_f32_16x16x32_bf16 v[196:199], v[52:55], a[240:243], v[196:199]
    ds_read_b64_tr_b16 v[44:45], v12 offset:6144
    v_mfma_f32_16x16x32_bf16 v[200:203], v[56:59], a[240:243], v[200:203]
    ds_read_b64_tr_b16 v[46:47], v12 offset:6400
    v_mfma_f32_16x16x32_bf16 v[216:219], v[56:59], a[244:247], v[216:219]
    buffer_load_dwordx4 v7, s[32:35], s52 offen offset:1024 lds
    v_mfma_f32_16x16x32_bf16 v[232:235], v[56:59], a[248:251], v[232:235]
    ds_read_b64_tr_b16 v[152:153], v26 offset:16384
    v_mfma_f32_16x16x32_bf16 v[248:251], v[56:59], a[252:255], v[248:251]
    ds_read_b64_tr_b16 v[154:155], v26 offset:17408
    v_mfma_f32_16x16x32_bf16 v[252:255], v[60:63], a[252:255], v[252:255]
    ds_read_b64_tr_b16 v[156:157], v27 offset:16384
    v_mfma_f32_16x16x32_bf16 v[236:239], v[60:63], a[248:251], v[236:239]
    ds_read_b64_tr_b16 v[158:159], v27 offset:17408
    v_mfma_f32_16x16x32_bf16 v[220:223], v[60:63], a[244:247], v[220:223]
    buffer_load_dwordx4 v8, s[32:35], s52 offen offset:2048 lds
    v_mfma_f32_16x16x32_bf16 v[204:207], v[60:63], a[240:243], v[204:207]
    v_exp_f32_e64 v160, v164
    s_nop 0
    v_add_f32 v160, 1.0, v160
    v_min_f32 v160, 0x7f000000, v160
    v_mov_b32 v161, v160
    s_nop 1
    v_permlane16_swap_b32 v160, v161
    v_mov_b32 v162, v160
    v_mov_b32 v163, v161
    s_nop 0
    v_permlane32_swap_b32 v160, v162
    v_permlane32_swap_b32 v161, v163
.p2align 3
    v_pk_mul_f32 v[48:49], v[192:193], v[192:193]
    v_pk_mul_f32 v[50:51], v[194:195], v[194:195]
    v_pk_mul_f32 v[52:53], v[196:197], v[196:197]
    v_pk_mul_f32 v[54:55], v[198:199], v[198:199]
    v_pk_fma_f32 v[48:49], v[48:49], v[30:31], v[30:31] op_sel:[0,1,0] op_sel_hi:[1,1,0]
    v_pk_fma_f32 v[50:51], v[50:51], v[30:31], v[30:31] op_sel:[0,1,0] op_sel_hi:[1,1,0]
    v_pk_fma_f32 v[52:53], v[52:53], v[30:31], v[30:31] op_sel:[0,1,0] op_sel_hi:[1,1,0]
    buffer_load_dwordx4 v9, s[32:35], s52 offen offset:3072 lds
    v_pk_fma_f32 v[54:55], v[54:55], v[30:31], v[30:31] op_sel:[0,1,0] op_sel_hi:[1,1,0]
    v_pk_mul_f32 v[48:49], v[48:49], v[192:193]
    v_pk_mul_f32 v[50:51], v[50:51], v[194:195]
    v_pk_mul_f32 v[52:53], v[52:53], v[196:197]
    v_pk_mul_f32 v[54:55], v[54:55], v[198:199]
    v_exp_f32 v48, v48
    v_exp_f32 v49, v49
    v_exp_f32 v50, v50
    v_exp_f32 v51, v51
    v_exp_f32_e64 v52, v52
    s_add_u32 s84, s100, 163840
    s_and_b32 s84, s84, 229376
    s_add_u32 m0, s50, 65536
    s_xor_b32 s84, s84, s4
    buffer_load_dwordx4 v20, s[56:59], s84 offen offset:0 lds
    v_exp_f32 v53, v53
    v_exp_f32 v54, v54
    v_exp_f32 v55, v55
    v_pk_fma_f32 v[48:49], v[48:49], v[160:161], v[160:161] op_sel:[0,0,0] op_sel_hi:[1,0,0]
    v_pk_fma_f32 v[50:51], v[50:51], v[160:161], v[160:161] op_sel:[0,0,0] op_sel_hi:[1,0,0]
    v_pk_fma_f32 v[52:53], v[52:53], v[160:161], v[160:161] op_sel:[0,0,0] op_sel_hi:[1,0,0]
    v_pk_fma_f32 v[54:55], v[54:55], v[160:161], v[160:161] op_sel:[0,0,0] op_sel_hi:[1,0,0]
    v_rcp_f32 v48, v48
    v_rcp_f32 v49, v49
    buffer_load_dwordx4 v21, s[56:59], s84 offen offset:1024 lds
    v_rcp_f32 v50, v50
    v_rcp_f32 v51, v51
    v_rcp_f32 v52, v52
    v_rcp_f32 v53, v53
    v_rcp_f32 v54, v54
    v_rcp_f32 v55, v55
    v_pk_mul_f32 v[192:193], v[192:193], v[200:201]
    v_pk_mul_f32 v[194:195], v[194:195], v[202:203]
    v_pk_mul_f32 v[196:197], v[196:197], v[204:205]
    buffer_load_dwordx4 v22, s[56:59], s84 offen offset:2048 lds
    v_pk_mul_f32 v[198:199], v[198:199], v[206:207]
    v_pk_mul_f32 v[192:193], v[192:193], v[48:49]
    v_pk_mul_f32 v[194:195], v[194:195], v[50:51]
    v_pk_mul_f32 v[196:197], v[196:197], v[52:53]
    v_pk_mul_f32 v[198:199], v[198:199], v[54:55]
    v_cvt_pk_bf16_f32 v200, v192, v193
    v_cvt_pk_bf16_f32 v202, v196, v197
    v_cvt_pk_bf16_f32 v201, v194, v195
    v_cvt_pk_bf16_f32 v203, v198, v199
    v_pk_mul_f32 v[56:57], v[208:209], v[208:209]
    v_pk_mul_f32 v[58:59], v[210:211], v[210:211]
    v_pk_mul_f32 v[60:61], v[212:213], v[212:213]
    v_pk_mul_f32 v[62:63], v[214:215], v[214:215]
    v_pk_fma_f32 v[56:57], v[56:57], v[30:31], v[30:31] op_sel:[0,1,0] op_sel_hi:[1,1,0]
    v_pk_fma_f32 v[58:59], v[58:59], v[30:31], v[30:31] op_sel:[0,1,0] op_sel_hi:[1,1,0]
    v_pk_fma_f32 v[60:61], v[60:61], v[30:31], v[30:31] op_sel:[0,1,0] op_sel_hi:[1,1,0]
    buffer_load_dwordx4 v23, s[56:59], s84 offen offset:3072 lds
    v_pk_fma_f32 v[62:63], v[62:63], v[30:31], v[30:31] op_sel:[0,1,0] op_sel_hi:[1,1,0]
    v_pk_mul_f32 v[56:57], v[56:57], v[208:209]
    v_pk_mul_f32 v[58:59], v[58:59], v[210:211]
    v_pk_mul_f32 v[60:61], v[60:61], v[212:213]
    v_pk_mul_f32 v[62:63], v[62:63], v[214:215]
    v_exp_f32 v56, v56
    v_exp_f32 v57, v57
    v_exp_f32 v58, v58
    v_exp_f32 v59, v59
    v_exp_f32_e64 v60, v60
    s_add_u32 s84, s100, 196608
    s_and_b32 s84, s84, 229376
    s_add_u32 m0, s50, 114688
    s_xor_b32 s84, s84, s4
    buffer_load_dwordx4 v20, s[56:59], s84 offen offset:0 lds
    v_exp_f32 v61, v61
    v_exp_f32 v62, v62
    v_exp_f32 v63, v63
    v_pk_fma_f32 v[56:57], v[56:57], v[160:161], v[160:161] op_sel:[0,1,1] op_sel_hi:[1,1,1]
    v_pk_fma_f32 v[58:59], v[58:59], v[160:161], v[160:161] op_sel:[0,1,1] op_sel_hi:[1,1,1]
    v_pk_fma_f32 v[60:61], v[60:61], v[160:161], v[160:161] op_sel:[0,1,1] op_sel_hi:[1,1,1]
    v_pk_fma_f32 v[62:63], v[62:63], v[160:161], v[160:161] op_sel:[0,1,1] op_sel_hi:[1,1,1]
    v_rcp_f32 v56, v56
    v_rcp_f32 v57, v57
    buffer_load_dwordx4 v21, s[56:59], s84 offen offset:1024 lds
    v_rcp_f32 v58, v58
    v_rcp_f32 v59, v59
    v_rcp_f32 v60, v60
    v_rcp_f32 v61, v61
    v_rcp_f32 v62, v62
    v_rcp_f32 v63, v63
    v_pk_mul_f32 v[208:209], v[208:209], v[216:217]
    v_pk_mul_f32 v[210:211], v[210:211], v[218:219]
    v_pk_mul_f32 v[212:213], v[212:213], v[220:221]
    buffer_store_dwordx4 v[200:203], v16, s[36:39], s54 offen offset:0 sc1
    v_pk_mul_f32 v[214:215], v[214:215], v[222:223]
    v_pk_mul_f32 v[208:209], v[208:209], v[56:57]
    v_pk_mul_f32 v[210:211], v[210:211], v[58:59]
    v_pk_mul_f32 v[212:213], v[212:213], v[60:61]
    v_pk_mul_f32 v[214:215], v[214:215], v[62:63]
    v_cvt_pk_bf16_f32 v216, v208, v209
    v_cvt_pk_bf16_f32 v218, v212, v213
    v_cvt_pk_bf16_f32 v217, v210, v211
    v_cvt_pk_bf16_f32 v219, v214, v215
    v_pk_mul_f32 v[48:49], v[224:225], v[224:225]
    v_pk_mul_f32 v[50:51], v[226:227], v[226:227]
    v_pk_mul_f32 v[52:53], v[228:229], v[228:229]
    v_pk_mul_f32 v[54:55], v[230:231], v[230:231]
    v_pk_fma_f32 v[48:49], v[48:49], v[30:31], v[30:31] op_sel:[0,1,0] op_sel_hi:[1,1,0]
    v_pk_fma_f32 v[50:51], v[50:51], v[30:31], v[30:31] op_sel:[0,1,0] op_sel_hi:[1,1,0]
    v_pk_fma_f32 v[52:53], v[52:53], v[30:31], v[30:31] op_sel:[0,1,0] op_sel_hi:[1,1,0]
    v_pk_fma_f32 v[54:55], v[54:55], v[30:31], v[30:31] op_sel:[0,1,0] op_sel_hi:[1,1,0]
    v_pk_mul_f32 v[48:49], v[48:49], v[224:225]
    v_pk_mul_f32 v[50:51], v[50:51], v[226:227]
    v_pk_mul_f32 v[52:53], v[52:53], v[228:229]
    v_pk_mul_f32 v[54:55], v[54:55], v[230:231]
    v_exp_f32 v48, v48
    v_exp_f32 v49, v49
    buffer_load_dwordx4 v22, s[56:59], s84 offen offset:2048 lds
    v_exp_f32 v50, v50
    v_exp_f32 v51, v51
    v_exp_f32 v52, v52
    v_exp_f32 v53, v53
    v_exp_f32 v54, v54
    v_exp_f32 v55, v55
    v_pk_fma_f32 v[48:49], v[48:49], v[162:163], v[162:163] op_sel:[0,0,0] op_sel_hi:[1,0,0]
    v_pk_fma_f32 v[50:51], v[50:51], v[162:163], v[162:163] op_sel:[0,0,0] op_sel_hi:[1,0,0]
    v_pk_fma_f32 v[52:53], v[52:53], v[162:163], v[162:163] op_sel:[0,0,0] op_sel_hi:[1,0,0]
    v_pk_fma_f32 v[54:55], v[54:55], v[162:163], v[162:163] op_sel:[0,0,0] op_sel_hi:[1,0,0]
    v_rcp_f32 v48, v48
    v_rcp_f32 v49, v49
    v_rcp_f32 v50, v50
    v_rcp_f32 v51, v51
    v_rcp_f32_e64 v52, v52
    buffer_store_dwordx4 v[216:219], v16, s[36:39], s54 offen offset:1024 sc1
    v_rcp_f32 v53, v53
    v_rcp_f32 v54, v54
    v_rcp_f32_e64 v55, v55
    v_pk_mul_f32 v[224:225], v[224:225], v[232:233]
    v_pk_mul_f32 v[226:227], v[226:227], v[234:235]
    v_pk_mul_f32 v[228:229], v[228:229], v[236:237]
    v_pk_mul_f32 v[230:231], v[230:231], v[238:239]
    v_pk_mul_f32 v[224:225], v[224:225], v[48:49]
    v_pk_mul_f32 v[226:227], v[226:227], v[50:51]
    v_pk_mul_f32 v[228:229], v[228:229], v[52:53]
    v_pk_mul_f32 v[230:231], v[230:231], v[54:55]
    v_cvt_pk_bf16_f32 v232, v224, v225
    v_cvt_pk_bf16_f32 v234, v228, v229
    v_cvt_pk_bf16_f32 v233, v226, v227
    v_cvt_pk_bf16_f32 v235, v230, v231
    v_pk_mul_f32 v[56:57], v[240:241], v[240:241]
    v_pk_mul_f32 v[58:59], v[242:243], v[242:243]
    v_pk_mul_f32 v[60:61], v[244:245], v[244:245]
    v_pk_mul_f32 v[62:63], v[246:247], v[246:247]
    v_pk_fma_f32 v[56:57], v[56:57], v[30:31], v[30:31] op_sel:[0,1,0] op_sel_hi:[1,1,0]
    v_pk_fma_f32 v[58:59], v[58:59], v[30:31], v[30:31] op_sel:[0,1,0] op_sel_hi:[1,1,0]
    v_pk_fma_f32 v[60:61], v[60:61], v[30:31], v[30:31] op_sel:[0,1,0] op_sel_hi:[1,1,0]
    v_pk_fma_f32 v[62:63], v[62:63], v[30:31], v[30:31] op_sel:[0,1,0] op_sel_hi:[1,1,0]
    v_pk_mul_f32 v[56:57], v[56:57], v[240:241]
    v_pk_mul_f32 v[58:59], v[58:59], v[242:243]
    v_pk_mul_f32 v[60:61], v[60:61], v[244:245]
    v_pk_mul_f32 v[62:63], v[62:63], v[246:247]
    v_exp_f32 v56, v56
    v_exp_f32 v57, v57
    v_exp_f32 v58, v58
    v_exp_f32 v59, v59
    v_exp_f32 v60, v60
    v_exp_f32 v61, v61
    v_exp_f32 v62, v62
    v_exp_f32 v63, v63
    buffer_store_dwordx4 v[232:235], v16, s[36:39], s54 offen offset:2048 sc1
    v_pk_fma_f32 v[56:57], v[56:57], v[162:163], v[162:163] op_sel:[0,1,1] op_sel_hi:[1,1,1]
    v_pk_fma_f32 v[58:59], v[58:59], v[162:163], v[162:163] op_sel:[0,1,1] op_sel_hi:[1,1,1]
    v_pk_fma_f32 v[60:61], v[60:61], v[162:163], v[162:163] op_sel:[0,1,1] op_sel_hi:[1,1,1]
    v_pk_fma_f32 v[62:63], v[62:63], v[162:163], v[162:163] op_sel:[0,1,1] op_sel_hi:[1,1,1]
    v_rcp_f32 v56, v56
    v_rcp_f32 v57, v57
    v_rcp_f32 v58, v58
    v_rcp_f32 v59, v59
    v_rcp_f32 v60, v60
    v_rcp_f32 v61, v61
    v_rcp_f32 v62, v62
    v_rcp_f32 v63, v63
    v_pk_mul_f32 v[240:241], v[240:241], v[248:249]
    v_pk_mul_f32 v[242:243], v[242:243], v[250:251]
    v_pk_mul_f32 v[244:245], v[244:245], v[252:253]
    v_pk_mul_f32 v[246:247], v[246:247], v[254:255]
    v_pk_mul_f32 v[240:241], v[240:241], v[56:57]
    v_pk_mul_f32 v[242:243], v[242:243], v[58:59]
    v_pk_mul_f32 v[244:245], v[244:245], v[60:61]
    v_pk_mul_f32 v[246:247], v[246:247], v[62:63]
    v_cvt_pk_bf16_f32 v248, v240, v241
    v_cvt_pk_bf16_f32 v250, v244, v245
    v_cvt_pk_bf16_f32 v249, v242, v243
    v_cvt_pk_bf16_f32 v251, v246, v247
    buffer_store_dwordx4 v[248:251], v16, s[36:39], s54 offen offset:3072 sc1
    s_add_u32 s48, s44, s47
    s_lshl_b32 s48, s48, 12
    s_sub_u32 s54, s54, s48
    s_add_u32 s54, s54, 65536
    s_waitcnt lgkmcnt(0)
    v_mfma_f32_16x16x32_bf16 v[192:195], v[32:35], a[0:3], 0
    ds_read_b64_tr_b16 v[48:49], v12 offset:8192
    s_lshl_b32 s48, s40, 10
    v_mfma_f32_16x16x32_bf16 v[196:199], v[32:35], a[4:7], 0
    ds_read_b64_tr_b16 v[50:51], v12 offset:8448
    v_add_u32 v2, s48, v16
    v_mfma_f32_16x16x32_bf16 v[208:211], v[32:35], a[8:11], 0
    ds_read_b64_tr_b16 v[52:53], v12 offset:12288
    v_xor_b32 v3, 1024, v2
    v_mfma_f32_16x16x32_bf16 v[212:215], v[32:35], a[12:15], 0
    ds_read_b64_tr_b16 v[54:55], v12 offset:12544
    v_xor_b32 v4, 2048, v2
    v_mfma_f32_16x16x32_bf16 v[220:223], v[36:39], a[12:15], 0
    ds_read_b64_tr_b16 v[56:57], v12 offset:10240
    v_xor_b32 v5, 3072, v2
    v_mfma_f32_16x16x32_bf16 v[216:219], v[36:39], a[8:11], 0
    ds_read_b64_tr_b16 v[58:59], v12 offset:10496
    v_mfma_f32_16x16x32_bf16 v[204:207], v[36:39], a[4:7], 0
    ds_read_b64_tr_b16 v[60:61], v12 offset:14336
    v_mfma_f32_16x16x32_bf16 v[200:203], v[36:39], a[0:3], 0
    ds_read_b64_tr_b16 v[62:63], v12 offset:14592
    v_mfma_f32_16x16x32_bf16 v[192:195], v[40:43], a[16:19], v[192:195]
    v_mfma_f32_16x16x32_bf16 v[196:199], v[40:43], a[20:23], v[196:199]
    v_mfma_f32_16x16x32_bf16 v[208:211], v[40:43], a[24:27], v[208:211]
    v_mfma_f32_16x16x32_bf16 v[212:215], v[40:43], a[28:31], v[212:215]
    v_mfma_f32_16x16x32_bf16 v[220:223], v[44:47], a[28:31], v[220:223]
    v_mfma_f32_16x16x32_bf16 v[216:219], v[44:47], a[24:27], v[216:219]
    v_mfma_f32_16x16x32_bf16 v[204:207], v[44:47], a[20:23], v[204:207]
    s_waitcnt vmcnt(19) lgkmcnt(0)
    v_mfma_f32_16x16x32_bf16 v[200:203], v[44:47], a[16:19], v[200:203]
    s_barrier
    v_mfma_f32_16x16x32_bf16 v[192:195], v[48:51], a[32:35], v[192:195]
    ds_read_b64_tr_b16 v[32:33], v12 offset:16384
    v_mfma_f32_16x16x32_bf16 v[196:199], v[48:51], a[36:39], v[196:199]
    ds_read_b64_tr_b16 v[34:35], v12 offset:16640
    v_mfma_f32_16x16x32_bf16 v[208:211], v[48:51], a[40:43], v[208:211]
    ds_read_b64_tr_b16 v[36:37], v12 offset:20480
    v_mfma_f32_16x16x32_bf16 v[212:215], v[48:51], a[44:47], v[212:215]
    buffer_load_dwordx4 v23, s[56:59], s84 offen offset:3072 lds
    v_mfma_f32_16x16x32_bf16 v[220:223], v[52:55], a[44:47], v[220:223]
    ds_read_b64_tr_b16 v[38:39], v12 offset:20736
    s_add_u32 s84, s100, 229376
    v_mfma_f32_16x16x32_bf16 v[216:219], v[52:55], a[40:43], v[216:219]
    ds_read_b64_tr_b16 v[40:41], v12 offset:18432
    s_and_b32 s84, s84, 229376
    s_add_u32 m0, s50, 131072
    v_mfma_f32_16x16x32_bf16 v[204:207], v[52:55], a[36:39], v[204:207]
    ds_read_b64_tr_b16 v[42:43], v12 offset:18688
    s_xor_b32 s84, s84, s4
    v_mfma_f32_16x16x32_bf16 v[200:203], v[52:55], a[32:35], v[200:203]
    buffer_load_dwordx4 v20, s[56:59], s84 offen offset:0 lds
    v_mfma_f32_16x16x32_bf16 v[192:195], v[56:59], a[48:51], v[192:195]
    ds_read_b64_tr_b16 v[44:45], v12 offset:22528
    v_mfma_f32_16x16x32_bf16 v[196:199], v[56:59], a[52:55], v[196:199]
    ds_read_b64_tr_b16 v[46:47], v12 offset:22784
    v_mfma_f32_16x16x32_bf16 v[208:211], v[56:59], a[56:59], v[208:211]
    v_mfma_f32_16x16x32_bf16 v[212:215], v[56:59], a[60:63], v[212:215]
    buffer_load_dwordx4 v21, s[56:59], s84 offen offset:1024 lds
    v_mfma_f32_16x16x32_bf16 v[220:223], v[60:63], a[60:63], v[220:223]
    v_mfma_f32_16x16x32_bf16 v[216:219], v[60:63], a[56:59], v[216:219]
    v_mfma_f32_16x16x32_bf16 v[204:207], v[60:63], a[52:55], v[204:207]
    v_mfma_f32_16x16x32_bf16 v[200:203], v[60:63], a[48:51], v[200:203]
    buffer_load_dwordx4 v22, s[56:59], s84 offen offset:2048 lds
    s_waitcnt lgkmcnt(1)
    v_mfma_f32_16x16x32_bf16 v[192:195], v[32:35], a[64:67], v[192:195]
    ds_read_b64_tr_b16 v[48:49], v12 offset:24576
    v_mfma_f32_16x16x32_bf16 v[196:199], v[32:35], a[68:71], v[196:199]
    ds_read_b64_tr_b16 v[50:51], v12 offset:24832
    v_mfma_f32_16x16x32_bf16 v[208:211], v[32:35], a[72:75], v[208:211]
    ds_read_b64_tr_b16 v[52:53], v12 offset:28672
    v_mfma_f32_16x16x32_bf16 v[212:215], v[32:35], a[76:79], v[212:215]
    buffer_load_dword v19, v1, s[36:39], s1 offen offset:0 sc1
    v_mfma_f32_16x16x32_bf16 v[220:223], v[36:39], a[76:79], v[220:223]
    ds_read_b64_tr_b16 v[54:55], v12 offset:28928
    v_mfma_f32_16x16x32_bf16 v[216:219], v[36:39], a[72:75], v[216:219]
    ds_read_b64_tr_b16 v[56:57], v12 offset:26624
    v_mfma_f32_16x16x32_bf16 v[204:207], v[36:39], a[68:71], v[204:207]
    ds_read_b64_tr_b16 v[58:59], v12 offset:26880
    v_mfma_f32_16x16x32_bf16 v[200:203], v[36:39], a[64:67], v[200:203]
    buffer_load_dwordx4 v23, s[56:59], s84 offen offset:3072 lds
    v_mfma_f32_16x16x32_bf16 v[192:195], v[40:43], a[80:83], v[192:195]
    ds_read_b64_tr_b16 v[60:61], v12 offset:30720
    s_add_u32 s84, s100, 0
    v_mfma_f32_16x16x32_bf16 v[196:199], v[40:43], a[84:87], v[196:199]
    ds_read_b64_tr_b16 v[62:63], v12 offset:30976
    s_and_b32 s84, s84, 98304
    s_add_u32 m0, s50, 147456
    v_mfma_f32_16x16x32_bf16 v[208:211], v[40:43], a[88:91], v[208:211]
    s_xor_b32 s84, s84, s5
    v_mfma_f32_16x16x32_bf16 v[212:215], v[40:43], a[92:95], v[212:215]
    buffer_load_dwordx4 v20, s[56:59], s84 offen offset:0 lds
    s_waitcnt lgkmcnt(4)
    v_mfma_f32_16x16x32_bf16 v[220:223], v[44:47], a[92:95], v[220:223]
    v_mfma_f32_16x16x32_bf16 v[216:219], v[44:47], a[88:91], v[216:219]
    v_mfma_f32_16x16x32_bf16 v[204:207], v[44:47], a[84:87], v[204:207]
    buffer_load_dwordx4 v21, s[56:59], s84 offen offset:1024 lds
    s_waitcnt vmcnt(23) lgkmcnt(0)
    v_mfma_f32_16x16x32_bf16 v[200:203], v[44:47], a[80:83], v[200:203]
    s_barrier
    v_mfma_f32_16x16x32_bf16 v[192:195], v[48:51], a[96:99], v[192:195]
    ds_read_b64_tr_b16 v[32:33], v12 offset:32768
    v_mfma_f32_16x16x32_bf16 v[196:199], v[48:51], a[100:103], v[196:199]
    ds_read_b64_tr_b16 v[34:35], v12 offset:33024
    v_mfma_f32_16x16x32_bf16 v[208:211], v[48:51], a[104:107], v[208:211]
    ds_read_b64_tr_b16 v[36:37], v12 offset:36864
    v_mfma_f32_16x16x32_bf16 v[212:215], v[48:51], a[108:111], v[212:215]
    buffer_load_dwordx4 v22, s[56:59], s84 offen offset:2048 lds
    v_mfma_f32_16x16x32_bf16 v[220:223], v[52:55], a[108:111], v[220:223]
    ds_read_b64_tr_b16 v[38:39], v12 offset:37120
    v_mfma_f32_16x16x32_bf16 v[216:219], v[52:55], a[104:107], v[216:219]
    ds_read_b64_tr_b16 v[40:41], v12 offset:34816
    v_mfma_f32_16x16x32_bf16 v[204:207], v[52:55], a[100:103], v[204:207]
    ds_read_b64_tr_b16 v[42:43], v12 offset:35072
    v_mfma_f32_16x16x32_bf16 v[200:203], v[52:55], a[96:99], v[200:203]
    buffer_load_dwordx4 v23, s[56:59], s84 offen offset:3072 lds
    v_mfma_f32_16x16x32_bf16 v[192:195], v[56:59], a[112:115], v[192:195]
    ds_read_b64_tr_b16 v[44:45], v12 offset:38912
    s_add_u32 s84, s100, 32768
    s_and_b32 s84, s84, 98304
    v_mfma_f32_16x16x32_bf16 v[196:199], v[56:59], a[116:119], v[196:199]
    ds_read_b64_tr_b16 v[46:47], v12 offset:39168
    s_add_u32 m0, s50, 0
    v_mfma_f32_16x16x32_bf16 v[208:211], v[56:59], a[120:123], v[208:211]
    s_xor_b32 s84, s84, s5
    v_mfma_f32_16x16x32_bf16 v[212:215], v[56:59], a[124:127], v[212:215]
    buffer_load_dwordx4 v20, s[56:59], s84 offen offset:0 lds
    v_mfma_f32_16x16x32_bf16 v[220:223], v[60:63], a[124:127], v[220:223]
    v_mfma_f32_16x16x32_bf16 v[216:219], v[60:63], a[120:123], v[216:219]
    v_mfma_f32_16x16x32_bf16 v[204:207], v[60:63], a[116:119], v[204:207]
    v_mfma_f32_16x16x32_bf16 v[200:203], v[60:63], a[112:115], v[200:203]
    buffer_load_dwordx4 v21, s[56:59], s84 offen offset:1024 lds
    s_waitcnt lgkmcnt(1)
    v_mfma_f32_16x16x32_bf16 v[192:195], v[32:35], a[128:131], v[192:195]
    ds_read_b64_tr_b16 v[48:49], v12 offset:40960
    v_mfma_f32_16x16x32_bf16 v[196:199], v[32:35], a[132:135], v[196:199]
    ds_read_b64_tr_b16 v[50:51], v12 offset:41216
    v_mfma_f32_16x16x32_bf16 v[208:211], v[32:35], a[136:139], v[208:211]
    ds_read_b64_tr_b16 v[52:53], v12 offset:45056
    v_mfma_f32_16x16x32_bf16 v[212:215], v[32:35], a[140:143], v[212:215]
    buffer_load_dwordx4 v22, s[56:59], s84 offen offset:2048 lds
    v_mfma_f32_16x16x32_bf16 v[220:223], v[36:39], a[140:143], v[220:223]
    ds_read_b64_tr_b16 v[54:55], v12 offset:45312
    v_mfma_f32_16x16x32_bf16 v[216:219], v[36:39], a[136:139], v[216:219]
    ds_read_b64_tr_b16 v[56:57], v12 offset:43008
    v_mfma_f32_16x16x32_bf16 v[204:207], v[36:39], a[132:135], v[204:207]
    ds_read_b64_tr_b16 v[58:59], v12 offset:43264
    v_mfma_f32_16x16x32_bf16 v[200:203], v[36:39], a[128:131], v[200:203]
    buffer_load_dwordx4 v23, s[56:59], s84 offen offset:3072 lds
    v_mfma_f32_16x16x32_bf16 v[192:195], v[40:43], a[144:147], v[192:195]
    ds_read_b64_tr_b16 v[60:61], v12 offset:47104
    s_add_u32 s84, s100, 65536
    s_and_b32 s84, s84, 98304
    v_mfma_f32_16x16x32_bf16 v[196:199], v[40:43], a[148:151], v[196:199]
    ds_read_b64_tr_b16 v[62:63], v12 offset:47360
    s_add_u32 m0, s50, 16384
    v_mfma_f32_16x16x32_bf16 v[208:211], v[40:43], a[152:155], v[208:211]
    s_xor_b32 s84, s84, s5
    v_mfma_f32_16x16x32_bf16 v[212:215], v[40:43], a[156:159], v[212:215]
    buffer_load_dwordx4 v20, s[56:59], s84 offen offset:0 lds
    s_waitcnt lgkmcnt(4)
    v_mfma_f32_16x16x32_bf16 v[220:223], v[44:47], a[156:159], v[220:223]
    v_mfma_f32_16x16x32_bf16 v[216:219], v[44:47], a[152:155], v[216:219]
    v_mfma_f32_16x16x32_bf16 v[204:207], v[44:47], a[148:151], v[204:207]
    buffer_load_dwordx4 v21, s[56:59], s84 offen offset:1024 lds
    s_waitcnt vmcnt(16) lgkmcnt(0)
    v_mfma_f32_16x16x32_bf16 v[200:203], v[44:47], a[144:147], v[200:203]
    s_barrier
    v_mfma_f32_16x16x32_bf16 v[192:195], v[48:51], a[160:163], v[192:195]
    ds_read_b64_tr_b16 v[32:33], v12 offset:49152
    v_mfma_f32_16x16x32_bf16 v[196:199], v[48:51], a[164:167], v[196:199]
    ds_read_b64_tr_b16 v[34:35], v12 offset:49408
    v_mfma_f32_16x16x32_bf16 v[208:211], v[48:51], a[168:171], v[208:211]
    ds_read_b64_tr_b16 v[36:37], v12 offset:53248
    v_mfma_f32_16x16x32_bf16 v[212:215], v[48:51], a[172:175], v[212:215]
    buffer_store_dword v24, v18, s[36:39], s0 offen sc1
    v_mfma_f32_16x16x32_bf16 v[220:223], v[52:55], a[172:175], v[220:223]
    ds_read_b64_tr_b16 v[38:39], v12 offset:53504
    v_mfma_f32_16x16x32_bf16 v[216:219], v[52:55], a[168:171], v[216:219]
    ds_read_b64_tr_b16 v[40:41], v12 offset:51200
    v_mfma_f32_16x16x32_bf16 v[204:207], v[52:55], a[164:167], v[204:207]
    ds_read_b64_tr_b16 v[42:43], v12 offset:51456
    v_mfma_f32_16x16x32_bf16 v[200:203], v[52:55], a[160:163], v[200:203]
    buffer_load_dwordx4 v22, s[56:59], s84 offen offset:2048 lds
    v_mfma_f32_16x16x32_bf16 v[192:195], v[56:59], a[176:179], v[192:195]
    ds_read_b64_tr_b16 v[44:45], v12 offset:55296
    v_mfma_f32_16x16x32_bf16 v[196:199], v[56:59], a[180:183], v[196:199]
    ds_read_b64_tr_b16 v[46:47], v12 offset:55552
    v_mfma_f32_16x16x32_bf16 v[208:211], v[56:59], a[184:187], v[208:211]
    v_mfma_f32_16x16x32_bf16 v[212:215], v[56:59], a[188:191], v[212:215]
    buffer_load_dwordx4 v23, s[56:59], s84 offen offset:3072 lds
    v_mfma_f32_16x16x32_bf16 v[220:223], v[60:63], a[188:191], v[220:223]
    s_waitcnt vmcnt(14)
    v_cmp_ne_u32 s[92:93], 0, v19
    s_nop 0
    s_cmp_eq_u64 s[92:93], -1
    s_cbranch_scc0 L_sp8
L_ok8:
    s_add_u32 s86, s101, 0
    v_mfma_f32_16x16x32_bf16 v[216:219], v[60:63], a[184:187], v[216:219]
    s_and_b32 s86, s86, 28672
    v_mfma_f32_16x16x32_bf16 v[204:207], v[60:63], a[180:183], v[204:207]
    s_xor_b32 s86, s86, s8
    v_mfma_f32_16x16x32_bf16 v[200:203], v[60:63], a[176:179], v[200:203]
L_kvmain_s4:
    s_cbranch_execz L_kvmain_ret
    buffer_load_dwordx4 a[0:3], v2, s[36:39], s86 offen sc1
    s_waitcnt lgkmcnt(0)
    v_mfma_f32_16x16x32_bf16 v[192:195], v[32:35], a[192:195], v[192:195]
    ds_read_b64_tr_b16 v[48:49], v12 offset:57344
    v_mfma_f32_16x16x32_bf16 v[196:199], v[32:35], a[196:199], v[196:199]
    ds_read_b64_tr_b16 v[50:51], v12 offset:57600
    v_mfma_f32_16x16x32_bf16 v[208:211], v[32:35], a[200:203], v[208:211]
    ds_read_b64_tr_b16 v[52:53], v12 offset:61440
    v_mfma_f32_16x16x32_bf16 v[212:215], v[32:35], a[204:207], v[212:215]
    buffer_load_dwordx4 a[4:7], v3, s[36:39], s86 offen sc1
    v_mfma_f32_16x16x32_bf16 v[220:223], v[36:39], a[204:207], v[220:223]
    ds_read_b64_tr_b16 v[54:55], v12 offset:61696
    v_mfma_f32_16x16x32_bf16 v[216:219], v[36:39], a[200:203], v[216:219]
    ds_read_b64_tr_b16 v[56:57], v12 offset:59392
    v_mfma_f32_16x16x32_bf16 v[204:207], v[36:39], a[196:199], v[204:207]
    ds_read_b64_tr_b16 v[58:59], v12 offset:59648
    v_mfma_f32_16x16x32_bf16 v[200:203], v[36:39], a[192:195], v[200:203]
    buffer_load_dwordx4 a[8:11], v4, s[36:39], s86 offen sc1
    v_mfma_f32_16x16x32_bf16 v[192:195], v[40:43], a[208:211], v[192:195]
    ds_read_b64_tr_b16 v[60:61], v12 offset:63488
    v_mfma_f32_16x16x32_bf16 v[196:199], v[40:43], a[212:215], v[196:199]
    ds_read_b64_tr_b16 v[62:63], v12 offset:63744
    v_mfma_f32_16x16x32_bf16 v[208:211], v[40:43], a[216:219], v[208:211]
    v_mfma_f32_16x16x32_bf16 v[212:215], v[40:43], a[220:223], v[212:215]
    buffer_load_dwordx4 a[12:15], v5, s[36:39], s86 offen sc1
    v_mfma_f32_16x16x32_bf16 v[220:223], v[44:47], a[220:223], v[220:223]
    s_add_u32 s86, s101, 4096
    s_and_b32 s86, s86, 28672
    v_mfma_f32_16x16x32_bf16 v[216:219], v[44:47], a[216:219], v[216:219]
    s_xor_b32 s86, s86, s8
    v_mfma_f32_16x16x32_bf16 v[204:207], v[44:47], a[212:215], v[204:207]
    buffer_load_dwordx4 a[16:19], v2, s[36:39], s86 offen sc1
    s_waitcnt lgkmcnt(0)
    v_mfma_f32_16x16x32_bf16 v[200:203], v[44:47], a[208:211], v[200:203]
    s_barrier
    v_mfma_f32_16x16x32_bf16 v[192:195], v[48:51], a[224:227], v[192:195]
    v_mfma_f32_16x16x32_bf16 v[196:199], v[48:51], a[228:231], v[196:199]
    v_mfma_f32_16x16x32_bf16 v[208:211], v[48:51], a[232:235], v[208:211]
    v_mfma_f32_16x16x32_bf16 v[212:215], v[48:51], a[236:239], v[212:215]
    buffer_load_dwordx4 a[20:23], v3, s[36:39], s86 offen sc1
    v_mfma_f32_16x16x32_bf16 v[220:223], v[52:55], a[236:239], v[220:223]
    v_mfma_f32_16x16x32_bf16 v[216:219], v[52:55], a[232:235], v[216:219]
    v_mfma_f32_16x16x32_bf16 v[204:207], v[52:55], a[228:231], v[204:207]
    v_mfma_f32_16x16x32_bf16 v[200:203], v[52:55], a[224:227], v[200:203]
    buffer_load_dwordx4 a[24:27], v4, s[36:39], s86 offen sc1
    v_mfma_f32_16x16x32_bf16 v[192:195], v[56:59], a[240:243], v[192:195]
    v_mfma_f32_16x16x32_bf16 v[196:199], v[56:59], a[244:247], v[196:199]
    v_mfma_f32_16x16x32_bf16 v[208:211], v[56:59], a[248:251], v[208:211]
    v_mfma_f32_16x16x32_bf16 v[212:215], v[56:59], a[252:255], v[212:215]
    buffer_load_dwordx4 a[28:31], v5, s[36:39], s86 offen sc1
    v_mfma_f32_16x16x32_bf16 v[220:223], v[60:63], a[252:255], v[220:223]
    s_add_u32 s84, s100, 98304
    s_and_b32 s84, s84, 98304
    v_mfma_f32_16x16x32_bf16 v[216:219], v[60:63], a[248:251], v[216:219]
    s_add_u32 m0, s50, 32768
    v_mfma_f32_16x16x32_bf16 v[204:207], v[60:63], a[244:247], v[204:207]
    s_xor_b32 s84, s84, s5
    v_mfma_f32_16x16x32_bf16 v[200:203], v[60:63], a[240:243], v[200:203]
    buffer_load_dwordx4 v20, s[56:59], s84 offen offset:0 lds
.p2align 3
    v_pk_mul_f32 v[32:33], v[192:193], v[192:193]
    v_pk_mul_f32 v[34:35], v[194:195], v[194:195]
    v_pk_mul_f32 v[36:37], v[196:197], v[196:197]
    v_pk_mul_f32 v[38:39], v[198:199], v[198:199]
    v_pk_fma_f32 v[32:33], v[32:33], v[30:31], v[30:31] op_sel:[0,1,0] op_sel_hi:[1,1,0]
    buffer_load_dwordx4 v21, s[56:59], s84 offen offset:1024 lds
    v_pk_fma_f32 v[34:35], v[34:35], v[30:31], v[30:31] op_sel:[0,1,0] op_sel_hi:[1,1,0]
    v_pk_fma_f32 v[36:37], v[36:37], v[30:31], v[30:31] op_sel:[0,1,0] op_sel_hi:[1,1,0]
    v_pk_fma_f32 v[38:39], v[38:39], v[30:31], v[30:31] op_sel:[0,1,0] op_sel_hi:[1,1,0]
    v_pk_mul_f32 v[32:33], v[32:33], v[192:193]
    v_pk_mul_f32 v[34:35], v[34:35], v[194:195]
    v_pk_mul_f32 v[36:37], v[36:37], v[196:197]
    v_pk_mul_f32 v[38:39], v[38:39], v[198:199]
    v_exp_f32 v32, v32
    v_exp_f32 v33, v33
    v_exp_f32_e64 v34, v34
    buffer_load_dwordx4 v22, s[56:59], s84 offen offset:2048 lds
    v_exp_f32 v35, v35
    v_exp_f32 v36, v36
    v_exp_f32 v37, v37
    v_exp_f32 v38, v38
    v_exp_f32_e64 v39, v39
    v_pk_fma_f32 v[32:33], v[32:33], v[160:161], v[160:161] op_sel:[0,0,0] op_sel_hi:[1,0,0]
    v_pk_fma_f32 v[34:35], v[34:35], v[160:161], v[160:161] op_sel:[0,0,0] op_sel_hi:[1,0,0]
    buffer_load_dwordx4 v23, s[56:59], s84 offen offset:3072 lds
    v_pk_fma_f32 v[36:37], v[36:37], v[160:161], v[160:161] op_sel:[0,1,1] op_sel_hi:[1,1,1]
    v_pk_fma_f32 v[38:39], v[38:39], v[160:161], v[160:161] op_sel:[0,1,1] op_sel_hi:[1,1,1]
    v_rcp_f32 v32, v32
    v_rcp_f32 v33, v33
    v_rcp_f32 v34, v34
    v_rcp_f32 v35, v35
    v_rcp_f32_e64 v36, v36
    s_add_u32 s86, s101, 8192
    s_and_b32 s86, s86, 28672
    s_xor_b32 s86, s86, s8
    buffer_load_dwordx4 a[32:35], v2, s[36:39], s86 offen sc1
    v_rcp_f32 v37, v37
    v_rcp_f32 v38, v38
    v_rcp_f32 v39, v39
    v_pk_mul_f32 v[192:193], v[192:193], v[200:201]
    v_pk_mul_f32 v[194:195], v[194:195], v[202:203]
    v_pk_mul_f32 v[196:197], v[196:197], v[204:205]
    v_pk_mul_f32 v[198:199], v[198:199], v[206:207]
    v_pk_mul_f32 v[192:193], v[192:193], v[32:33]
    v_pk_mul_f32 v[194:195], v[194:195], v[34:35]
    buffer_load_dwordx4 a[36:39], v3, s[36:39], s86 offen sc1
    v_pk_mul_f32 v[196:197], v[196:197], v[36:37]
    v_pk_mul_f32 v[198:199], v[198:199], v[38:39]
    v_cvt_pk_bf16_f32 v200, v192, v193
    v_cvt_pk_bf16_f32 v202, v196, v197
    v_cvt_pk_bf16_f32 v201, v194, v195
    v_cvt_pk_bf16_f32 v203, v198, v199
    v_permlane16_swap_b32 v200, v202
    s_nop 0
    v_permlane16_swap_b32 v201, v203
    v_pk_mul_f32 v[40:41], v[208:209], v[208:209]
    v_pk_mul_f32 v[42:43], v[210:211], v[210:211]
    v_pk_mul_f32 v[44:45], v[212:213], v[212:213]
    v_pk_mul_f32 v[46:47], v[214:215], v[214:215]
    v_pk_fma_f32 v[40:41], v[40:41], v[30:31], v[30:31] op_sel:[0,1,0] op_sel_hi:[1,1,0]
    buffer_load_dwordx4 a[40:43], v4, s[36:39], s86 offen sc1
    v_pk_fma_f32 v[42:43], v[42:43], v[30:31], v[30:31] op_sel:[0,1,0] op_sel_hi:[1,1,0]
    v_pk_fma_f32 v[44:45], v[44:45], v[30:31], v[30:31] op_sel:[0,1,0] op_sel_hi:[1,1,0]
    v_pk_fma_f32 v[46:47], v[46:47], v[30:31], v[30:31] op_sel:[0,1,0] op_sel_hi:[1,1,0]
    v_pk_mul_f32 v[40:41], v[40:41], v[208:209]
    v_pk_mul_f32 v[42:43], v[42:43], v[210:211]
    v_pk_mul_f32 v[44:45], v[44:45], v[212:213]
    v_pk_mul_f32 v[46:47], v[46:47], v[214:215]
    v_exp_f32 v40, v40
    v_exp_f32 v41, v41
    v_exp_f32 v42, v42
    buffer_load_dwordx4 a[44:47], v5, s[36:39], s86 offen sc1
    v_exp_f32 v43, v43
    v_exp_f32 v44, v44
    v_exp_f32 v45, v45
    v_exp_f32 v46, v46
    v_exp_f32_e64 v47, v47
    v_pk_fma_f32 v[40:41], v[40:41], v[162:163], v[162:163] op_sel:[0,0,0] op_sel_hi:[1,0,0]
    v_pk_fma_f32 v[42:43], v[42:43], v[162:163], v[162:163] op_sel:[0,0,0] op_sel_hi:[1,0,0]
    v_add_u32 v20, v20, v13
    v_add_u32 v21, v21, v13
    v_add_u32 v21, 0xffffd000, v21
    v_add_u32_e64 v22, v22, v13
    v_add_u32 v22, 0x2000, v22
    v_add_u32_e64 v23, v23, v13
    v_add_u32 v23, 0xfffff000, v23
    s_add_u32 s84, s100, 0
    s_and_b32 s84, s84, 32768
    s_add_u32 m0, s50, 49152
    s_xor_b32 s84, s84, s6
    buffer_load_dwordx4 v20, s[56:59], s84 offen offset:0 lds
    v_pk_fma_f32 v[44:45], v[44:45], v[162:163], v[162:163] op_sel:[0,1,1] op_sel_hi:[1,1,1]
    v_pk_fma_f32 v[46:47], v[46:47], v[162:163], v[162:163] op_sel:[0,1,1] op_sel_hi:[1,1,1]
    v_rcp_f32 v40, v40
    v_rcp_f32 v41, v41
    v_rcp_f32 v42, v42
    v_rcp_f32 v43, v43
    v_rcp_f32_e64 v44, v44
    buffer_load_dwordx4 v21, s[56:59], s84 offen offset:1024 lds
    v_rcp_f32 v45, v45
    v_rcp_f32 v46, v46
    v_rcp_f32_e64 v47, v47
    v_pk_mul_f32 v[208:209], v[208:209], v[216:217]
    v_pk_mul_f32 v[210:211], v[210:211], v[218:219]
    v_pk_mul_f32 v[212:213], v[212:213], v[220:221]
    v_pk_mul_f32 v[214:215], v[214:215], v[222:223]
    v_pk_mul_f32 v[208:209], v[208:209], v[40:41]
    v_pk_mul_f32 v[210:211], v[210:211], v[42:43]
    buffer_store_dwordx4 v[200:203], v10, s[36:39], s54 offen offset:0 sc1
    v_pk_mul_f32 v[212:213], v[212:213], v[44:45]
    v_pk_mul_f32 v[214:215], v[214:215], v[46:47]
    v_cvt_pk_bf16_f32 v216, v208, v209
    v_cvt_pk_bf16_f32 v218, v212, v213
    v_cvt_pk_bf16_f32 v217, v210, v211
    v_cvt_pk_bf16_f32 v219, v214, v215
    v_permlane16_swap_b32 v216, v218
    s_nop 0
    v_permlane16_swap_b32 v217, v219
    buffer_store_dwordx4 v[216:219], v10, s[36:39], s54 offen offset:2048 sc1
    s_add_u32 s0, s0, 32768
    s_add_u32 s49, s1, 32768
    s_waitcnt vmcnt(19)
    v_mfma_f32_16x16x32_bf16 v[192:195], v[64:67], a[0:3], 0
    v_add_u32 v6, 0xfffe0000, v24
    v_add_u32 v7, 0xfffe0000, v25
    v_mfma_f32_16x16x32_bf16 v[196:199], v[68:71], a[0:3], 0
    v_add_u32 v8, 0xfffe0000, v26
    v_add_u32 v9, 0xfffe0000, v27
    v_mfma_f32_16x16x32_bf16 v[200:203], v[72:75], a[0:3], 0
    buffer_load_dwordx4 v22, s[56:59], s84 offen offset:2048 lds
    v_mfma_f32_16x16x32_bf16 v[204:207], v[76:79], a[0:3], 0
    v_add_u32 v28, 0xffff0000, v24
    s_waitcnt vmcnt(19)
    v_mfma_f32_16x16x32_bf16 v[220:223], v[76:79], a[4:7], 0
    v_add_u32 v29, 0xffff0000, v25
    v_add_u32 v30, 0xffff0000, v26
    v_mfma_f32_16x16x32_bf16 v[216:219], v[72:75], a[4:7], 0
    buffer_load_dwordx4 v23, s[56:59], s84 offen offset:3072 lds
    v_mfma_f32_16x16x32_bf16 v[212:215], v[68:71], a[4:7], 0
    s_add_u32 s86, s101, 12288
    s_and_b32 s86, s86, 28672
    v_mfma_f32_16x16x32_bf16 v[208:211], v[64:67], a[4:7], 0
    s_xor_b32 s86, s86, s8
    s_waitcnt vmcnt(19)
    v_mfma_f32_16x16x32_bf16 v[224:227], v[64:67], a[8:11], 0
    buffer_load_dwordx4 a[48:51], v2, s[36:39], s86 offen sc1
    v_mfma_f32_16x16x32_bf16 v[228:231], v[68:71], a[8:11], 0
    v_add_u32 v31, 0xffff0000, v27
    v_mfma_f32_16x16x32_bf16 v[232:235], v[72:75], a[8:11], 0
    v_mfma_f32_16x16x32_bf16 v[236:239], v[76:79], a[8:11], 0
    buffer_load_dwordx4 a[52:55], v3, s[36:39], s86 offen sc1
    s_waitcnt vmcnt(20)
    v_mfma_f32_16x16x32_bf16 v[252:255], v[76:79], a[12:15], 0
    v_mfma_f32_16x16x32_bf16 v[248:251], v[72:75], a[12:15], 0
    v_mfma_f32_16x16x32_bf16 v[244:247], v[68:71], a[12:15], 0
    buffer_load_dwordx4 a[56:59], v4, s[36:39], s86 offen sc1
    v_mfma_f32_16x16x32_bf16 v[240:243], v[64:67], a[12:15], 0
    s_waitcnt vmcnt(5)
    s_barrier
    v_mfma_f32_16x16x32_bf16 v[192:195], v[80:83], a[16:19], v[192:195]
    v_mfma_f32_16x16x32_bf16 v[196:199], v[84:87], a[16:19], v[196:199]
    v_mfma_f32_16x16x32_bf16 v[200:203], v[88:91], a[16:19], v[200:203]
    buffer_store_dword v24, v18, s[36:39], s0 offen sc1
    v_mfma_f32_16x16x32_bf16 v[204:207], v[92:95], a[16:19], v[204:207]
    v_mfma_f32_16x16x32_bf16 v[220:223], v[92:95], a[20:23], v[220:223]
    v_mfma_f32_16x16x32_bf16 v[216:219], v[88:91], a[20:23], v[216:219]
    buffer_load_dword v19, v1, s[36:39], s1 offen offset:1024 sc1
    v_mfma_f32_16x16x32_bf16 v[212:215], v[84:87], a[20:23], v[212:215]
    v_mfma_f32_16x16x32_bf16 v[208:211], v[80:83], a[20:23], v[208:211]
    v_mfma_f32_16x16x32_bf16 v[224:227], v[80:83], a[24:27], v[224:227]
    buffer_load_dwordx4 a[60:63], v5, s[36:39], s86 offen sc1
    v_mfma_f32_16x16x32_bf16 v[228:231], v[84:87], a[24:27], v[228:231]
    s_add_u32 s86, s101, 16384
    s_and_b32 s86, s86, 28672
    v_mfma_f32_16x16x32_bf16 v[232:235], v[88:91], a[24:27], v[232:235]
    s_xor_b32 s86, s86, s8
    v_mfma_f32_16x16x32_bf16 v[236:239], v[92:95], a[24:27], v[236:239]
    buffer_load_dwordx4 a[64:67], v2, s[36:39], s86 offen sc1
    v_mfma_f32_16x16x32_bf16 v[252:255], v[92:95], a[28:31], v[252:255]
    v_mfma_f32_16x16x32_bf16 v[248:251], v[88:91], a[28:31], v[248:251]
    v_mfma_f32_16x16x32_bf16 v[244:247], v[84:87], a[28:31], v[244:247]
    buffer_load_dwordx4 a[68:71], v3, s[36:39], s86 offen sc1
    v_mfma_f32_16x16x32_bf16 v[240:243], v[80:83], a[28:31], v[240:243]
    v_mfma_f32_16x16x32_bf16 v[192:195], v[96:99], a[32:35], v[192:195]
    ds_read_b64_tr_b16 v[48:49], v28 offset:16384
    v_mfma_f32_16x16x32_bf16 v[196:199], v[100:103], a[32:35], v[196:199]
    ds_read_b64_tr_b16 v[50:51], v28 offset:17408
    v_mfma_f32_16x16x32_bf16 v[200:203], v[104:107], a[32:35], v[200:203]
    buffer_load_dwordx4 a[72:75], v4, s[36:39], s86 offen sc1
    v_mfma_f32_16x16x32_bf16 v[204:207], v[108:111], a[32:35], v[204:207]
    ds_read_b64_tr_b16 v[52:53], v29 offset:16384
    v_mfma_f32_16x16x32_bf16 v[220:223], v[108:111], a[36:39], v[220:223]
    ds_read_b64_tr_b16 v[54:55], v29 offset:17408
    v_mfma_f32_16x16x32_bf16 v[216:219], v[104:107], a[36:39], v[216:219]
    buffer_load_dwordx4 a[76:79], v5, s[36:39], s86 offen sc1
    v_mfma_f32_16x16x32_bf16 v[212:215], v[100:103], a[36:39], v[212:215]
    ds_read_b64_tr_b16 v[56:57], v30 offset:16384
    s_add_u32 s86, s101, 20480
    s_and_b32 s86, s86, 28672
    v_mfma_f32_16x16x32_bf16 v[208:211], v[96:99], a[36:39], v[208:211]
    ds_read_b64_tr_b16 v[58:59], v30 offset:17408
    s_xor_b32 s86, s86, s8
    v_mfma_f32_16x16x32_bf16 v[224:227], v[96:99], a[40:43], v[224:227]
    buffer_load_dwordx4 a[80:83], v2, s[36:39], s86 offen sc1
    v_mfma_f32_16x16x32_bf16 v[228:231], v[100:103], a[40:43], v[228:231]
    ds_read_b64_tr_b16 v[60:61], v31 offset:16384
    v_mfma_f32_16x16x32_bf16 v[232:235], v[104:107], a[40:43], v[232:235]
    ds_read_b64_tr_b16 v[62:63], v31 offset:17408
    v_mfma_f32_16x16x32_bf16 v[236:239], v[108:111], a[40:43], v[236:239]
    buffer_load_dwordx4 a[84:87], v3, s[36:39], s86 offen sc1
    v_mfma_f32_16x16x32_bf16 v[252:255], v[108:111], a[44:47], v[252:255]
    v_mfma_f32_16x16x32_bf16 v[248:251], v[104:107], a[44:47], v[248:251]
    v_mfma_f32_16x16x32_bf16 v[244:247], v[100:103], a[44:47], v[244:247]
    buffer_load_dwordx4 a[88:91], v4, s[36:39], s86 offen sc1
    v_mfma_f32_16x16x32_bf16 v[240:243], v[96:99], a[44:47], v[240:243]
    s_waitcnt vmcnt(12) lgkmcnt(2)
    v_mfma_f32_16x16x32_bf16 v[192:195], v[48:51], a[48:51], v[192:195]
    ds_read_b64_tr_b16 v[32:33], v28 offset:32768
    v_mfma_f32_16x16x32_bf16 v[196:199], v[52:55], a[48:51], v[196:199]
    ds_read_b64_tr_b16 v[34:35], v28 offset:33792
    v_mfma_f32_16x16x32_bf16 v[200:203], v[56:59], a[48:51], v[200:203]
    buffer_load_dwordx4 a[92:95], v5, s[36:39], s86 offen sc1
    s_waitcnt lgkmcnt(2)
    v_mfma_f32_16x16x32_bf16 v[204:207], v[60:63], a[48:51], v[204:207]
    ds_read_b64_tr_b16 v[36:37], v29 offset:32768
    s_add_u32 s86, s101, 24576
    s_and_b32 s86, s86, 28672
    s_waitcnt vmcnt(12)
    v_mfma_f32_16x16x32_bf16 v[220:223], v[60:63], a[52:55], v[220:223]
    ds_read_b64_tr_b16 v[38:39], v29 offset:33792
    s_xor_b32 s86, s86, s8
    v_mfma_f32_16x16x32_bf16 v[216:219], v[56:59], a[52:55], v[216:219]
    buffer_load_dwordx4 a[96:99], v2, s[36:39], s86 offen sc1
    v_mfma_f32_16x16x32_bf16 v[212:215], v[52:55], a[52:55], v[212:215]
    ds_read_b64_tr_b16 v[40:41], v30 offset:32768
    v_mfma_f32_16x16x32_bf16 v[208:211], v[48:51], a[52:55], v[208:211]
    ds_read_b64_tr_b16 v[42:43], v30 offset:33792
    s_waitcnt vmcnt(12)
    v_mfma_f32_16x16x32_bf16 v[224:227], v[48:51], a[56:59], v[224:227]
    buffer_load_dwordx4 a[100:103], v3, s[36:39], s86 offen sc1
    v_mfma_f32_16x16x32_bf16 v[228:231], v[52:55], a[56:59], v[228:231]
    ds_read_b64_tr_b16 v[44:45], v31 offset:32768
    v_mfma_f32_16x16x32_bf16 v[232:235], v[56:59], a[56:59], v[232:235]
    ds_read_b64_tr_b16 v[46:47], v31 offset:33792
    v_mfma_f32_16x16x32_bf16 v[236:239], v[60:63], a[56:59], v[236:239]
    buffer_load_dwordx4 a[104:107], v4, s[36:39], s86 offen sc1
    s_waitcnt vmcnt(11)
    v_mfma_f32_16x16x32_bf16 v[252:255], v[60:63], a[60:63], v[252:255]
    v_mfma_f32_16x16x32_bf16 v[248:251], v[56:59], a[60:63], v[248:251]
    v_mfma_f32_16x16x32_bf16 v[244:247], v[52:55], a[60:63], v[244:247]
    buffer_load_dwordx4 a[108:111], v5, s[36:39], s86 offen sc1
    v_mfma_f32_16x16x32_bf16 v[240:243], v[48:51], a[60:63], v[240:243]
    s_waitcnt vmcnt(11) lgkmcnt(2)
    v_mfma_f32_16x16x32_bf16 v[192:195], v[32:35], a[64:67], v[192:195]
    ds_read_b64_tr_b16 v[48:49], v28 offset:0
    v_cmp_ne_u32 s[92:93], 0, v19
    s_nop 0
    s_cmp_eq_u64 s[92:93], -1
    s_cbranch_scc0 L_sp9
L_ok9:
    s_add_u32 s86, s101, 28672
    v_mfma_f32_16x16x32_bf16 v[196:199], v[36:39], a[64:67], v[196:199]
    ds_read_b64_tr_b16 v[50:51], v28 offset:1024
    s_and_b32 s86, s86, 28672
    s_xor_b32 s86, s86, s8
    v_mfma_f32_16x16x32_bf16 v[200:203], v[40:43], a[64:67], v[200:203]
    buffer_load_dwordx4 a[112:115], v2, s[36:39], s86 offen sc1
    s_waitcnt lgkmcnt(2)
    v_mfma_f32_16x16x32_bf16 v[204:207], v[44:47], a[64:67], v[204:207]
    ds_read_b64_tr_b16 v[52:53], v29 offset:0
    s_waitcnt vmcnt(11)
    v_mfma_f32_16x16x32_bf16 v[220:223], v[44:47], a[68:71], v[220:223]
    ds_read_b64_tr_b16 v[54:55], v29 offset:1024
    v_mfma_f32_16x16x32_bf16 v[216:219], v[40:43], a[68:71], v[216:219]
    buffer_load_dwordx4 a[116:119], v3, s[36:39], s86 offen sc1
    v_mfma_f32_16x16x32_bf16 v[212:215], v[36:39], a[68:71], v[212:215]
    ds_read_b64_tr_b16 v[56:57], v30 offset:0
    v_mfma_f32_16x16x32_bf16 v[208:211], v[32:35], a[68:71], v[208:211]
    ds_read_b64_tr_b16 v[58:59], v30 offset:1024
    s_waitcnt vmcnt(11)
    v_mfma_f32_16x16x32_bf16 v[224:227], v[32:35], a[72:75], v[224:227]
    buffer_load_dwordx4 a[120:123], v4, s[36:39], s86 offen sc1
    v_mfma_f32_16x16x32_bf16 v[228:231], v[36:39], a[72:75], v[228:231]
    ds_read_b64_tr_b16 v[60:61], v31 offset:0
    v_mfma_f32_16x16x32_bf16 v[232:235], v[40:43], a[72:75], v[232:235]
    ds_read_b64_tr_b16 v[62:63], v31 offset:1024
    v_mfma_f32_16x16x32_bf16 v[236:239], v[44:47], a[72:75], v[236:239]
    buffer_load_dwordx4 a[124:127], v5, s[36:39], s86 offen sc1
    s_waitcnt vmcnt(12)
    v_mfma_f32_16x16x32_bf16 v[252:255], v[44:47], a[76:79], v[252:255]
    s_add_u32 s84, s100, 32768
    s_and_b32 s84, s84, 32768
    v_mfma_f32_16x16x32_bf16 v[248:251], v[40:43], a[76:79], v[248:251]
    s_add_u32 m0, s50, 81920
    s_xor_b32 s84, s84, s6
    v_mfma_f32_16x16x32_bf16 v[244:247], v[36:39], a[76:79], v[244:247]
    buffer_load_dwordx4 v20, s[56:59], s84 offen offset:0 lds
    v_mfma_f32_16x16x32_bf16 v[240:243], v[32:35], a[76:79], v[240:243]
    s_waitcnt vmcnt(12) lgkmcnt(2)
    v_mfma_f32_16x16x32_bf16 v[192:195], v[48:51], a[80:83], v[192:195]
    ds_read_b64_tr_b16 v[32:33], v28 offset:49152
    v_mfma_f32_16x16x32_bf16 v[196:199], v[52:55], a[80:83], v[196:199]
    ds_read_b64_tr_b16 v[34:35], v28 offset:50176
    v_mfma_f32_16x16x32_bf16 v[200:203], v[56:59], a[80:83], v[200:203]
    buffer_load_dwordx4 v21, s[56:59], s84 offen offset:1024 lds
    s_waitcnt lgkmcnt(2)
    v_mfma_f32_16x16x32_bf16 v[204:207], v[60:63], a[80:83], v[204:207]
    ds_read_b64_tr_b16 v[36:37], v29 offset:49152
    s_waitcnt vmcnt(12)
    v_mfma_f32_16x16x32_bf16 v[220:223], v[60:63], a[84:87], v[220:223]
    ds_read_b64_tr_b16 v[38:39], v29 offset:50176
    v_mfma_f32_16x16x32_bf16 v[216:219], v[56:59], a[84:87], v[216:219]
    buffer_load_dwordx4 v22, s[56:59], s84 offen offset:2048 lds
    v_mfma_f32_16x16x32_bf16 v[212:215], v[52:55], a[84:87], v[212:215]
    ds_read_b64_tr_b16 v[40:41], v30 offset:49152
    v_mfma_f32_16x16x32_bf16 v[208:211], v[48:51], a[84:87], v[208:211]
    ds_read_b64_tr_b16 v[42:43], v30 offset:50176
    s_waitcnt vmcnt(12)
    v_mfma_f32_16x16x32_bf16 v[224:227], v[48:51], a[88:91], v[224:227]
    buffer_load_dwordx4 v23, s[56:59], s84 offen offset:3072 lds
    v_mfma_f32_16x16x32_bf16 v[228:231], v[52:55], a[88:91], v[228:231]
    ds_read_b64_tr_b16 v[44:45], v31 offset:49152
    s_add_u32 s86, s101, 0
    s_and_b32 s86, s86, 12288
    v_mfma_f32_16x16x32_bf16 v[232:235], v[56:59], a[88:91], v[232:235]
    ds_read_b64_tr_b16 v[46:47], v31 offset:50176
    s_xor_b32 s86, s86, s9
    v_mfma_f32_16x16x32_bf16 v[236:239], v[60:63], a[88:91], v[236:239]
    buffer_load_dwordx4 a[128:131], v2, s[36:39], s86 offen sc1
    s_waitcnt vmcnt(13)
    v_mfma_f32_16x16x32_bf16 v[252:255], v[60:63], a[92:95], v[252:255]
    v_mfma_f32_16x16x32_bf16 v[248:251], v[56:59], a[92:95], v[248:251]
    v_mfma_f32_16x16x32_bf16 v[244:247], v[52:55], a[92:95], v[244:247]
    buffer_load_dwordx4 a[132:135], v3, s[36:39], s86 offen sc1
    v_mfma_f32_16x16x32_bf16 v[240:243], v[48:51], a[92:95], v[240:243]
    s_waitcnt vmcnt(13) lgkmcnt(2)
    v_mfma_f32_16x16x32_bf16 v[192:195], v[32:35], a[96:99], v[192:195]
    ds_read_b64_tr_b16 v[48:49], v24 offset:0
    v_mfma_f32_16x16x32_bf16 v[196:199], v[36:39], a[96:99], v[196:199]
    ds_read_b64_tr_b16 v[50:51], v24 offset:1024
    v_mfma_f32_16x16x32_bf16 v[200:203], v[40:43], a[96:99], v[200:203]
    buffer_load_dwordx4 a[136:139], v4, s[36:39], s86 offen sc1
    s_waitcnt lgkmcnt(2)
    v_mfma_f32_16x16x32_bf16 v[204:207], v[44:47], a[96:99], v[204:207]
    ds_read_b64_tr_b16 v[52:53], v25 offset:0
    s_waitcnt vmcnt(13)
    v_mfma_f32_16x16x32_bf16 v[220:223], v[44:47], a[100:103], v[220:223]
    ds_read_b64_tr_b16 v[54:55], v25 offset:1024
    v_mfma_f32_16x16x32_bf16 v[216:219], v[40:43], a[100:103], v[216:219]
    buffer_load_dwordx4 a[140:143], v5, s[36:39], s86 offen sc1
    v_mfma_f32_16x16x32_bf16 v[212:215], v[36:39], a[100:103], v[212:215]
    ds_read_b64_tr_b16 v[56:57], v26 offset:0
    s_add_u32 s86, s101, 4096
    s_and_b32 s86, s86, 12288
    v_mfma_f32_16x16x32_bf16 v[208:211], v[32:35], a[100:103], v[208:211]
    ds_read_b64_tr_b16 v[58:59], v26 offset:1024
    s_xor_b32 s86, s86, s9
    s_waitcnt vmcnt(13)
    v_mfma_f32_16x16x32_bf16 v[224:227], v[32:35], a[104:107], v[224:227]
    buffer_load_dwordx4 a[144:147], v2, s[36:39], s86 offen sc1
    v_mfma_f32_16x16x32_bf16 v[228:231], v[36:39], a[104:107], v[228:231]
    ds_read_b64_tr_b16 v[60:61], v27 offset:0
    v_mfma_f32_16x16x32_bf16 v[232:235], v[40:43], a[104:107], v[232:235]
    ds_read_b64_tr_b16 v[62:63], v27 offset:1024
    v_mfma_f32_16x16x32_bf16 v[236:239], v[44:47], a[104:107], v[236:239]
    buffer_load_dwordx4 a[148:151], v3, s[36:39], s86 offen sc1
    s_waitcnt vmcnt(14)
    v_mfma_f32_16x16x32_bf16 v[252:255], v[44:47], a[108:111], v[252:255]
    v_mfma_f32_16x16x32_bf16 v[248:251], v[40:43], a[108:111], v[248:251]
    v_mfma_f32_16x16x32_bf16 v[244:247], v[36:39], a[108:111], v[244:247]
    buffer_load_dwordx4 a[152:155], v4, s[36:39], s86 offen sc1
    v_mfma_f32_16x16x32_bf16 v[240:243], v[32:35], a[108:111], v[240:243]
    s_waitcnt vmcnt(14) lgkmcnt(2)
    v_mfma_f32_16x16x32_bf16 v[192:195], v[48:51], a[112:115], v[192:195]
    ds_read_b64_tr_b16 v[32:33], v24 offset:16384
    v_mfma_f32_16x16x32_bf16 v[196:199], v[52:55], a[112:115], v[196:199]
    ds_read_b64_tr_b16 v[34:35], v24 offset:17408
    v_mfma_f32_16x16x32_bf16 v[200:203], v[56:59], a[112:115], v[200:203]
    buffer_load_dwordx4 a[156:159], v5, s[36:39], s86 offen sc1
    s_waitcnt lgkmcnt(2)
    v_mfma_f32_16x16x32_bf16 v[204:207], v[60:63], a[112:115], v[204:207]
    ds_read_b64_tr_b16 v[36:37], v25 offset:16384
    s_add_u32 s86, s101, 8192
    s_and_b32 s86, s86, 12288
    s_waitcnt vmcnt(14)
    v_mfma_f32_16x16x32_bf16 v[220:223], v[60:63], a[116:119], v[220:223]
    ds_read_b64_tr_b16 v[38:39], v25 offset:17408
    s_xor_b32 s86, s86, s9
    v_mfma_f32_16x16x32_bf16 v[216:219], v[56:59], a[116:119], v[216:219]
    buffer_load_dwordx4 a[160:163], v2, s[36:39], s86 offen sc1
    v_mfma_f32_16x16x32_bf16 v[212:215], v[52:55], a[116:119], v[212:215]
    ds_read_b64_tr_b16 v[40:41], v26 offset:16384
    v_mfma_f32_16x16x32_bf16 v[208:211], v[48:51], a[116:119], v[208:211]
    ds_read_b64_tr_b16 v[42:43], v26 offset:17408
    s_waitcnt vmcnt(14)
    v_mfma_f32_16x16x32_bf16 v[224:227], v[48:51], a[120:123], v[224:227]
    buffer_load_dwordx4 a[164:167], v3, s[36:39], s86 offen sc1
    v_mfma_f32_16x16x32_bf16 v[228:231], v[52:55], a[120:123], v[228:231]
    ds_read_b64_tr_b16 v[44:45], v27 offset:16384
    v_mfma_f32_16x16x32_bf16 v[232:235], v[56:59], a[120:123], v[232:235]
    ds_read_b64_tr_b16 v[46:47], v27 offset:17408
    v_mfma_f32_16x16x32_bf16 v[236:239], v[60:63], a[120:123], v[236:239]
    buffer_load_dwordx4 a[168:171], v4, s[36:39], s86 offen sc1
    s_waitcnt vmcnt(15)
    v_mfma_f32_16x16x32_bf16 v[252:255], v[60:63], a[124:127], v[252:255]
    v_mfma_f32_16x16x32_bf16 v[248:251], v[56:59], a[124:127], v[248:251]
    v_mfma_f32_16x16x32_bf16 v[244:247], v[52:55], a[124:127], v[244:247]
    buffer_load_dwordx4 a[172:175], v5, s[36:39], s86 offen sc1
    v_mfma_f32_16x16x32_bf16 v[240:243], v[48:51], a[124:127], v[240:243]
    s_waitcnt vmcnt(11) lgkmcnt(2)
    v_mfma_f32_16x16x32_bf16 v[192:195], v[32:35], a[128:131], v[192:195]
    ds_read_b64_tr_b16 v[48:49], v6 offset:0
    v_mfma_f32_16x16x32_bf16 v[196:199], v[36:39], a[128:131], v[196:199]
    ds_read_b64_tr_b16 v[50:51], v6 offset:1024
    v_mfma_f32_16x16x32_bf16 v[200:203], v[40:43], a[128:131], v[200:203]
    buffer_load_dword v19, v1, s[36:39], s49 offen offset:1024 sc1
    s_waitcnt lgkmcnt(2)
    v_mfma_f32_16x16x32_bf16 v[204:207], v[44:47], a[128:131], v[204:207]
    ds_read_b64_tr_b16 v[52:53], v7 offset:0
    s_waitcnt vmcnt(11)
    v_mfma_f32_16x16x32_bf16 v[220:223], v[44:47], a[132:135], v[220:223]
    ds_read_b64_tr_b16 v[54:55], v7 offset:1024
    v_mfma_f32_16x16x32_bf16 v[216:219], v[40:43], a[132:135], v[216:219]
    buffer_load_dword v10, v1, s[36:39], s49 offen offset:0 sc1
    v_mfma_f32_16x16x32_bf16 v[212:215], v[36:39], a[132:135], v[212:215]
    ds_read_b64_tr_b16 v[56:57], v8 offset:0
    v_sub_u32 v20, v20, v13
    v_sub_u32 v21, v21, v13
    v_add_u32 v21, 0x3000, v21
    v_sub_u32_e64 v22, v22, v13
    v_add_u32 v22, 0xffffe000, v22
    v_sub_u32_e64 v23, v23, v13
    v_mfma_f32_16x16x32_bf16 v[208:211], v[32:35], a[132:135], v[208:211]
    ds_read_b64_tr_b16 v[58:59], v8 offset:1024
    v_add_u32 v23, 0x1000, v23
    s_add_u32 s84, s100, 0
    s_and_b32 s84, s84, 98304
    s_add_u32 m0, s50, 98304
    s_xor_b32 s84, s84, s7
    s_waitcnt vmcnt(11)
    v_mfma_f32_16x16x32_bf16 v[224:227], v[32:35], a[136:139], v[224:227]
    buffer_load_dwordx4 v20, s[60:63], s84 offen offset:0 lds
    v_mfma_f32_16x16x32_bf16 v[228:231], v[36:39], a[136:139], v[228:231]
    ds_read_b64_tr_b16 v[60:61], v9 offset:0
    v_mfma_f32_16x16x32_bf16 v[232:235], v[40:43], a[136:139], v[232:235]
    ds_read_b64_tr_b16 v[62:63], v9 offset:1024
    v_mfma_f32_16x16x32_bf16 v[236:239], v[44:47], a[136:139], v[236:239]
    buffer_load_dwordx4 v21, s[60:63], s84 offen offset:1024 lds
    s_waitcnt vmcnt(12)
    v_mfma_f32_16x16x32_bf16 v[252:255], v[44:47], a[140:143], v[252:255]
    v_mfma_f32_16x16x32_bf16 v[248:251], v[40:43], a[140:143], v[248:251]
    v_mfma_f32_16x16x32_bf16 v[244:247], v[36:39], a[140:143], v[244:247]
    buffer_load_dwordx4 v22, s[60:63], s84 offen offset:2048 lds
    v_mfma_f32_16x16x32_bf16 v[240:243], v[32:35], a[140:143], v[240:243]
    s_waitcnt vmcnt(12) lgkmcnt(2)
    v_mfma_f32_16x16x32_bf16 v[192:195], v[48:51], a[144:147], v[192:195]
    ds_read_b64_tr_b16 v[32:33], v6 offset:16384
    v_mfma_f32_16x16x32_bf16 v[196:199], v[52:55], a[144:147], v[196:199]
    ds_read_b64_tr_b16 v[34:35], v6 offset:17408
    v_mfma_f32_16x16x32_bf16 v[200:203], v[56:59], a[144:147], v[200:203]
    buffer_load_dwordx4 v23, s[60:63], s84 offen offset:3072 lds
    s_waitcnt lgkmcnt(2)
    v_mfma_f32_16x16x32_bf16 v[204:207], v[60:63], a[144:147], v[204:207]
    ds_read_b64_tr_b16 v[36:37], v7 offset:16384
    s_add_u32 s86, s101, 12288
    s_and_b32 s86, s86, 12288
    s_waitcnt vmcnt(12)
    v_mfma_f32_16x16x32_bf16 v[220:223], v[60:63], a[148:151], v[220:223]
    ds_read_b64_tr_b16 v[38:39], v7 offset:17408
    s_xor_b32 s86, s86, s9
    v_mfma_f32_16x16x32_bf16 v[216:219], v[56:59], a[148:151], v[216:219]
    buffer_load_dwordx4 a[176:179], v2, s[36:39], s86 offen sc1
    v_mfma_f32_16x16x32_bf16 v[212:215], v[52:55], a[148:151], v[212:215]
    ds_read_b64_tr_b16 v[40:41], v8 offset:16384
    v_mfma_f32_16x16x32_bf16 v[208:211], v[48:51], a[148:151], v[208:211]
    ds_read_b64_tr_b16 v[42:43], v8 offset:17408
    s_waitcnt vmcnt(12)
    v_mfma_f32_16x16x32_bf16 v[224:227], v[48:51], a[152:155], v[224:227]
    buffer_load_dwordx4 a[180:183], v3, s[36:39], s86 offen sc1
    v_mfma_f32_16x16x32_bf16 v[228:231], v[52:55], a[152:155], v[228:231]
    ds_read_b64_tr_b16 v[44:45], v9 offset:16384
    v_mfma_f32_16x16x32_bf16 v[232:235], v[56:59], a[152:155], v[232:235]
    ds_read_b64_tr_b16 v[46:47], v9 offset:17408
    v_mfma_f32_16x16x32_bf16 v[236:239], v[60:63], a[152:155], v[236:239]
    buffer_load_dwordx4 a[184:187], v4, s[36:39], s86 offen sc1
    s_waitcnt vmcnt(13)
    v_mfma_f32_16x16x32_bf16 v[252:255], v[60:63], a[156:159], v[252:255]
    v_mfma_f32_16x16x32_bf16 v[248:251], v[56:59], a[156:159], v[248:251]
    v_mfma_f32_16x16x32_bf16 v[244:247], v[52:55], a[156:159], v[244:247]
    buffer_load_dwordx4 a[188:191], v5, s[36:39], s86 offen sc1
    v_mfma_f32_16x16x32_bf16 v[240:243], v[48:51], a[156:159], v[240:243]
    s_waitcnt vmcnt(13) lgkmcnt(2)
    v_mfma_f32_16x16x32_bf16 v[192:195], v[32:35], a[160:163], v[192:195]
    ds_read_b64_tr_b16 v[48:49], v6 offset:32768
    s_waitcnt vmcnt(9)
    v_cmp_ne_u32 s[92:93], 0, v19
    s_nop 0
    s_cmp_eq_u64 s[92:93], -1
    s_cbranch_scc0 L_sp10
L_ok10:
    s_waitcnt vmcnt(8)
    v_cmp_ne_u32 s[92:93], 0, v10
    s_nop 0
    s_cmp_eq_u64 s[92:93], -1
    s_cbranch_scc0 L_sp11
L_ok11:
    s_add_u32 s86, s101, 0
    v_mfma_f32_16x16x32_bf16 v[196:199], v[36:39], a[160:163], v[196:199]
    ds_read_b64_tr_b16 v[50:51], v6 offset:33792
    s_and_b32 s86, s86, 4096
    s_xor_b32 s86, s86, s10
    v_mfma_f32_16x16x32_bf16 v[200:203], v[40:43], a[160:163], v[200:203]
L_kvmain_s5:
    s_cbranch_execz L_kvmain_ret
    buffer_load_dwordx4 a[192:195], v2, s[36:39], s86 offen sc1
    s_waitcnt lgkmcnt(2)
    v_mfma_f32_16x16x32_bf16 v[204:207], v[44:47], a[160:163], v[204:207]
    ds_read_b64_tr_b16 v[52:53], v7 offset:32768
    v_mfma_f32_16x16x32_bf16 v[220:223], v[44:47], a[164:167], v[220:223]
    ds_read_b64_tr_b16 v[54:55], v7 offset:33792
    v_mfma_f32_16x16x32_bf16 v[216:219], v[40:43], a[164:167], v[216:219]
    buffer_load_dwordx4 a[196:199], v3, s[36:39], s86 offen sc1
    v_mfma_f32_16x16x32_bf16 v[212:215], v[36:39], a[164:167], v[212:215]
    ds_read_b64_tr_b16 v[56:57], v8 offset:32768
    v_mfma_f32_16x16x32_bf16 v[208:211], v[32:35], a[164:167], v[208:211]
    ds_read_b64_tr_b16 v[58:59], v8 offset:33792
    v_mfma_f32_16x16x32_bf16 v[224:227], v[32:35], a[168:171], v[224:227]
    buffer_load_dwordx4 a[200:203], v4, s[36:39], s86 offen sc1
    v_mfma_f32_16x16x32_bf16 v[228:231], v[36:39], a[168:171], v[228:231]
    ds_read_b64_tr_b16 v[60:61], v9 offset:32768
    v_mfma_f32_16x16x32_bf16 v[232:235], v[40:43], a[168:171], v[232:235]
    ds_read_b64_tr_b16 v[62:63], v9 offset:33792
    v_mfma_f32_16x16x32_bf16 v[236:239], v[44:47], a[168:171], v[236:239]
    buffer_load_dwordx4 a[204:207], v5, s[36:39], s86 offen sc1
    v_mfma_f32_16x16x32_bf16 v[252:255], v[44:47], a[172:175], v[252:255]
    s_add_u32 s86, s101, 4096
    s_and_b32 s86, s86, 4096
    v_mfma_f32_16x16x32_bf16 v[248:251], v[40:43], a[172:175], v[248:251]
    s_xor_b32 s86, s86, s10
    v_mfma_f32_16x16x32_bf16 v[244:247], v[36:39], a[172:175], v[244:247]
    buffer_load_dwordx4 a[208:211], v2, s[36:39], s86 offen sc1
    v_mfma_f32_16x16x32_bf16 v[240:243], v[32:35], a[172:175], v[240:243]
    s_waitcnt vmcnt(8) lgkmcnt(2)
    v_mfma_f32_16x16x32_bf16 v[192:195], v[48:51], a[176:179], v[192:195]
    ds_read_b64_tr_b16 v[32:33], v6 offset:49152
    v_add_u32 v14, s51, v16
    v_mfma_f32_16x16x32_bf16 v[196:199], v[52:55], a[176:179], v[196:199]
    ds_read_b64_tr_b16 v[34:35], v6 offset:50176
    v_xor_b32 v15, 0x1000, v14
    v_mfma_f32_16x16x32_bf16 v[200:203], v[56:59], a[176:179], v[200:203]
    buffer_load_dwordx4 a[212:215], v3, s[36:39], s86 offen sc1
    s_waitcnt lgkmcnt(2)
    v_mfma_f32_16x16x32_bf16 v[204:207], v[60:63], a[176:179], v[204:207]
    ds_read_b64_tr_b16 v[36:37], v7 offset:49152
    s_waitcnt vmcnt(8)
    v_mfma_f32_16x16x32_bf16 v[220:223], v[60:63], a[180:183], v[220:223]
    ds_read_b64_tr_b16 v[38:39], v7 offset:50176
    v_xor_b32 v11, 0x2000, v14
    v_mfma_f32_16x16x32_bf16 v[216:219], v[56:59], a[180:183], v[216:219]
    buffer_load_dwordx4 a[216:219], v4, s[36:39], s86 offen sc1
    v_mfma_f32_16x16x32_bf16 v[212:215], v[52:55], a[180:183], v[212:215]
    ds_read_b64_tr_b16 v[40:41], v8 offset:49152
    v_xor_b32 v12, 0x3000, v14
    v_mfma_f32_16x16x32_bf16 v[208:211], v[48:51], a[180:183], v[208:211]
    ds_read_b64_tr_b16 v[42:43], v8 offset:50176
    s_waitcnt vmcnt(8)
    v_mfma_f32_16x16x32_bf16 v[224:227], v[48:51], a[184:187], v[224:227]
    buffer_load_dwordx4 a[220:223], v5, s[36:39], s86 offen sc1
    v_mfma_f32_16x16x32_bf16 v[228:231], v[52:55], a[184:187], v[228:231]
    ds_read_b64_tr_b16 v[44:45], v9 offset:49152
    s_add_u32 s12, s101, 0
    s_and_b32 s12, s12, 12288
    s_xor_b32 s12, s12, s11
    s_add_u32 s13, s101, 4096
    s_and_b32 s13, s13, 12288
    s_xor_b32 s13, s13, s11
    v_mfma_f32_16x16x32_bf16 v[232:235], v[56:59], a[184:187], v[232:235]
    ds_read_b64_tr_b16 v[46:47], v9 offset:50176
    s_add_u32 s14, s101, 8192
    s_and_b32 s14, s14, 12288
    s_xor_b32 s14, s14, s11
    s_add_u32 s15, s101, 12288
    s_and_b32 s15, s15, 12288
    s_xor_b32 s15, s15, s11
    v_mfma_f32_16x16x32_bf16 v[236:239], v[60:63], a[184:187], v[236:239]
    buffer_load_dwordx4 a[228:231], v3, s[36:39], s12 offen sc1
    s_waitcnt vmcnt(9)
    v_mfma_f32_16x16x32_bf16 v[252:255], v[60:63], a[188:191], v[252:255]
    v_and_b32 v18, 60, v0
    v_and_b32_e64 v13, 3, v0
    v_mfma_f32_16x16x32_bf16 v[248:251], v[56:59], a[188:191], v[248:251]
    v_lshlrev_b32_e64 v17, 8, v18
    v_lshl_add_u32 v17, v13, 4, v17
    v_mfma_f32_16x16x32_bf16 v[244:247], v[52:55], a[188:191], v[244:247]
    buffer_load_dwordx4 a[244:247], v3, s[36:39], s13 offen sc1
    v_mfma_f32_16x16x32_bf16 v[240:243], v[48:51], a[188:191], v[240:243]
    v_and_b32 v13, 1, v0
    s_waitcnt vmcnt(9) lgkmcnt(1)
    v_mfma_f32_16x16x32_bf16 v[192:195], v[32:35], a[192:195], v[192:195]
    ds_read_b64_tr_b16 v[48:49], v28 offset:16384
    v_lshl_add_u32 v18, v13, 7, v18
    v_mfma_f32_16x16x32_bf16 v[196:199], v[36:39], a[192:195], v[196:199]
    ds_read_b64_tr_b16 v[50:51], v28 offset:17408
    v_bfe_u32 v13, v0, 1, 1
    v_mfma_f32_16x16x32_bf16 v[200:203], v[40:43], a[192:195], v[200:203]
    buffer_load_dwordx4 a[4:7], v3, s[36:39], s14 offen sc1
    s_waitcnt lgkmcnt(2)
    v_mfma_f32_16x16x32_bf16 v[204:207], v[44:47], a[192:195], v[204:207]
    ds_read_b64_tr_b16 v[52:53], v29 offset:16384
    s_waitcnt vmcnt(9)
    v_mfma_f32_16x16x32_bf16 v[220:223], v[44:47], a[196:199], v[220:223]
    ds_read_b64_tr_b16 v[54:55], v29 offset:17408
    v_lshl_add_u32 v18, v13, 6, v18
    v_mfma_f32_16x16x32_bf16 v[216:219], v[40:43], a[196:199], v[216:219]
    buffer_load_dwordx4 a[20:23], v3, s[36:39], s15 offen sc1
    v_mfma_f32_16x16x32_bf16 v[212:215], v[36:39], a[196:199], v[212:215]
    ds_read_b64_tr_b16 v[56:57], v30 offset:16384
    s_lshl2_add_u32 s48, s90, s40
    v_mfma_f32_16x16x32_bf16 v[208:211], v[32:35], a[196:199], v[208:211]
    ds_read_b64_tr_b16 v[58:59], v30 offset:17408
    s_waitcnt vmcnt(9)
    v_mfma_f32_16x16x32_bf16 v[224:227], v[32:35], a[200:203], v[224:227]
    buffer_load_dwordx4 a[232:235], v4, s[36:39], s12 offen sc1
    v_mfma_f32_16x16x32_bf16 v[228:231], v[36:39], a[200:203], v[228:231]
    ds_read_b64_tr_b16 v[60:61], v31 offset:16384
    s_lshl_b32 s48, s48, 14
    v_mfma_f32_16x16x32_bf16 v[232:235], v[40:43], a[200:203], v[232:235]
    ds_read_b64_tr_b16 v[62:63], v31 offset:17408
    s_lshl_b32 s53, s91, 7
    v_mfma_f32_16x16x32_bf16 v[236:239], v[44:47], a[200:203], v[236:239]
    buffer_load_dwordx4 a[248:251], v4, s[36:39], s13 offen sc1
    s_waitcnt vmcnt(10)
    v_mfma_f32_16x16x32_bf16 v[252:255], v[44:47], a[204:207], v[252:255]
    s_add_u32 s53, s48, s53
    v_mfma_f32_16x16x32_bf16 v[248:251], v[40:43], a[204:207], v[248:251]
    v_mfma_f32_16x16x32_bf16 v[244:247], v[36:39], a[204:207], v[244:247]
    buffer_load_dwordx4 a[8:11], v4, s[36:39], s14 offen sc1
    v_mfma_f32_16x16x32_bf16 v[240:243], v[32:35], a[204:207], v[240:243]
    s_waitcnt vmcnt(9) lgkmcnt(2)
    v_mfma_f32_16x16x32_bf16 v[208:211], v[48:51], a[212:215], v[208:211]
    ds_read_b64_tr_b16 v[32:33], v28 offset:32768
    v_mfma_f32_16x16x32_bf16 v[212:215], v[52:55], a[212:215], v[212:215]
    buffer_load_dwordx4 a[24:27], v4, s[36:39], s15 offen sc1
    ds_read_b64_tr_b16 v[34:35], v28 offset:33792
    v_mfma_f32_16x16x32_bf16 v[216:219], v[56:59], a[212:215], v[216:219]
    ds_read_b64_tr_b16 v[36:37], v29 offset:32768
    s_waitcnt lgkmcnt(3)
    v_mfma_f32_16x16x32_bf16 v[220:223], v[60:63], a[212:215], v[220:223]
    buffer_load_dwordx4 a[236:239], v5, s[36:39], s12 offen sc1
    s_waitcnt vmcnt(10)
    v_mfma_f32_16x16x32_bf16 v[236:239], v[60:63], a[216:219], v[236:239]
    ds_read_b64_tr_b16 v[38:39], v29 offset:33792
    v_mfma_f32_16x16x32_bf16 v[232:235], v[56:59], a[216:219], v[232:235]
    buffer_load_dwordx4 a[252:255], v5, s[36:39], s13 offen sc1
    v_mfma_f32_16x16x32_bf16 v[228:231], v[52:55], a[216:219], v[228:231]
    ds_read_b64_tr_b16 v[40:41], v30 offset:32768
    v_mfma_f32_16x16x32_bf16 v[224:227], v[48:51], a[216:219], v[224:227]
    ds_read_b64_tr_b16 v[42:43], v30 offset:33792
    s_waitcnt vmcnt(10)
    v_mfma_f32_16x16x32_bf16 v[240:243], v[48:51], a[220:223], v[240:243]
    buffer_load_dwordx4 a[12:15], v5, s[36:39], s14 offen sc1
    v_mfma_f32_16x16x32_bf16 v[244:247], v[52:55], a[220:223], v[244:247]
    ds_read_b64_tr_b16 v[44:45], v31 offset:32768
    v_mfma_f32_16x16x32_bf16 v[248:251], v[56:59], a[220:223], v[248:251]
    buffer_load_dwordx4 a[28:31], v5, s[36:39], s15 offen sc1
    v_mfma_f32_16x16x32_bf16 v[252:255], v[60:63], a[220:223], v[252:255]
    ds_read_b64_tr_b16 v[46:47], v31 offset:33792
    s_waitcnt vmcnt(11) lgkmcnt(4)
    v_mfma_f32_16x16x32_bf16 v[208:211], v[32:35], a[228:231], v[208:211]
    v_mfma_f32_16x16x32_bf16 v[212:215], v[36:39], a[228:231], v[212:215]
    buffer_load_dwordx4 a[224:227], v2, s[36:39], s12 offen sc1
    s_waitcnt lgkmcnt(2)
    v_mfma_f32_16x16x32_bf16 v[216:219], v[40:43], a[228:231], v[216:219]
    s_waitcnt lgkmcnt(0)
    v_mfma_f32_16x16x32_bf16 v[220:223], v[44:47], a[228:231], v[220:223]
    s_waitcnt vmcnt(11)
    v_mfma_f32_16x16x32_bf16 v[208:211], v[112:115], a[244:247], v[208:211]
    v_mfma_f32_16x16x32_bf16 v[212:215], v[116:119], a[244:247], v[212:215]
    buffer_load_dwordx4 a[240:243], v2, s[36:39], s13 offen sc1
    v_mfma_f32_16x16x32_bf16 v[216:219], v[120:123], a[244:247], v[216:219]
    v_mfma_f32_16x16x32_bf16 v[220:223], v[124:127], a[244:247], v[220:223]
    s_waitcnt vmcnt(11)
    v_mfma_f32_16x16x32_bf16 v[208:211], v[128:131], a[4:7], v[208:211]
    v_mfma_f32_16x16x32_bf16 v[212:215], v[132:135], a[4:7], v[212:215]
    buffer_load_dwordx4 a[0:3], v2, s[36:39], s14 offen sc1
    v_mfma_f32_16x16x32_bf16 v[216:219], v[136:139], a[4:7], v[216:219]
    v_mfma_f32_16x16x32_bf16 v[220:223], v[140:143], a[4:7], v[220:223]
    s_waitcnt vmcnt(11)
    v_mfma_f32_16x16x32_bf16 v[208:211], v[144:147], a[20:23], v[208:211]
    v_mfma_f32_16x16x32_bf16 v[212:215], v[148:151], a[20:23], v[212:215]
    buffer_load_dwordx4 a[16:19], v2, s[36:39], s15 offen sc1
    v_mfma_f32_16x16x32_bf16 v[216:219], v[152:155], a[20:23], v[216:219]
    v_mfma_f32_16x16x32_bf16 v[220:223], v[156:159], a[20:23], v[220:223]
    s_waitcnt vmcnt(11)
    v_mfma_f32_16x16x32_bf16 v[224:227], v[32:35], a[232:235], v[224:227]
    v_mfma_f32_16x16x32_bf16 v[228:231], v[36:39], a[232:235], v[228:231]
    v_mfma_f32_16x16x32_bf16 v[232:235], v[40:43], a[232:235], v[232:235]
    v_mfma_f32_16x16x32_bf16 v[236:239], v[44:47], a[232:235], v[236:239]
    s_waitcnt vmcnt(10)
    v_mfma_f32_16x16x32_bf16 v[224:227], v[112:115], a[248:251], v[224:227]
    ds_write_b128 v14, v[208:211] offset:0
    v_mfma_f32_16x16x32_bf16 v[228:231], v[116:119], a[248:251], v[228:231]
    v_mfma_f32_16x16x32_bf16 v[232:235], v[120:123], a[248:251], v[232:235]
    v_mfma_f32_16x16x32_bf16 v[236:239], v[124:127], a[248:251], v[236:239]
    ds_write_b128 v14, v[212:215] offset:1024
    s_waitcnt vmcnt(9)
    v_mfma_f32_16x16x32_bf16 v[224:227], v[128:131], a[8:11], v[224:227]
    v_mfma_f32_16x16x32_bf16 v[228:231], v[132:135], a[8:11], v[228:231]
    v_mfma_f32_16x16x32_bf16 v[232:235], v[136:139], a[8:11], v[232:235]
    ds_write_b128 v14, v[216:219] offset:2048
    v_mfma_f32_16x16x32_bf16 v[236:239], v[140:143], a[8:11], v[236:239]
    s_waitcnt vmcnt(8)
    v_mfma_f32_16x16x32_bf16 v[224:227], v[144:147], a[24:27], v[224:227]
    v_mfma_f32_16x16x32_bf16 v[228:231], v[148:151], a[24:27], v[228:231]
    ds_write_b128 v14, v[220:223] offset:3072
    v_mfma_f32_16x16x32_bf16 v[232:235], v[152:155], a[24:27], v[232:235]
    v_mfma_f32_16x16x32_bf16 v[236:239], v[156:159], a[24:27], v[236:239]
    s_waitcnt vmcnt(7)
    v_mfma_f32_16x16x32_bf16 v[240:243], v[32:35], a[236:239], v[240:243]
    v_mfma_f32_16x16x32_bf16 v[244:247], v[36:39], a[236:239], v[244:247]
    v_mfma_f32_16x16x32_bf16 v[248:251], v[40:43], a[236:239], v[248:251]
    v_mfma_f32_16x16x32_bf16 v[252:255], v[44:47], a[236:239], v[252:255]
    ds_write_b128 v14, v[224:227] offset:16384
    s_waitcnt vmcnt(6)
    v_mfma_f32_16x16x32_bf16 v[240:243], v[112:115], a[252:255], v[240:243]
    v_mfma_f32_16x16x32_bf16 v[244:247], v[116:119], a[252:255], v[244:247]
    v_mfma_f32_16x16x32_bf16 v[248:251], v[120:123], a[252:255], v[248:251]
    ds_write_b128 v14, v[228:231] offset:17408
    v_mfma_f32_16x16x32_bf16 v[252:255], v[124:127], a[252:255], v[252:255]
    s_waitcnt vmcnt(5)
    v_mfma_f32_16x16x32_bf16 v[240:243], v[128:131], a[12:15], v[240:243]
    v_mfma_f32_16x16x32_bf16 v[244:247], v[132:135], a[12:15], v[244:247]
    ds_write_b128 v14, v[232:235] offset:18432
    v_mfma_f32_16x16x32_bf16 v[248:251], v[136:139], a[12:15], v[248:251]
    v_mfma_f32_16x16x32_bf16 v[252:255], v[140:143], a[12:15], v[252:255]
    s_waitcnt vmcnt(4)
    v_mfma_f32_16x16x32_bf16 v[240:243], v[144:147], a[28:31], v[240:243]
    ds_write_b128 v14, v[236:239] offset:19456
    v_mfma_f32_16x16x32_bf16 v[244:247], v[148:151], a[28:31], v[244:247]
    v_mfma_f32_16x16x32_bf16 v[248:251], v[152:155], a[28:31], v[248:251]
    v_mfma_f32_16x16x32_bf16 v[252:255], v[156:159], a[28:31], v[252:255]
    s_waitcnt lgkmcnt(0)
    s_barrier
    v_mfma_f32_16x16x32_bf16 v[204:207], v[60:63], a[208:211], v[204:207]
    ds_read_b128 v[64:67], v15 offset:0
    v_mfma_f32_16x16x32_bf16 v[200:203], v[56:59], a[208:211], v[200:203]
    ds_write_b128 v14, v[240:243] offset:32768
    v_mfma_f32_16x16x32_bf16 v[196:199], v[52:55], a[208:211], v[196:199]
    ds_read_b128 v[68:71], v15 offset:1024
    v_mfma_f32_16x16x32_bf16 v[192:195], v[48:51], a[208:211], v[192:195]
    ds_read_b128 v[72:75], v15 offset:2048
    s_waitcnt vmcnt(3)
    v_mfma_f32_16x16x32_bf16 v[192:195], v[32:35], a[224:227], v[192:195]
    ds_write_b128 v14, v[244:247] offset:33792
    v_mfma_f32_16x16x32_bf16 v[196:199], v[36:39], a[224:227], v[196:199]
    ds_read_b128 v[76:79], v15 offset:3072
    v_mfma_f32_16x16x32_bf16 v[200:203], v[40:43], a[224:227], v[200:203]
    ds_read_b128 v[80:83], v11 offset:16384
    v_mfma_f32_16x16x32_bf16 v[204:207], v[44:47], a[224:227], v[204:207]
    ds_write_b128 v14, v[248:251] offset:34816
    s_waitcnt vmcnt(2)
    v_mfma_f32_16x16x32_bf16 v[192:195], v[112:115], a[240:243], v[192:195]
    ds_read_b128 v[84:87], v11 offset:17408
    v_mfma_f32_16x16x32_bf16 v[196:199], v[116:119], a[240:243], v[196:199]
    ds_read_b128 v[88:91], v11 offset:18432
    v_mfma_f32_16x16x32_bf16 v[200:203], v[120:123], a[240:243], v[200:203]
    ds_write_b128 v14, v[252:255] offset:35840
    v_mfma_f32_16x16x32_bf16 v[204:207], v[124:127], a[240:243], v[204:207]
    ds_read_b128 v[92:95], v11 offset:19456
    s_waitcnt lgkmcnt(5)
    v_add_f32_e64 v64, v64, v80
    s_waitcnt vmcnt(1)
    v_mfma_f32_16x16x32_bf16 v[192:195], v[128:131], a[0:3], v[192:195]
    v_add_f32 v65, v65, v81
    v_add_f32 v66, v66, v82
    v_mfma_f32_16x16x32_bf16 v[196:199], v[132:135], a[0:3], v[196:199]
    v_add_f32 v67, v67, v83
    s_waitcnt lgkmcnt(3)
    v_add_f32 v68, v68, v84
    s_waitcnt lgkmcnt(0)
    v_mfma_f32_16x16x32_bf16 v[200:203], v[136:139], a[0:3], v[200:203]
    s_barrier
    v_mfma_f32_16x16x32_bf16 v[204:207], v[140:143], a[0:3], v[204:207]
    ds_read_b128 v[96:99], v12 offset:32768
    v_add_f32_e64 v69, v69, v85
    s_waitcnt vmcnt(0)
    v_mfma_f32_16x16x32_bf16 v[192:195], v[144:147], a[16:19], v[192:195]
    ds_read_b128 v[100:103], v12 offset:33792
    v_add_f32_e64 v70, v70, v86
    v_mfma_f32_16x16x32_bf16 v[196:199], v[148:151], a[16:19], v[196:199]
    ds_read_b128 v[104:107], v12 offset:34816
    v_add_f32_e64 v71, v71, v87
    v_mfma_f32_16x16x32_bf16 v[200:203], v[152:155], a[16:19], v[200:203]
    ds_read_b128 v[108:111], v12 offset:35840
    v_add_f32_e64 v72, v72, v88
    v_mfma_f32_16x16x32_bf16 v[204:207], v[156:159], a[16:19], v[204:207]
    v_add_f32 v73, v73, v89
    v_add_f32 v74, v74, v90
    v_add_f32_e64 v75, v75, v91
    v_pk_add_f32 v[76:77], v[76:77], v[92:93]
    v_pk_add_f32 v[78:79], v[78:79], v[94:95]
    s_waitcnt lgkmcnt(3)
    v_pk_add_f32 v[64:65], v[64:65], v[96:97]
    v_pk_add_f32 v[66:67], v[66:67], v[98:99]
    s_waitcnt lgkmcnt(2)
    v_pk_add_f32 v[68:69], v[68:69], v[100:101]
    v_pk_add_f32 v[70:71], v[70:71], v[102:103]
    s_waitcnt lgkmcnt(1)
    v_pk_add_f32 v[72:73], v[72:73], v[104:105]
    v_pk_add_f32 v[74:75], v[74:75], v[106:107]
    s_waitcnt lgkmcnt(0)
    v_pk_add_f32 v[76:77], v[76:77], v[108:109]
    v_pk_add_f32 v[78:79], v[78:79], v[110:111]
    v_pk_add_f32 v[192:193], v[192:193], v[64:65]
    v_pk_add_f32 v[194:195], v[194:195], v[66:67]
    v_cvt_pk_bf16_f32 v32, v192, v193
    v_cvt_pk_bf16_f32 v33, v194, v195
    v_pk_add_f32 v[196:197], v[196:197], v[68:69]
    v_pk_add_f32 v[198:199], v[198:199], v[70:71]
    v_cvt_pk_bf16_f32 v34, v196, v197
    v_cvt_pk_bf16_f32 v35, v198, v199
    s_nop 0
    v_permlane16_swap_b32 v32, v34
    v_permlane16_swap_b32 v33, v35
    ds_bpermute_b32 v40, v18, v32
    ds_bpermute_b32 v41, v18, v33
    ds_bpermute_b32 v42, v18, v34
    ds_bpermute_b32 v43, v18, v35
    v_pk_add_f32 v[200:201], v[200:201], v[72:73]
    v_pk_add_f32 v[202:203], v[202:203], v[74:75]
    v_cvt_pk_bf16_f32 v36, v200, v201
    v_cvt_pk_bf16_f32 v37, v202, v203
    v_pk_add_f32 v[204:205], v[204:205], v[76:77]
    v_pk_add_f32 v[206:207], v[206:207], v[78:79]
    v_cvt_pk_bf16_f32 v38, v204, v205
    v_cvt_pk_bf16_f32 v39, v206, v207
    s_nop 0
    v_permlane16_swap_b32 v36, v38
    v_permlane16_swap_b32 v37, v39
    ds_bpermute_b32 v44, v18, v36
    ds_bpermute_b32 v45, v18, v37
    ds_bpermute_b32 v46, v18, v38
    ds_bpermute_b32 v47, v18, v39
    s_waitcnt lgkmcnt(4)
    buffer_store_dwordx4 v[40:43], v17, s[76:79], s53 offen offset:0 sc1
    s_waitcnt lgkmcnt(0)
    buffer_store_dwordx4 v[44:47], v17, s[76:79], s53 offen offset:64 sc1
    s_endpgm
L_last:
    s_endpgm
.section .rodata,"a"
.p2align 6

.amdhsa_kernel gated_mix__linear_kernel_hedgehog__glu_gated_geglu__prompt_kernel
  .amdhsa_next_free_vgpr 512
  .amdhsa_next_free_sgpr 102
  .amdhsa_accum_offset 256
  .amdhsa_group_segment_fixed_size 0
  .amdhsa_kernarg_size 96
  .amdhsa_user_sgpr_count 2
  .amdhsa_user_sgpr_kernarg_segment_ptr 1
  .amdhsa_system_sgpr_workgroup_id_x 1
.end_amdhsa_kernel
```
